```python
import torch

def _softmax(x, axis=-1):
    return torch.softmax(x, dim=axis)
def _gelu(x):
    return torch.nn.functional.gelu(x, approximate="tanh")
def _silu(x):
    return torch.nn.functional.silu(x)
def _sigmoid(x):
    return torch.sigmoid(x)
def _layernorm(x, axis=-1, eps=1e-5):
    m = x.mean(dim=axis, keepdim=True)
    v = x.var(dim=axis, keepdim=True, unbiased=False)
    return (x - m) / torch.sqrt(v + eps)
def _scatter_add(tgt, idx, src, axis=0):
    return tgt.clone().index_add_(axis, idx, src)
def _segment_sum(src, seg, n):
    out = torch.zeros((n,) + src.shape[1:], dtype=src.dtype)
    return out.index_add_(0, seg, src)
def _pad(x, pw):
    flat = tuple(v for pair in reversed(pw) for v in pair)
    return torch.nn.functional.pad(x, flat)

kernel_name = 'standalone__gqa_block_cached__near_ridge'

def setup_inputs():

    _w = (lambda a: (lambda t: t.to(torch.bfloat16) if t.is_floating_point() else t)(torch.as_tensor(a)))
    B, Sq, D = 16, 64, 512
    Hq, Hkv, Sk, Dh = 32, 8, 1024, 128
    assert Hq % Hkv == 0, (Hq, Hkv)
    return {
        "x": _w((lambda *s: torch.randn(*s, dtype=torch.bfloat16) * 0.8)(B, Sq, D)),
        "k_cache": _w((lambda *s: torch.randn(*s, dtype=torch.bfloat16) * 0.8)(B, Hkv, Sk, Dh)),
        "v_cache": _w((lambda *s: torch.randn(*s, dtype=torch.bfloat16) * 0.05)(B, Hkv, Sk, Dh)),
        "wq": _w((lambda *s: torch.randn(*s, dtype=torch.bfloat16) * 0.8)(D, Hq * Dh) * (D ** -0.5)),
        "wo": _w((lambda *s: torch.randn(*s, dtype=torch.bfloat16) * 0.05)(Hq * Dh, D) * ((Hq * Dh) ** -0.5)),
    }

def reference(x, k_cache, v_cache, wq, wo):
    B, Sq, D = x.shape
    Hq, Dh = 32, 128
    Hkv = k_cache.shape[1]
    rep = Hq // Hkv
    q = (lambda x, *d: x.permute(*d))((x @ wq).reshape(B, Sq, Hq, Dh), 0, 2, 1, 3)
    k = (lambda x, n, axis: torch.repeat_interleave(x, n, dim=axis))(k_cache, rep, axis=1)
    v = (lambda x, n, axis: torch.repeat_interleave(x, n, dim=axis))(v_cache, rep, axis=1)
    scores = torch.einsum("bhqd,bhkd->bhqk", q, k) * (Dh ** -0.5)
    p = _softmax(scores, axis=-1)
    o = torch.einsum("bhqk,bhkd->bhqd", p, v)
    return (lambda x, *d: x.permute(*d))(o, 0, 2, 1, 3).reshape(B, Sq, Hq * Dh) @ wo
```

```asm
; @launch grid=(256,1,1) block=(512,1,1) lds=163840
.amdgcn_target "amdgcn-amd-amdhsa--gfx950"
.text
.globl standalone__gqa_block_cached__near_ridge_kernel
.p2align 8
.type standalone__gqa_block_cached__near_ridge_kernel,@function
standalone__gqa_block_cached__near_ridge_kernel:
    s_cmp_ge_u32 s2, 256
    s_cbranch_scc1 L_end
    s_memrealtime s[70:71]
    s_load_dwordx16 s[4:19], s[0:1], 0
    v_lshrrev_b32 v1, 6, v0
    v_and_b32 v0, 63, v0
    v_readfirstlane_b32 s3, v1
    s_and_b32 s60, s2, 7
    s_lshr_b32 s61, s2, 4
    s_bfe_u32 s62, s2, 0x10003
    s_lshl_b32 s63, s60, 1
    s_add_u32 s63, s63, s62
    s_and_b32 s68, s61, 3
    s_cmp_lt_u32 s3, 4
    s_cbranch_scc1 L_compute
    s_lshr_b32 s69, s61, 2
    s_and_b32 s76, s60, 3
    s_xor_b32 s77, s76, s69
    s_lshl_b32 s76, s76, 2
    s_xor_b32 s76, s76, s61
    s_sub_u32 s49, s3, 4
    s_lshl_b32 s48, s49, 11
    s_lshl_b32 s56, s76, 18
    s_lshl_b32 s57, s77, 8
    v_lshrrev_b32 v2, 4, v0
    v_and_b32 v3, 15, v0
    v_lshrrev_b32 v4, 5, v0
    v_and_b32 v5, 31, v0
    s_and_b32 s65, s49, 1
    s_lshl_b32 s65, s65, 3
    v_or_b32 v6, s65, v2
    v_xor_b32 v6, v6, v3
    v_lshlrev_b32 v6, 4, v6
    s_lshl_b32 s65, s49, 3
    v_add_u32 v7, s65, v2
    v_lshl_add_u32 v8, v7, 10, v6
    v_xor_b32 v9, 64, v8
    v_add_u32 v9, 3072, v9
    s_lshl_b32 s65, s49, 2
    v_add_u32 v18, s65, v4
    s_lshr_b32 s65, s49, 1
    s_lshl_b32 s65, s65, 3
    v_lshl_or_b32 v19, v4, 1, s65
    v_xor_b32 v19, v19, v5
    v_lshlrev_b32 v19, 4, v19
    v_lshl_add_u32 v10, v18, 13, v19
    v_xor_b32 v11, 64, v10
    v_add_u32 v11, 15360, v11
    s_waitcnt lgkmcnt(0)
    s_lshl_b32 s66, s61, 16
    s_add_u32 s20, s4, s66
    s_addc_u32 s21, s5, 0
    s_mov_b32 s22, 65536
    s_mov_b32 s23, 0x20000
    s_lshl_b32 s66, s63, 9
    s_add_u32 s24, s10, s66
    s_addc_u32 s25, s11, 0
    s_mov_b32 s26, 4186624
    s_mov_b32 s27, 0x20000
    s_add_u32 m0, s48, 0
    s_xor_b32 s53, s57, 0
    buffer_load_dwordx4 v8, s[20:23], s53 offen  lds
    buffer_load_dwordx4 v9, s[20:23], s53 offen offset:1024  lds
    s_add_u32 m0, s48, 8192
    s_xor_b32 s53, s57, 32768
    buffer_load_dwordx4 v8, s[20:23], s53 offen  lds
    buffer_load_dwordx4 v9, s[20:23], s53 offen offset:1024  lds
    s_add_u32 m0, s48, 65536
    s_xor_b32 s53, s56, 0
    buffer_load_dwordx4 v10, s[24:27], s53 offen  lds
    buffer_load_dwordx4 v11, s[24:27], s53 offen offset:1024  lds
    s_add_u32 m0, s48, 73728
    s_xor_b32 s53, s56, 131072
    buffer_load_dwordx4 v10, s[24:27], s53 offen  lds
    buffer_load_dwordx4 v11, s[24:27], s53 offen offset:1024  lds
    s_lshl_b32 s64, s61, 3
    s_add_u32 s64, s64, s60
    s_lshl_b32 s66, s64, 18
    s_add_u32 s28, s6, s66
    s_addc_u32 s29, s7, 0
    s_mov_b32 s30, 262144
    s_mov_b32 s31, 0x20000
    s_lshl_b32 s66, s64, 18
    s_add_u32 s32, s8, s66
    s_addc_u32 s33, s9, 0
    s_mov_b32 s34, 262144
    s_mov_b32 s35, 0x20000
    s_lshl_b32 s66, s63, 18
    s_add_u32 s36, s12, s66
    s_addc_u32 s37, s13, 0
    s_mov_b32 s38, 262144
    s_mov_b32 s39, 0x20000
    v_lshl_add_u32 v12, v7, 8, v6
    v_xor_b32 v13, 64, v12
    v_lshlrev_b32 v18, 1, v2
    v_xor_b32 v19, v18, v3
    v_lshlrev_b32 v19, 4, v19
    v_lshl_add_u32 v14, v7, 8, v19
    v_xor_b32 v15, 128, v14
    v_and_b32 v19, 7, v0
    v_xor_b32 v19, v19, v18
    v_lshlrev_b32 v19, 4, v19
    v_lshrrev_b32 v18, 3, v0
    s_lshl_b32 s65, s49, 4
    v_add_u32 v18, s65, v18
    v_lshl_add_u32 v16, v18, 10, v19
    v_add_u32 v17, 7168, v16
    s_lshr_b32 s65, s61, 3
    s_lshl_b32 s65, s65, 17
    s_and_b32 s66, s61, 7
    s_lshl_b32 s66, s66, 7
    s_or_b32 s58, s65, s66
    s_lshl_b32 s44, s62, 13
    s_xor_b32 s45, s44, 8192
    s_add_u32 s46, s44, s48
    s_add_u32 s47, s45, s48
    s_add_u32 m0, s48, 16384
    s_xor_b32 s53, s56, 262144
    buffer_load_dwordx4 v10, s[24:27], s53 offen  lds
    buffer_load_dwordx4 v11, s[24:27], s53 offen offset:1024  lds
    s_add_u32 m0, s48, 24576
    s_xor_b32 s53, s56, 393216
    buffer_load_dwordx4 v10, s[24:27], s53 offen  lds
    buffer_load_dwordx4 v11, s[24:27], s53 offen offset:1024  lds
    s_add_u32 m0, s48, 81920
    s_xor_b32 s53, s56, 524288
    buffer_load_dwordx4 v10, s[24:27], s53 offen  lds
    buffer_load_dwordx4 v11, s[24:27], s53 offen offset:1024  lds
    s_add_u32 m0, s48, 90112
    s_xor_b32 s53, s56, 655360
    buffer_load_dwordx4 v10, s[24:27], s53 offen  lds
    buffer_load_dwordx4 v11, s[24:27], s53 offen offset:1024  lds
    s_lshl_b32 s66, s61, 20
    s_add_u32 s88, s18, s66
    s_addc_u32 s89, s19, 0
    s_mov_b32 s90, 1048576
    s_mov_b32 s91, 0x20000
    s_lshl_b32 s66, s61, 16
    s_add_u32 s84, s14, s66
    s_addc_u32 s85, s15, 0
    s_mov_b32 s86, 65536
    s_mov_b32 s87, 0x20000
    s_lshl_b32 s66, s61, 13
    s_add_u32 s66, s66, 0x1000000
    s_add_u32 s92, s18, s66
    s_addc_u32 s93, s19, 0
    s_mov_b32 s94, 8192
    s_mov_b32 s95, 0x20000
    v_mov_b32 v21, 131072
    v_lshlrev_b32 v20, 4, v0
    v_lshlrev_b32 v26, 4, v0
    v_add_u32 v26, s48, v26
    v_add_u32 v27, 65536, v26
    s_waitcnt vmcnt(8)
    s_barrier
    s_add_u32 m0, s48, 32768
    s_xor_b32 s53, s57, 256
    buffer_load_dwordx4 v8, s[20:23], s53 offen  lds
    buffer_load_dwordx4 v9, s[20:23], s53 offen offset:1024  lds
    s_add_u32 m0, s48, 40960
    s_xor_b32 s53, s57, 33024
    buffer_load_dwordx4 v8, s[20:23], s53 offen  lds
    buffer_load_dwordx4 v9, s[20:23], s53 offen offset:1024  lds
    s_add_u32 m0, s48, 98304
    s_xor_b32 s53, s56, 786432
    buffer_load_dwordx4 v10, s[24:27], s53 offen  lds
    buffer_load_dwordx4 v11, s[24:27], s53 offen offset:1024  lds
    s_add_u32 m0, s48, 106496
    s_xor_b32 s53, s56, 917504
    buffer_load_dwordx4 v10, s[24:27], s53 offen  lds
    buffer_load_dwordx4 v11, s[24:27], s53 offen offset:1024  lds
    s_waitcnt vmcnt(8)
    s_barrier
    s_add_u32 m0, s48, 49152
    s_xor_b32 s53, s56, 1048576
    buffer_load_dwordx4 v10, s[24:27], s53 offen  lds
    buffer_load_dwordx4 v11, s[24:27], s53 offen offset:1024  lds
    s_add_u32 m0, s48, 57344
    s_xor_b32 s53, s56, 1179648
    buffer_load_dwordx4 v10, s[24:27], s53 offen  lds
    buffer_load_dwordx4 v11, s[24:27], s53 offen offset:1024  lds
    s_add_u32 m0, s48, 114688
    s_xor_b32 s53, s56, 1310720
    buffer_load_dwordx4 v10, s[24:27], s53 offen  lds
    buffer_load_dwordx4 v11, s[24:27], s53 offen offset:1024  lds
    s_add_u32 m0, s48, 122880
    s_xor_b32 s53, s56, 1441792
    buffer_load_dwordx4 v10, s[24:27], s53 offen  lds
    buffer_load_dwordx4 v11, s[24:27], s53 offen offset:1024  lds
    s_waitcnt vmcnt(8)
    s_barrier
    s_add_u32 m0, s48, 0
    s_xor_b32 s53, s57, 512
    buffer_load_dwordx4 v8, s[20:23], s53 offen  lds
    buffer_load_dwordx4 v9, s[20:23], s53 offen offset:1024  lds
    s_add_u32 m0, s48, 8192
    s_xor_b32 s53, s57, 33280
    buffer_load_dwordx4 v8, s[20:23], s53 offen  lds
    buffer_load_dwordx4 v9, s[20:23], s53 offen offset:1024  lds
    s_add_u32 m0, s48, 65536
    s_xor_b32 s53, s56, 1572864
    buffer_load_dwordx4 v10, s[24:27], s53 offen  lds
    buffer_load_dwordx4 v11, s[24:27], s53 offen offset:1024  lds
    s_add_u32 m0, s48, 73728
    s_xor_b32 s53, s56, 1703936
    buffer_load_dwordx4 v10, s[24:27], s53 offen  lds
    buffer_load_dwordx4 v11, s[24:27], s53 offen offset:1024  lds
    s_waitcnt vmcnt(8)
    s_barrier
    s_add_u32 m0, s48, 16384
    s_xor_b32 s53, s56, 1835008
    buffer_load_dwordx4 v10, s[24:27], s53 offen  lds
    buffer_load_dwordx4 v11, s[24:27], s53 offen offset:1024  lds
    s_add_u32 m0, s48, 24576
    s_xor_b32 s53, s56, 1966080
    buffer_load_dwordx4 v10, s[24:27], s53 offen  lds
    buffer_load_dwordx4 v11, s[24:27], s53 offen offset:1024  lds
    s_add_u32 m0, s48, 81920
    s_xor_b32 s53, s56, 2097152
    buffer_load_dwordx4 v10, s[24:27], s53 offen  lds
    buffer_load_dwordx4 v11, s[24:27], s53 offen offset:1024  lds
    s_add_u32 m0, s48, 90112
    s_xor_b32 s53, s56, 2228224
    buffer_load_dwordx4 v10, s[24:27], s53 offen  lds
    buffer_load_dwordx4 v11, s[24:27], s53 offen offset:1024  lds
    s_waitcnt vmcnt(8)
    s_barrier
    s_add_u32 m0, s48, 32768
    s_xor_b32 s53, s56, 2359296
    buffer_load_dwordx4 v10, s[24:27], s53 offen  lds
    buffer_load_dwordx4 v11, s[24:27], s53 offen offset:1024  lds
    s_add_u32 m0, s48, 40960
    s_xor_b32 s53, s56, 2490368
    buffer_load_dwordx4 v10, s[24:27], s53 offen  lds
    buffer_load_dwordx4 v11, s[24:27], s53 offen offset:1024  lds
    s_add_u32 m0, s48, 98304
    s_xor_b32 s53, s56, 2621440
    buffer_load_dwordx4 v10, s[24:27], s53 offen  lds
    buffer_load_dwordx4 v11, s[24:27], s53 offen offset:1024  lds
    s_add_u32 m0, s48, 106496
    s_xor_b32 s53, s56, 2752512
    buffer_load_dwordx4 v10, s[24:27], s53 offen  lds
    buffer_load_dwordx4 v11, s[24:27], s53 offen offset:1024  lds
    s_waitcnt vmcnt(8)
    s_barrier
    s_add_u32 m0, s48, 49152
    s_xor_b32 s53, s57, 768
    buffer_load_dwordx4 v8, s[20:23], s53 offen  lds
    buffer_load_dwordx4 v9, s[20:23], s53 offen offset:1024  lds
    s_add_u32 m0, s48, 57344
    s_xor_b32 s53, s57, 33536
    buffer_load_dwordx4 v8, s[20:23], s53 offen  lds
    buffer_load_dwordx4 v9, s[20:23], s53 offen offset:1024  lds
    s_add_u32 m0, s48, 114688
    s_xor_b32 s53, s56, 2883584
    buffer_load_dwordx4 v10, s[24:27], s53 offen  lds
    buffer_load_dwordx4 v11, s[24:27], s53 offen offset:1024  lds
    s_add_u32 m0, s48, 122880
    s_xor_b32 s53, s56, 3014656
    buffer_load_dwordx4 v10, s[24:27], s53 offen  lds
    buffer_load_dwordx4 v11, s[24:27], s53 offen offset:1024  lds
    s_waitcnt vmcnt(8)
    s_barrier
    s_add_u32 m0, s48, 0
    s_xor_b32 s53, s56, 3145728
    buffer_load_dwordx4 v10, s[24:27], s53 offen  lds
    buffer_load_dwordx4 v11, s[24:27], s53 offen offset:1024  lds
    s_add_u32 m0, s48, 8192
    s_xor_b32 s53, s56, 3276800
    buffer_load_dwordx4 v10, s[24:27], s53 offen  lds
    buffer_load_dwordx4 v11, s[24:27], s53 offen offset:1024  lds
    s_add_u32 m0, s48, 65536
    s_xor_b32 s53, s56, 3407872
    buffer_load_dwordx4 v10, s[24:27], s53 offen  lds
    buffer_load_dwordx4 v11, s[24:27], s53 offen offset:1024  lds
    s_add_u32 m0, s48, 73728
    s_xor_b32 s53, s56, 3538944
    buffer_load_dwordx4 v10, s[24:27], s53 offen  lds
    buffer_load_dwordx4 v11, s[24:27], s53 offen offset:1024  lds
    s_waitcnt vmcnt(8)
    s_barrier
    s_add_u32 m0, s48, 16384
    s_xor_b32 s53, s56, 3670016
    buffer_load_dwordx4 v10, s[24:27], s53 offen  lds
    buffer_load_dwordx4 v11, s[24:27], s53 offen offset:1024  lds
    s_add_u32 m0, s48, 24576
    s_xor_b32 s53, s56, 3801088
    buffer_load_dwordx4 v10, s[24:27], s53 offen  lds
    buffer_load_dwordx4 v11, s[24:27], s53 offen offset:1024  lds
    s_add_u32 m0, s48, 81920
    s_xor_b32 s53, s56, 3932160
    buffer_load_dwordx4 v10, s[24:27], s53 offen  lds
    buffer_load_dwordx4 v11, s[24:27], s53 offen offset:1024  lds
    s_add_u32 m0, s48, 90112
    s_xor_b32 s53, s56, 4063232
    buffer_load_dwordx4 v10, s[24:27], s53 offen  lds
    buffer_load_dwordx4 v11, s[24:27], s53 offen offset:1024  lds
    s_add_u32 m0, s46, 32768
    s_add_u32 s53, s44, 0
    buffer_load_dwordx4 v12, s[28:31], s53 offen nt lds
    buffer_load_dwordx4 v13, s[28:31], s53 offen offset:1024 nt lds
    s_add_u32 m0, s47, 32768
    s_add_u32 s53, s45, 0
    buffer_load_dwordx4 v12, s[28:31], s53 offen nt lds
    buffer_load_dwordx4 v13, s[28:31], s53 offen offset:1024 nt lds
    s_waitcnt vmcnt(12)
    s_barrier
    s_add_u32 m0, s46, 49152
    s_add_u32 s53, s44, 16384
    buffer_load_dwordx4 v12, s[28:31], s53 offen nt lds
    buffer_load_dwordx4 v13, s[28:31], s53 offen offset:1024 nt lds
    s_add_u32 m0, s47, 49152
    s_add_u32 s53, s45, 16384
    buffer_load_dwordx4 v12, s[28:31], s53 offen nt lds
    buffer_load_dwordx4 v13, s[28:31], s53 offen offset:1024 nt lds
    s_waitcnt vmcnt(8)
    s_barrier
    s_add_u32 m0, s46, 114688
    s_add_u32 s53, s44, 0
    buffer_load_dwordx4 v14, s[32:35], s53 offen nt lds
    buffer_load_dwordx4 v15, s[32:35], s53 offen offset:1024 nt lds
    s_add_u32 m0, s47, 114688
    s_add_u32 s53, s45, 0
    buffer_load_dwordx4 v14, s[32:35], s53 offen nt lds
    buffer_load_dwordx4 v15, s[32:35], s53 offen offset:1024 nt lds
    s_waitcnt vmcnt(8)
    s_barrier
    s_add_u32 m0, s46, 0
    s_add_u32 s53, s44, 32768
    buffer_load_dwordx4 v12, s[28:31], s53 offen nt lds
    buffer_load_dwordx4 v13, s[28:31], s53 offen offset:1024 nt lds
    s_add_u32 m0, s46, 65536
    s_add_u32 s53, s44, 16384
    buffer_load_dwordx4 v14, s[32:35], s53 offen nt lds
    buffer_load_dwordx4 v15, s[32:35], s53 offen offset:1024 nt lds
    s_add_u32 m0, s47, 0
    s_add_u32 s53, s45, 32768
    buffer_load_dwordx4 v12, s[28:31], s53 offen nt lds
    buffer_load_dwordx4 v13, s[28:31], s53 offen offset:1024 nt lds
    s_add_u32 m0, s47, 65536
    s_add_u32 s53, s45, 16384
    buffer_load_dwordx4 v14, s[32:35], s53 offen nt lds
    buffer_load_dwordx4 v15, s[32:35], s53 offen offset:1024 nt lds
L_re_loader:
    s_waitcnt vmcnt(8)
    s_barrier
    s_add_u32 m0, s46, 16384
    s_add_u32 s53, s44, 49152
    buffer_load_dwordx4 v12, s[28:31], s53 offen nt lds
    buffer_load_dwordx4 v13, s[28:31], s53 offen offset:1024 nt lds
    s_add_u32 m0, s46, 81920
    s_add_u32 s53, s44, 32768
    buffer_load_dwordx4 v14, s[32:35], s53 offen nt lds
    buffer_load_dwordx4 v15, s[32:35], s53 offen offset:1024 nt lds
    s_add_u32 m0, s47, 16384
    s_add_u32 s53, s45, 49152
    buffer_load_dwordx4 v12, s[28:31], s53 offen nt lds
    buffer_load_dwordx4 v13, s[28:31], s53 offen offset:1024 nt lds
    s_add_u32 m0, s47, 81920
    s_add_u32 s53, s45, 32768
    buffer_load_dwordx4 v14, s[32:35], s53 offen nt lds
    buffer_load_dwordx4 v15, s[32:35], s53 offen offset:1024 nt lds
    s_waitcnt vmcnt(8)
    s_barrier
    s_add_u32 m0, s46, 32768
    s_add_u32 s53, s44, 65536
    buffer_load_dwordx4 v12, s[28:31], s53 offen nt lds
    buffer_load_dwordx4 v13, s[28:31], s53 offen offset:1024 nt lds
    s_add_u32 m0, s46, 98304
    s_add_u32 s53, s44, 49152
    buffer_load_dwordx4 v14, s[32:35], s53 offen nt lds
    buffer_load_dwordx4 v15, s[32:35], s53 offen offset:1024 nt lds
    s_add_u32 m0, s47, 32768
    s_add_u32 s53, s45, 65536
    buffer_load_dwordx4 v12, s[28:31], s53 offen nt lds
    buffer_load_dwordx4 v13, s[28:31], s53 offen offset:1024 nt lds
    s_add_u32 m0, s47, 98304
    s_add_u32 s53, s45, 49152
    buffer_load_dwordx4 v14, s[32:35], s53 offen nt lds
    buffer_load_dwordx4 v15, s[32:35], s53 offen offset:1024 nt lds
    s_waitcnt vmcnt(8)
    s_barrier
    s_add_u32 m0, s46, 49152
    s_add_u32 s53, s44, 81920
    buffer_load_dwordx4 v12, s[28:31], s53 offen nt lds
    buffer_load_dwordx4 v13, s[28:31], s53 offen offset:1024 nt lds
    s_add_u32 m0, s46, 114688
    s_add_u32 s53, s44, 65536
    buffer_load_dwordx4 v14, s[32:35], s53 offen nt lds
    buffer_load_dwordx4 v15, s[32:35], s53 offen offset:1024 nt lds
    s_add_u32 m0, s47, 49152
    s_add_u32 s53, s45, 81920
    buffer_load_dwordx4 v12, s[28:31], s53 offen nt lds
    buffer_load_dwordx4 v13, s[28:31], s53 offen offset:1024 nt lds
    s_add_u32 m0, s47, 114688
    s_add_u32 s53, s45, 65536
    buffer_load_dwordx4 v14, s[32:35], s53 offen nt lds
    buffer_load_dwordx4 v15, s[32:35], s53 offen offset:1024 nt lds
    s_waitcnt vmcnt(8)
    s_barrier
    s_add_u32 m0, s46, 0
    s_add_u32 s53, s44, 98304
    buffer_load_dwordx4 v12, s[28:31], s53 offen nt lds
    buffer_load_dwordx4 v13, s[28:31], s53 offen offset:1024 nt lds
    s_add_u32 m0, s46, 65536
    s_add_u32 s53, s44, 81920
    buffer_load_dwordx4 v14, s[32:35], s53 offen nt lds
    buffer_load_dwordx4 v15, s[32:35], s53 offen offset:1024 nt lds
    s_add_u32 m0, s47, 0
    s_add_u32 s53, s45, 98304
    buffer_load_dwordx4 v12, s[28:31], s53 offen nt lds
    buffer_load_dwordx4 v13, s[28:31], s53 offen offset:1024 nt lds
    s_add_u32 m0, s47, 65536
    s_add_u32 s53, s45, 81920
    buffer_load_dwordx4 v14, s[32:35], s53 offen nt lds
    buffer_load_dwordx4 v15, s[32:35], s53 offen offset:1024 nt lds
    s_waitcnt vmcnt(8)
    s_barrier
    s_add_u32 m0, s46, 16384
    s_add_u32 s53, s44, 114688
    buffer_load_dwordx4 v12, s[28:31], s53 offen nt lds
    buffer_load_dwordx4 v13, s[28:31], s53 offen offset:1024 nt lds
    s_add_u32 m0, s46, 81920
    s_add_u32 s53, s44, 98304
    buffer_load_dwordx4 v14, s[32:35], s53 offen nt lds
    buffer_load_dwordx4 v15, s[32:35], s53 offen offset:1024 nt lds
    s_add_u32 m0, s47, 16384
    s_add_u32 s53, s45, 114688
    buffer_load_dwordx4 v12, s[28:31], s53 offen nt lds
    buffer_load_dwordx4 v13, s[28:31], s53 offen offset:1024 nt lds
    s_add_u32 m0, s47, 81920
    s_add_u32 s53, s45, 98304
    buffer_load_dwordx4 v14, s[32:35], s53 offen nt lds
    buffer_load_dwordx4 v15, s[32:35], s53 offen offset:1024 nt lds
    s_waitcnt vmcnt(8)
    s_barrier
    s_add_u32 m0, s46, 32768
    s_add_u32 s53, s44, 131072
    buffer_load_dwordx4 v12, s[28:31], s53 offen nt lds
    buffer_load_dwordx4 v13, s[28:31], s53 offen offset:1024 nt lds
    s_add_u32 m0, s46, 98304
    s_add_u32 s53, s44, 114688
    buffer_load_dwordx4 v14, s[32:35], s53 offen nt lds
    buffer_load_dwordx4 v15, s[32:35], s53 offen offset:1024 nt lds
    s_add_u32 m0, s47, 32768
    s_add_u32 s53, s45, 131072
    buffer_load_dwordx4 v12, s[28:31], s53 offen nt lds
    buffer_load_dwordx4 v13, s[28:31], s53 offen offset:1024 nt lds
    s_add_u32 m0, s47, 98304
    s_add_u32 s53, s45, 114688
    buffer_load_dwordx4 v14, s[32:35], s53 offen nt lds
    buffer_load_dwordx4 v15, s[32:35], s53 offen offset:1024 nt lds
    s_waitcnt vmcnt(8)
    s_barrier
    s_add_u32 m0, s46, 49152
    s_add_u32 s53, s44, 147456
    buffer_load_dwordx4 v12, s[28:31], s53 offen nt lds
    buffer_load_dwordx4 v13, s[28:31], s53 offen offset:1024 nt lds
    s_add_u32 m0, s46, 114688
    s_add_u32 s53, s44, 131072
    buffer_load_dwordx4 v14, s[32:35], s53 offen nt lds
    buffer_load_dwordx4 v15, s[32:35], s53 offen offset:1024 nt lds
    s_add_u32 m0, s47, 49152
    s_add_u32 s53, s45, 147456
    buffer_load_dwordx4 v12, s[28:31], s53 offen nt lds
    buffer_load_dwordx4 v13, s[28:31], s53 offen offset:1024 nt lds
    s_add_u32 m0, s47, 114688
    s_add_u32 s53, s45, 131072
    buffer_load_dwordx4 v14, s[32:35], s53 offen nt lds
    buffer_load_dwordx4 v15, s[32:35], s53 offen offset:1024 nt lds
    s_waitcnt vmcnt(8)
    s_barrier
    s_add_u32 m0, s46, 0
    s_add_u32 s53, s44, 163840
    buffer_load_dwordx4 v12, s[28:31], s53 offen nt lds
    buffer_load_dwordx4 v13, s[28:31], s53 offen offset:1024 nt lds
    s_add_u32 m0, s46, 65536
    s_add_u32 s53, s44, 147456
    buffer_load_dwordx4 v14, s[32:35], s53 offen nt lds
    buffer_load_dwordx4 v15, s[32:35], s53 offen offset:1024 nt lds
    s_add_u32 m0, s47, 0
    s_add_u32 s53, s45, 163840
    buffer_load_dwordx4 v12, s[28:31], s53 offen nt lds
    buffer_load_dwordx4 v13, s[28:31], s53 offen offset:1024 nt lds
    s_add_u32 m0, s47, 65536
    s_add_u32 s53, s45, 147456
    buffer_load_dwordx4 v14, s[32:35], s53 offen nt lds
    buffer_load_dwordx4 v15, s[32:35], s53 offen offset:1024 nt lds
    s_waitcnt vmcnt(8)
    s_barrier
    s_add_u32 m0, s46, 16384
    s_add_u32 s53, s44, 180224
    buffer_load_dwordx4 v12, s[28:31], s53 offen nt lds
    buffer_load_dwordx4 v13, s[28:31], s53 offen offset:1024 nt lds
    s_add_u32 m0, s46, 81920
    s_add_u32 s53, s44, 163840
    buffer_load_dwordx4 v14, s[32:35], s53 offen nt lds
    buffer_load_dwordx4 v15, s[32:35], s53 offen offset:1024 nt lds
    s_add_u32 m0, s47, 16384
    s_add_u32 s53, s45, 180224
    buffer_load_dwordx4 v12, s[28:31], s53 offen nt lds
    buffer_load_dwordx4 v13, s[28:31], s53 offen offset:1024 nt lds
    s_add_u32 m0, s47, 81920
    s_add_u32 s53, s45, 163840
    buffer_load_dwordx4 v14, s[32:35], s53 offen nt lds
    buffer_load_dwordx4 v15, s[32:35], s53 offen offset:1024 nt lds
    s_waitcnt vmcnt(8)
    s_barrier
    s_add_u32 m0, s46, 32768
    s_add_u32 s53, s44, 196608
    buffer_load_dwordx4 v12, s[28:31], s53 offen nt lds
    buffer_load_dwordx4 v13, s[28:31], s53 offen offset:1024 nt lds
    s_add_u32 m0, s46, 98304
    s_add_u32 s53, s44, 180224
    buffer_load_dwordx4 v14, s[32:35], s53 offen nt lds
    buffer_load_dwordx4 v15, s[32:35], s53 offen offset:1024 nt lds
    s_add_u32 m0, s47, 32768
    s_add_u32 s53, s45, 196608
    buffer_load_dwordx4 v12, s[28:31], s53 offen nt lds
    buffer_load_dwordx4 v13, s[28:31], s53 offen offset:1024 nt lds
    s_add_u32 m0, s47, 98304
    s_add_u32 s53, s45, 180224
    buffer_load_dwordx4 v14, s[32:35], s53 offen nt lds
    buffer_load_dwordx4 v15, s[32:35], s53 offen offset:1024 nt lds
    s_waitcnt vmcnt(8)
    s_barrier
    s_add_u32 m0, s46, 49152
    s_add_u32 s53, s44, 212992
    buffer_load_dwordx4 v12, s[28:31], s53 offen nt lds
    buffer_load_dwordx4 v13, s[28:31], s53 offen offset:1024 nt lds
    s_add_u32 m0, s46, 114688
    s_add_u32 s53, s44, 196608
    buffer_load_dwordx4 v14, s[32:35], s53 offen nt lds
    buffer_load_dwordx4 v15, s[32:35], s53 offen offset:1024 nt lds
    s_add_u32 m0, s47, 49152
    s_add_u32 s53, s45, 212992
    buffer_load_dwordx4 v12, s[28:31], s53 offen nt lds
    buffer_load_dwordx4 v13, s[28:31], s53 offen offset:1024 nt lds
    s_add_u32 m0, s47, 114688
    s_add_u32 s53, s45, 196608
    buffer_load_dwordx4 v14, s[32:35], s53 offen nt lds
    buffer_load_dwordx4 v15, s[32:35], s53 offen offset:1024 nt lds
    s_waitcnt vmcnt(8)
    s_barrier
    s_add_u32 m0, s46, 0
    s_add_u32 s53, s44, 229376
    buffer_load_dwordx4 v12, s[28:31], s53 offen nt lds
    buffer_load_dwordx4 v13, s[28:31], s53 offen offset:1024 nt lds
    s_add_u32 m0, s46, 65536
    s_add_u32 s53, s44, 212992
    buffer_load_dwordx4 v14, s[32:35], s53 offen nt lds
    buffer_load_dwordx4 v15, s[32:35], s53 offen offset:1024 nt lds
    s_add_u32 m0, s47, 0
    s_add_u32 s53, s45, 229376
    buffer_load_dwordx4 v12, s[28:31], s53 offen nt lds
    buffer_load_dwordx4 v13, s[28:31], s53 offen offset:1024 nt lds
    s_add_u32 m0, s47, 65536
    s_add_u32 s53, s45, 212992
    buffer_load_dwordx4 v14, s[32:35], s53 offen nt lds
    buffer_load_dwordx4 v15, s[32:35], s53 offen offset:1024 nt lds
    s_waitcnt vmcnt(8)
    s_barrier
    s_add_u32 m0, s46, 16384
    s_add_u32 s53, s44, 245760
    buffer_load_dwordx4 v12, s[28:31], s53 offen nt lds
    buffer_load_dwordx4 v13, s[28:31], s53 offen offset:1024 nt lds
    s_add_u32 m0, s46, 81920
    s_add_u32 s53, s44, 229376
    buffer_load_dwordx4 v14, s[32:35], s53 offen nt lds
    buffer_load_dwordx4 v15, s[32:35], s53 offen offset:1024 nt lds
    s_add_u32 m0, s47, 16384
    s_add_u32 s53, s45, 245760
    buffer_load_dwordx4 v12, s[28:31], s53 offen nt lds
    buffer_load_dwordx4 v13, s[28:31], s53 offen offset:1024 nt lds
    s_add_u32 m0, s47, 81920
    s_add_u32 s53, s45, 229376
    buffer_load_dwordx4 v14, s[32:35], s53 offen nt lds
    buffer_load_dwordx4 v15, s[32:35], s53 offen offset:1024 nt lds
    s_waitcnt vmcnt(8)
    s_barrier
    s_add_u32 m0, s46, 98304
    s_add_u32 s53, s44, 245760
    buffer_load_dwordx4 v14, s[32:35], s53 offen nt lds
    buffer_load_dwordx4 v15, s[32:35], s53 offen offset:1024 nt lds
    s_add_u32 m0, s47, 98304
    s_add_u32 s53, s45, 245760
    buffer_load_dwordx4 v14, s[32:35], s53 offen nt lds
    buffer_load_dwordx4 v15, s[32:35], s53 offen offset:1024 nt lds
    s_add_u32 m0, s48, 49152
    s_xor_b32 s53, s58, 0
    buffer_load_dwordx4 v16, s[36:39], s53 offen  lds
    buffer_load_dwordx4 v17, s[36:39], s53 offen offset:1024  lds
    s_add_u32 m0, s48, 57344
    s_xor_b32 s53, s58, 65536
    buffer_load_dwordx4 v16, s[36:39], s53 offen  lds
    buffer_load_dwordx4 v17, s[36:39], s53 offen offset:1024  lds
    s_add_u32 m0, s48, 114688
    s_xor_b32 s53, s58, 131072
    buffer_load_dwordx4 v16, s[36:39], s53 offen  lds
    buffer_load_dwordx4 v17, s[36:39], s53 offen offset:1024  lds
    s_add_u32 m0, s48, 122880
    s_xor_b32 s53, s58, 196608
    buffer_load_dwordx4 v16, s[36:39], s53 offen  lds
    buffer_load_dwordx4 v17, s[36:39], s53 offen offset:1024  lds
    s_waitcnt vmcnt(12)
    s_barrier
    s_add_u32 m0, s48, 0
    s_xor_b32 s53, s58, 128
    buffer_load_dwordx4 v16, s[36:39], s53 offen  lds
    buffer_load_dwordx4 v17, s[36:39], s53 offen offset:1024  lds
    s_add_u32 m0, s48, 8192
    s_xor_b32 s53, s58, 65664
    buffer_load_dwordx4 v16, s[36:39], s53 offen  lds
    buffer_load_dwordx4 v17, s[36:39], s53 offen offset:1024  lds
    s_add_u32 m0, s48, 65536
    s_xor_b32 s53, s58, 131200
    buffer_load_dwordx4 v16, s[36:39], s53 offen  lds
    buffer_load_dwordx4 v17, s[36:39], s53 offen offset:1024  lds
    s_add_u32 m0, s48, 73728
    s_xor_b32 s53, s58, 196736
    buffer_load_dwordx4 v16, s[36:39], s53 offen  lds
    buffer_load_dwordx4 v17, s[36:39], s53 offen offset:1024  lds
    s_waitcnt vmcnt(16)
    s_barrier
    s_add_u32 m0, s48, 16384
    s_xor_b32 s53, s58, 256
    buffer_load_dwordx4 v16, s[36:39], s53 offen  lds
    buffer_load_dwordx4 v17, s[36:39], s53 offen offset:1024  lds
    s_add_u32 m0, s48, 24576
    s_xor_b32 s53, s58, 65792
    buffer_load_dwordx4 v16, s[36:39], s53 offen  lds
    buffer_load_dwordx4 v17, s[36:39], s53 offen offset:1024  lds
    s_add_u32 m0, s48, 81920
    s_xor_b32 s53, s58, 131328
    buffer_load_dwordx4 v16, s[36:39], s53 offen  lds
    buffer_load_dwordx4 v17, s[36:39], s53 offen offset:1024  lds
    s_add_u32 m0, s48, 90112
    s_xor_b32 s53, s58, 196864
    buffer_load_dwordx4 v16, s[36:39], s53 offen  lds
    buffer_load_dwordx4 v17, s[36:39], s53 offen offset:1024  lds
    s_add_u32 m0, s48, 32768
    s_xor_b32 s53, s58, 384
    buffer_load_dwordx4 v16, s[36:39], s53 offen  lds
    buffer_load_dwordx4 v17, s[36:39], s53 offen offset:1024  lds
    s_add_u32 m0, s48, 40960
    s_xor_b32 s53, s58, 65920
    buffer_load_dwordx4 v16, s[36:39], s53 offen  lds
    buffer_load_dwordx4 v17, s[36:39], s53 offen offset:1024  lds
    s_waitcnt vmcnt(0)
    s_barrier
    s_barrier
    ds_read_b32 v4, v21
    s_waitcnt lgkmcnt(0)
    v_readfirstlane_b32 s65, v4
    s_nop 0
    s_cmp_eq_u32 s65, -1
    s_cbranch_scc1 L_safe_loader
    s_add_u32 m0, s48, 98304
    s_xor_b32 s53, s58, 131456
    buffer_load_dwordx4 v16, s[36:39], s53 offen  lds
    buffer_load_dwordx4 v17, s[36:39], s53 offen offset:1024  lds
    s_add_u32 m0, s48, 106496
    s_xor_b32 s53, s58, 196992
    buffer_load_dwordx4 v16, s[36:39], s53 offen  lds
    buffer_load_dwordx4 v17, s[36:39], s53 offen offset:1024  lds
    s_barrier
    s_add_u32 m0, s48, 49152
    s_xor_b32 s53, s58, 512
    buffer_load_dwordx4 v16, s[36:39], s53 offen  lds
    buffer_load_dwordx4 v17, s[36:39], s53 offen offset:1024  lds
    s_add_u32 m0, s48, 57344
    s_xor_b32 s53, s58, 66048
    buffer_load_dwordx4 v16, s[36:39], s53 offen  lds
    buffer_load_dwordx4 v17, s[36:39], s53 offen offset:1024  lds
    s_add_u32 m0, s48, 114688
    s_xor_b32 s53, s58, 131584
    buffer_load_dwordx4 v16, s[36:39], s53 offen  lds
    buffer_load_dwordx4 v17, s[36:39], s53 offen offset:1024  lds
    s_add_u32 m0, s48, 122880
    s_xor_b32 s53, s58, 197120
    buffer_load_dwordx4 v16, s[36:39], s53 offen  lds
    buffer_load_dwordx4 v17, s[36:39], s53 offen offset:1024  lds
    s_barrier
    s_add_u32 m0, s48, 0
    s_xor_b32 s53, s58, 640
    buffer_load_dwordx4 v16, s[36:39], s53 offen  lds
    buffer_load_dwordx4 v17, s[36:39], s53 offen offset:1024  lds
    s_add_u32 m0, s48, 8192
    s_xor_b32 s53, s58, 66176
    buffer_load_dwordx4 v16, s[36:39], s53 offen  lds
    buffer_load_dwordx4 v17, s[36:39], s53 offen offset:1024  lds
    s_add_u32 m0, s48, 65536
    s_xor_b32 s53, s58, 131712
    buffer_load_dwordx4 v16, s[36:39], s53 offen  lds
    buffer_load_dwordx4 v17, s[36:39], s53 offen offset:1024  lds
    s_add_u32 m0, s48, 73728
    s_xor_b32 s53, s58, 197248
    buffer_load_dwordx4 v16, s[36:39], s53 offen  lds
    buffer_load_dwordx4 v17, s[36:39], s53 offen offset:1024  lds
    s_waitcnt vmcnt(16)
    s_barrier
    s_add_u32 m0, s48, 16384
    s_xor_b32 s53, s58, 768
    buffer_load_dwordx4 v16, s[36:39], s53 offen  lds
    buffer_load_dwordx4 v17, s[36:39], s53 offen offset:1024  lds
    s_add_u32 m0, s48, 24576
    s_xor_b32 s53, s58, 66304
    buffer_load_dwordx4 v16, s[36:39], s53 offen  lds
    buffer_load_dwordx4 v17, s[36:39], s53 offen offset:1024  lds
    s_add_u32 m0, s48, 81920
    s_xor_b32 s53, s58, 131840
    buffer_load_dwordx4 v16, s[36:39], s53 offen  lds
    buffer_load_dwordx4 v17, s[36:39], s53 offen offset:1024  lds
    s_add_u32 m0, s48, 90112
    s_xor_b32 s53, s58, 197376
    buffer_load_dwordx4 v16, s[36:39], s53 offen  lds
    buffer_load_dwordx4 v17, s[36:39], s53 offen offset:1024  lds
    s_waitcnt vmcnt(16)
    s_barrier
    s_add_u32 m0, s48, 32768
    s_xor_b32 s53, s58, 896
    buffer_load_dwordx4 v16, s[36:39], s53 offen  lds
    buffer_load_dwordx4 v17, s[36:39], s53 offen offset:1024  lds
    s_add_u32 m0, s48, 40960
    s_xor_b32 s53, s58, 66432
    buffer_load_dwordx4 v16, s[36:39], s53 offen  lds
    buffer_load_dwordx4 v17, s[36:39], s53 offen offset:1024  lds
    s_add_u32 m0, s48, 98304
    s_xor_b32 s53, s58, 131968
    buffer_load_dwordx4 v16, s[36:39], s53 offen  lds
    buffer_load_dwordx4 v17, s[36:39], s53 offen offset:1024  lds
    s_add_u32 m0, s48, 106496
    s_xor_b32 s53, s58, 197504
    buffer_load_dwordx4 v16, s[36:39], s53 offen  lds
    buffer_load_dwordx4 v17, s[36:39], s53 offen offset:1024  lds
    s_waitcnt vmcnt(16)
    s_barrier
    s_cmp_lg_u32 s49, 3
    s_cbranch_scc1 L_nopub0
    s_memrealtime s[72:73]
    s_lshl_b32 s65, s63, 3
    v_lshlrev_b32 v2, 9, v0
    s_waitcnt lgkmcnt(0)
    v_mov_b32 v4, s72
    v_mov_b32 v5, s73
    s_mov_b64 exec, 0xffff
    buffer_store_dwordx2 v[4:5], v2, s[92:95], s65 offen offset:0 sc0 sc1
    s_mov_b64 exec, -1
L_nopub0:
    s_waitcnt vmcnt(8)
    s_barrier
    s_waitcnt vmcnt(0)
    s_barrier
    s_cmp_lg_u32 s49, 3
    s_cbranch_scc1 L_nopub1
    s_memrealtime s[72:73]
    s_lshl_b32 s65, s63, 3
    v_lshlrev_b32 v2, 9, v0
    s_waitcnt lgkmcnt(0)
    v_mov_b32 v4, s72
    v_mov_b32 v5, s73
    s_mov_b64 exec, 0xffff
    buffer_store_dwordx2 v[4:5], v2, s[92:95], s65 offen offset:128 sc0 sc1
    s_mov_b64 exec, -1
L_nopub1:
    s_cmp_eq_u32 s49, 3
    s_cbranch_scc1 L_end
    s_lshl_b32 s65, s63, 9
    s_lshl_b32 s66, s49, 7
    s_add_u32 s65, s65, s66
    v_and_b32 v2, 15, v0
    v_lshlrev_b32 v2, 3, v2
    v_mov_b32 v102, s71
    s_mov_b32 s67, 0
L_poll_l:
    buffer_load_dwordx2 v[100:101], v2, s[92:95], s65 offen sc0 sc1
    s_waitcnt vmcnt(0)
    v_subrev_co_u32 v100, vcc, s70, v100
    s_nop 1
    v_subb_co_u32 v101, vcc, v101, v102, vcc
    v_lshrrev_b32 v100, 24, v100
    v_or_b32 v100, v100, v101
    v_cmp_ne_u32 vcc, 0, v100
    s_nop 4
    s_cbranch_vccz L_poll_l_done
    s_add_u32 s67, s67, 1
    s_cmp_lt_u32 s67, 0x40000
    s_cbranch_scc1 L_poll_l
L_poll_l_done:
    s_lshl_b32 s66, s49, 18
    s_lshl_b32 s67, s63, 14
    s_add_u32 s66, s66, s67
    buffer_load_dwordx4 v[32:35], v20, s[88:91], s66 offen offset:0 sc1
    buffer_load_dwordx4 v[36:39], v20, s[88:91], s66 offen offset:1024 sc1
    buffer_load_dwordx4 v[40:43], v20, s[88:91], s66 offen offset:2048 sc1
    buffer_load_dwordx4 v[44:47], v20, s[88:91], s66 offen offset:3072 sc1
    s_add_u32 s66, s66, 4096
    buffer_load_dwordx4 v[48:51], v20, s[88:91], s66 offen offset:0 sc1
    buffer_load_dwordx4 v[52:55], v20, s[88:91], s66 offen offset:1024 sc1
    buffer_load_dwordx4 v[56:59], v20, s[88:91], s66 offen offset:2048 sc1
    buffer_load_dwordx4 v[60:63], v20, s[88:91], s66 offen offset:3072 sc1
    s_add_u32 s66, s66, 4096
    buffer_load_dwordx4 v[64:67], v20, s[88:91], s66 offen offset:0 sc1
    buffer_load_dwordx4 v[68:71], v20, s[88:91], s66 offen offset:1024 sc1
    buffer_load_dwordx4 v[72:75], v20, s[88:91], s66 offen offset:2048 sc1
    buffer_load_dwordx4 v[76:79], v20, s[88:91], s66 offen offset:3072 sc1
    s_add_u32 s66, s66, 4096
    buffer_load_dwordx4 v[80:83], v20, s[88:91], s66 offen offset:0 sc1
    buffer_load_dwordx4 v[84:87], v20, s[88:91], s66 offen offset:1024 sc1
    buffer_load_dwordx4 v[88:91], v20, s[88:91], s66 offen offset:2048 sc1
    buffer_load_dwordx4 v[92:95], v20, s[88:91], s66 offen offset:3072 sc1
    v_and_b32 v2, 15, v0
    v_lshlrev_b32 v2, 10, v2
    v_bfe_u32 v3, v0, 4, 1
    v_lshl_add_u32 v2, v3, 5, v2
    v_bfe_u32 v3, v0, 5, 1
    v_lshl_add_u32 v2, v3, 4, v2
    s_lshl_b32 s67, s49, 1
    s_lshr_b32 s52, s63, 3
    s_add_u32 s67, s67, s52
    s_and_b32 s52, s61, 7
    s_xor_b32 s67, s67, s52
    s_lshl_b32 s67, s67, 7
    s_bfe_u32 s52, s63, 0x10002
    s_lshl_b32 s52, s52, 6
    s_add_u32 s67, s67, s52
    s_and_b32 s52, s63, 3
    s_lshl_b32 s52, s52, 14
    s_add_u32 s67, s67, s52
    s_mov_b32 s66, 0xffff0000
    s_waitcnt vmcnt(15)
    v_lshlrev_b32 v8, 16, v32
    v_and_b32 v9, s66, v32
    v_lshlrev_b32 v10, 16, v33
    v_and_b32 v11, s66, v33
    v_lshlrev_b32 v12, 16, v34
    v_and_b32 v13, s66, v34
    v_lshlrev_b32 v14, 16, v35
    v_and_b32 v15, s66, v35
    s_waitcnt vmcnt(14)
    v_lshlrev_b32 v16, 16, v36
    v_and_b32 v17, s66, v36
    v_add_f32 v8, v8, v16
    v_add_f32 v9, v9, v17
    v_lshlrev_b32 v16, 16, v37
    v_and_b32 v17, s66, v37
    v_add_f32 v10, v10, v16
    v_add_f32 v11, v11, v17
    v_lshlrev_b32 v16, 16, v38
    v_and_b32 v17, s66, v38
    v_add_f32 v12, v12, v16
    v_add_f32 v13, v13, v17
    v_lshlrev_b32 v16, 16, v39
    v_and_b32 v17, s66, v39
    v_add_f32 v14, v14, v16
    v_add_f32 v15, v15, v17
    s_waitcnt vmcnt(13)
    v_lshlrev_b32 v16, 16, v40
    v_and_b32 v17, s66, v40
    v_add_f32 v8, v8, v16
    v_add_f32 v9, v9, v17
    v_lshlrev_b32 v16, 16, v41
    v_and_b32 v17, s66, v41
    v_add_f32 v10, v10, v16
    v_add_f32 v11, v11, v17
    v_lshlrev_b32 v16, 16, v42
    v_and_b32 v17, s66, v42
    v_add_f32 v12, v12, v16
    v_add_f32 v13, v13, v17
    v_lshlrev_b32 v16, 16, v43
    v_and_b32 v17, s66, v43
    v_add_f32 v14, v14, v16
    v_add_f32 v15, v15, v17
    s_waitcnt vmcnt(12)
    v_lshlrev_b32 v16, 16, v44
    v_and_b32 v17, s66, v44
    v_add_f32 v8, v8, v16
    v_add_f32 v9, v9, v17
    v_lshlrev_b32 v16, 16, v45
    v_and_b32 v17, s66, v45
    v_add_f32 v10, v10, v16
    v_add_f32 v11, v11, v17
    v_lshlrev_b32 v16, 16, v46
    v_and_b32 v17, s66, v46
    v_add_f32 v12, v12, v16
    v_add_f32 v13, v13, v17
    v_lshlrev_b32 v16, 16, v47
    v_and_b32 v17, s66, v47
    v_add_f32 v14, v14, v16
    v_add_f32 v15, v15, v17
    s_waitcnt vmcnt(11)
    v_lshlrev_b32 v16, 16, v48
    v_and_b32 v17, s66, v48
    v_add_f32 v8, v8, v16
    v_add_f32 v9, v9, v17
    v_lshlrev_b32 v16, 16, v49
    v_and_b32 v17, s66, v49
    v_add_f32 v10, v10, v16
    v_add_f32 v11, v11, v17
    v_lshlrev_b32 v16, 16, v50
    v_and_b32 v17, s66, v50
    v_add_f32 v12, v12, v16
    v_add_f32 v13, v13, v17
    v_lshlrev_b32 v16, 16, v51
    v_and_b32 v17, s66, v51
    v_add_f32 v14, v14, v16
    v_add_f32 v15, v15, v17
    s_waitcnt vmcnt(10)
    v_lshlrev_b32 v16, 16, v52
    v_and_b32 v17, s66, v52
    v_add_f32 v8, v8, v16
    v_add_f32 v9, v9, v17
    v_lshlrev_b32 v16, 16, v53
    v_and_b32 v17, s66, v53
    v_add_f32 v10, v10, v16
    v_add_f32 v11, v11, v17
    v_lshlrev_b32 v16, 16, v54
    v_and_b32 v17, s66, v54
    v_add_f32 v12, v12, v16
    v_add_f32 v13, v13, v17
    v_lshlrev_b32 v16, 16, v55
    v_and_b32 v17, s66, v55
    v_add_f32 v14, v14, v16
    v_add_f32 v15, v15, v17
    s_waitcnt vmcnt(9)
    v_lshlrev_b32 v16, 16, v56
    v_and_b32 v17, s66, v56
    v_add_f32 v8, v8, v16
    v_add_f32 v9, v9, v17
    v_lshlrev_b32 v16, 16, v57
    v_and_b32 v17, s66, v57
    v_add_f32 v10, v10, v16
    v_add_f32 v11, v11, v17
    v_lshlrev_b32 v16, 16, v58
    v_and_b32 v17, s66, v58
    v_add_f32 v12, v12, v16
    v_add_f32 v13, v13, v17
    v_lshlrev_b32 v16, 16, v59
    v_and_b32 v17, s66, v59
    v_add_f32 v14, v14, v16
    v_add_f32 v15, v15, v17
    s_waitcnt vmcnt(8)
    v_lshlrev_b32 v16, 16, v60
    v_and_b32 v17, s66, v60
    v_add_f32 v8, v8, v16
    v_add_f32 v9, v9, v17
    v_lshlrev_b32 v16, 16, v61
    v_and_b32 v17, s66, v61
    v_add_f32 v10, v10, v16
    v_add_f32 v11, v11, v17
    v_lshlrev_b32 v16, 16, v62
    v_and_b32 v17, s66, v62
    v_add_f32 v12, v12, v16
    v_add_f32 v13, v13, v17
    v_lshlrev_b32 v16, 16, v63
    v_and_b32 v17, s66, v63
    v_add_f32 v14, v14, v16
    v_add_f32 v15, v15, v17
    s_waitcnt vmcnt(7)
    v_lshlrev_b32 v16, 16, v64
    v_and_b32 v17, s66, v64
    v_add_f32 v8, v8, v16
    v_add_f32 v9, v9, v17
    v_lshlrev_b32 v16, 16, v65
    v_and_b32 v17, s66, v65
    v_add_f32 v10, v10, v16
    v_add_f32 v11, v11, v17
    v_lshlrev_b32 v16, 16, v66
    v_and_b32 v17, s66, v66
    v_add_f32 v12, v12, v16
    v_add_f32 v13, v13, v17
    v_lshlrev_b32 v16, 16, v67
    v_and_b32 v17, s66, v67
    v_add_f32 v14, v14, v16
    v_add_f32 v15, v15, v17
    s_waitcnt vmcnt(6)
    v_lshlrev_b32 v16, 16, v68
    v_and_b32 v17, s66, v68
    v_add_f32 v8, v8, v16
    v_add_f32 v9, v9, v17
    v_lshlrev_b32 v16, 16, v69
    v_and_b32 v17, s66, v69
    v_add_f32 v10, v10, v16
    v_add_f32 v11, v11, v17
    v_lshlrev_b32 v16, 16, v70
    v_and_b32 v17, s66, v70
    v_add_f32 v12, v12, v16
    v_add_f32 v13, v13, v17
    v_lshlrev_b32 v16, 16, v71
    v_and_b32 v17, s66, v71
    v_add_f32 v14, v14, v16
    v_add_f32 v15, v15, v17
    s_waitcnt vmcnt(5)
    v_lshlrev_b32 v16, 16, v72
    v_and_b32 v17, s66, v72
    v_add_f32 v8, v8, v16
    v_add_f32 v9, v9, v17
    v_lshlrev_b32 v16, 16, v73
    v_and_b32 v17, s66, v73
    v_add_f32 v10, v10, v16
    v_add_f32 v11, v11, v17
    v_lshlrev_b32 v16, 16, v74
    v_and_b32 v17, s66, v74
    v_add_f32 v12, v12, v16
    v_add_f32 v13, v13, v17
    v_lshlrev_b32 v16, 16, v75
    v_and_b32 v17, s66, v75
    v_add_f32 v14, v14, v16
    v_add_f32 v15, v15, v17
    s_waitcnt vmcnt(4)
    v_lshlrev_b32 v16, 16, v76
    v_and_b32 v17, s66, v76
    v_add_f32 v8, v8, v16
    v_add_f32 v9, v9, v17
    v_lshlrev_b32 v16, 16, v77
    v_and_b32 v17, s66, v77
    v_add_f32 v10, v10, v16
    v_add_f32 v11, v11, v17
    v_lshlrev_b32 v16, 16, v78
    v_and_b32 v17, s66, v78
    v_add_f32 v12, v12, v16
    v_add_f32 v13, v13, v17
    v_lshlrev_b32 v16, 16, v79
    v_and_b32 v17, s66, v79
    v_add_f32 v14, v14, v16
    v_add_f32 v15, v15, v17
    s_waitcnt vmcnt(3)
    v_lshlrev_b32 v16, 16, v80
    v_and_b32 v17, s66, v80
    v_add_f32 v8, v8, v16
    v_add_f32 v9, v9, v17
    v_lshlrev_b32 v16, 16, v81
    v_and_b32 v17, s66, v81
    v_add_f32 v10, v10, v16
    v_add_f32 v11, v11, v17
    v_lshlrev_b32 v16, 16, v82
    v_and_b32 v17, s66, v82
    v_add_f32 v12, v12, v16
    v_add_f32 v13, v13, v17
    v_lshlrev_b32 v16, 16, v83
    v_and_b32 v17, s66, v83
    v_add_f32 v14, v14, v16
    v_add_f32 v15, v15, v17
    s_waitcnt vmcnt(2)
    v_lshlrev_b32 v16, 16, v84
    v_and_b32 v17, s66, v84
    v_add_f32 v8, v8, v16
    v_add_f32 v9, v9, v17
    v_lshlrev_b32 v16, 16, v85
    v_and_b32 v17, s66, v85
    v_add_f32 v10, v10, v16
    v_add_f32 v11, v11, v17
    v_lshlrev_b32 v16, 16, v86
    v_and_b32 v17, s66, v86
    v_add_f32 v12, v12, v16
    v_add_f32 v13, v13, v17
    v_lshlrev_b32 v16, 16, v87
    v_and_b32 v17, s66, v87
    v_add_f32 v14, v14, v16
    v_add_f32 v15, v15, v17
    s_waitcnt vmcnt(1)
    v_lshlrev_b32 v16, 16, v88
    v_and_b32 v17, s66, v88
    v_add_f32 v8, v8, v16
    v_add_f32 v9, v9, v17
    v_lshlrev_b32 v16, 16, v89
    v_and_b32 v17, s66, v89
    v_add_f32 v10, v10, v16
    v_add_f32 v11, v11, v17
    v_lshlrev_b32 v16, 16, v90
    v_and_b32 v17, s66, v90
    v_add_f32 v12, v12, v16
    v_add_f32 v13, v13, v17
    v_lshlrev_b32 v16, 16, v91
    v_and_b32 v17, s66, v91
    v_add_f32 v14, v14, v16
    v_add_f32 v15, v15, v17
    s_waitcnt vmcnt(0)
    v_lshlrev_b32 v16, 16, v92
    v_and_b32 v17, s66, v92
    v_add_f32 v8, v8, v16
    v_add_f32 v9, v9, v17
    v_lshlrev_b32 v16, 16, v93
    v_and_b32 v17, s66, v93
    v_add_f32 v10, v10, v16
    v_add_f32 v11, v11, v17
    v_lshlrev_b32 v16, 16, v94
    v_and_b32 v17, s66, v94
    v_add_f32 v12, v12, v16
    v_add_f32 v13, v13, v17
    v_lshlrev_b32 v16, 16, v95
    v_and_b32 v17, s66, v95
    v_add_f32 v14, v14, v16
    v_add_f32 v15, v15, v17
    v_cvt_pk_bf16_f32 v16, v8, v9
    v_cvt_pk_bf16_f32 v17, v10, v11
    v_cvt_pk_bf16_f32 v18, v12, v13
    v_cvt_pk_bf16_f32 v19, v14, v15
    s_nop 0
    v_permlane16_swap_b32 v16, v18
    v_permlane16_swap_b32 v17, v19
    buffer_store_dwordx4 v[16:19], v2, s[84:87], s67 offen
L_end:
    s_endpgm
L_safe_loader:
    s_waitcnt vmcnt(0)
    s_barrier
    s_mov_b32 s67, 0
L_safe_l_loop:
    s_add_u32 m0, s46, 0
    s_add_u32 s53, s44, s67
    buffer_load_dwordx4 v12, s[28:31], s53 offen nt lds
    buffer_load_dwordx4 v13, s[28:31], s53 offen offset:1024 nt lds
    s_add_u32 m0, s47, 0
    s_add_u32 s53, s45, s67
    buffer_load_dwordx4 v12, s[28:31], s53 offen nt lds
    buffer_load_dwordx4 v13, s[28:31], s53 offen offset:1024 nt lds
    s_waitcnt vmcnt(0)
    s_barrier
    s_add_u32 s67, s67, 16384
    s_barrier
    s_cmp_lt_u32 s67, 262144
    s_cbranch_scc1 L_safe_l_loop
    s_add_u32 m0, s46, 32768
    s_add_u32 s53, s44, 0
    buffer_load_dwordx4 v12, s[28:31], s53 offen nt lds
    buffer_load_dwordx4 v13, s[28:31], s53 offen offset:1024 nt lds
    s_add_u32 m0, s47, 32768
    s_add_u32 s53, s45, 0
    buffer_load_dwordx4 v12, s[28:31], s53 offen nt lds
    buffer_load_dwordx4 v13, s[28:31], s53 offen offset:1024 nt lds
    s_add_u32 m0, s46, 49152
    s_add_u32 s53, s44, 16384
    buffer_load_dwordx4 v12, s[28:31], s53 offen nt lds
    buffer_load_dwordx4 v13, s[28:31], s53 offen offset:1024 nt lds
    s_add_u32 m0, s47, 49152
    s_add_u32 s53, s45, 16384
    buffer_load_dwordx4 v12, s[28:31], s53 offen nt lds
    buffer_load_dwordx4 v13, s[28:31], s53 offen offset:1024 nt lds
    s_add_u32 m0, s46, 114688
    s_add_u32 s53, s44, 0
    buffer_load_dwordx4 v14, s[32:35], s53 offen nt lds
    buffer_load_dwordx4 v15, s[32:35], s53 offen offset:1024 nt lds
    s_add_u32 m0, s47, 114688
    s_add_u32 s53, s45, 0
    buffer_load_dwordx4 v14, s[32:35], s53 offen nt lds
    buffer_load_dwordx4 v15, s[32:35], s53 offen offset:1024 nt lds
    s_add_u32 m0, s46, 0
    s_add_u32 s53, s44, 32768
    buffer_load_dwordx4 v12, s[28:31], s53 offen nt lds
    buffer_load_dwordx4 v13, s[28:31], s53 offen offset:1024 nt lds
    s_add_u32 m0, s47, 0
    s_add_u32 s53, s45, 32768
    buffer_load_dwordx4 v12, s[28:31], s53 offen nt lds
    buffer_load_dwordx4 v13, s[28:31], s53 offen offset:1024 nt lds
    s_add_u32 m0, s46, 65536
    s_add_u32 s53, s44, 16384
    buffer_load_dwordx4 v14, s[32:35], s53 offen nt lds
    buffer_load_dwordx4 v15, s[32:35], s53 offen offset:1024 nt lds
    s_add_u32 m0, s47, 65536
    s_add_u32 s53, s45, 16384
    buffer_load_dwordx4 v14, s[32:35], s53 offen nt lds
    buffer_load_dwordx4 v15, s[32:35], s53 offen offset:1024 nt lds
    s_waitcnt vmcnt(0)
    s_barrier
    s_branch L_re_loader
L_compute:
    s_getpc_b64 s[98:99]
L_pc:
    s_sub_u32 s98, s98, L_pc-standalone__gqa_block_cached__near_ridge_kernel
    s_subb_u32 s99, s99, 0
    s_bfe_u32 s65, s2, 0x40003
    s_lshl_b32 s65, s65, 2
    s_add_u32 s65, s65, s3
    s_lshl_b32 s65, s65, 10
    v_lshrrev_b32 v1, 3, v0
    v_lshl_add_u32 v1, v1, 7, s65
    v_min_u32 v1, L_code_end-standalone__gqa_block_cached__near_ridge_kernel-4, v1
    global_load_dword v36, v1, s[98:99]
    s_setprio 1
    s_mov_b32 s78, 1
    s_and_b32 s50, s3, 1
    s_lshr_b32 s51, s3, 1
    v_and_b32 v3, 15, v0
    v_lshrrev_b32 v4, 4, v0
    v_xor_b32 v1, v4, v3
    v_lshlrev_b32 v1, 4, v1
    v_lshl_add_u32 v1, v3, 8, v1
    s_lshl_b32 s65, s50, 13
    s_lshl_b32 s66, s68, 6
    s_or_b32 s65, s65, s66
    v_xor_b32 v12, s65, v1
    v_xor_b32 v13, 64, v12
    v_xor_b32 v14, 128, v12
    v_xor_b32 v15, 192, v12
    v_bfe_u32 v5, v0, 4, 1
    v_lshrrev_b32 v6, 5, v0
    v_lshl_or_b32 v1, v5, 1, v6
    v_xor_b32 v1, v1, v3
    v_lshlrev_b32 v1, 4, v1
    v_lshl_add_u32 v8, v3, 8, v1
    v_xor_b32 v9, 64, v8
    v_xor_b32 v10, 128, v8
    v_xor_b32 v11, 192, v8
    v_bfe_u32 v1, v0, 2, 2
    v_and_b32 v2, 1, v0
    v_bfe_u32 v3, v0, 1, 1
    v_lshl_or_b32 v5, v5, 2, v1
    v_lshl_or_b32 v7, v5, 1, v3
    v_lshlrev_b32 v7, 4, v7
    v_lshl_or_b32 v7, v2, 3, v7
    v_lshl_add_u32 v6, v4, 3, v1
    v_lshl_add_u32 v6, v6, 9, v7
    s_lshl_b32 s65, s51, 8
    v_add_u32 v16, s65, v6
    v_xor_b32 v17, 32, v16
    v_xor_b32 v18, 64, v16
    v_xor_b32 v19, 96, v16
    v_xor_b32 v20, 128, v16
    v_xor_b32 v21, 160, v16
    v_xor_b32 v22, 192, v16
    v_xor_b32 v23, 224, v16
    v_add_u32 v24, 65536, v16
    v_add_u32 v25, 65536, v17
    v_add_u32 v26, 65536, v18
    v_add_u32 v27, 65536, v19
    v_add_u32 v28, 65536, v20
    v_add_u32 v29, 65536, v21
    v_add_u32 v30, 65536, v22
    v_add_u32 v31, 65536, v23
    v_lshl_add_u32 v6, v4, 2, v1
    v_lshl_add_u32 v42, v6, 8, v7
    v_add_u32 v42, 65536, v42
    v_and_b32 v7, 6, v5
    v_or_b32 v7, v7, v3
    v_lshlrev_b32 v7, 4, v7
    v_lshl_or_b32 v7, v2, 3, v7
    v_lshl_add_u32 v7, v6, 7, v7
    s_lshr_b32 s65, s61, 3
    s_xor_b32 s65, s65, s51
    s_lshl_b32 s65, s65, 16
    s_lshl_b32 s66, s51, 6
    s_or_b32 s65, s65, s66
    v_xor_b32 v43, s65, v7
    s_lshl_b32 s65, s3, 15
    v_lshl_add_u32 v32, v0, 4, s65
    s_lshl_b32 s65, s3, 13
    s_add_u32 s65, s65, 131072
    v_lshl_add_u32 v33, v0, 4, s65
    v_xor_b32 v34, 16384, v33
    v_and_b32 v1, 3, v0
    v_lshlrev_b32 v1, 13, v1
    s_lshl_b32 s65, s3, 2
    s_add_u32 s65, s65, 138240
    v_add_u32 v35, s65, v1
    v_mov_b32 v44, 0x3f803f80
    v_mov_b32 v45, 0x3f803f80
    v_mov_b32 v46, 0x3f803f80
    v_mov_b32 v47, 0x3f803f80
    v_mov_b32 v38, 0xff800000
    v_mov_b32 v39, 0xff800000
    s_mov_b32 s96, 0x3e0293ee
    s_mov_b32 s97, 0x3e0293ee
    s_mov_b32 s79, 0x5d800000
    s_waitcnt lgkmcnt(0)
    s_lshl_b32 s66, s61, 20
    s_lshl_b32 s67, s63, 10
    s_add_u32 s66, s66, s67
    s_add_u32 s40, s18, s66
    s_addc_u32 s41, s19, 0
    s_mov_b32 s42, 1033216
    s_mov_b32 s43, 0x20000
    s_lshl_b32 s66, s61, 20
    s_add_u32 s88, s18, s66
    s_addc_u32 s89, s19, 0
    s_mov_b32 s90, 1048576
    s_mov_b32 s91, 0x20000
    s_lshl_b32 s66, s61, 16
    s_add_u32 s84, s14, s66
    s_addc_u32 s85, s15, 0
    s_mov_b32 s86, 65536
    s_mov_b32 s87, 0x20000
    s_lshl_b32 s66, s61, 13
    s_add_u32 s66, s66, 0x1000000
    s_add_u32 s92, s18, s66
    s_addc_u32 s93, s19, 0
    s_mov_b32 s94, 8192
    s_mov_b32 s95, 0x20000
    s_barrier
    ds_read_b128 v[48:51], v12 offset:0
    ds_read_b128 v[52:55], v12 offset:4096
    ds_read_b64_tr_b16 a[0:1], v24 offset:0
    ds_read_b64_tr_b16 a[2:3], v24 offset:2048
    ds_read_b64_tr_b16 a[4:5], v25 offset:0
    ds_read_b64_tr_b16 a[6:7], v25 offset:2048
    ds_read_b128 v[56:59], v13 offset:0
    ds_read_b64_tr_b16 a[8:9], v26 offset:0
    ds_read_b64_tr_b16 a[10:11], v26 offset:2048
    ds_read_b128 v[60:63], v13 offset:4096
    ds_read_b64_tr_b16 a[12:13], v27 offset:0
    ds_read_b64_tr_b16 a[14:15], v27 offset:2048
    ds_read_b128 v[64:67], v14 offset:0
    ds_read_b64_tr_b16 a[16:17], v28 offset:0
    ds_read_b64_tr_b16 a[18:19], v28 offset:2048
    s_waitcnt lgkmcnt(11)
    v_mfma_f32_16x16x32_bf16 v[112:115], a[0:3], v[48:51], 0
    v_mfma_f32_16x16x32_bf16 v[116:119], a[0:3], v[52:55], 0
    ds_read_b128 v[68:71], v14 offset:4096
    ds_read_b64_tr_b16 a[20:21], v29 offset:0
    ds_read_b64_tr_b16 a[22:23], v29 offset:2048
    ds_read_b128 v[72:75], v15 offset:0
    ds_read_b64_tr_b16 a[24:25], v30 offset:0
    ds_read_b64_tr_b16 a[26:27], v30 offset:2048
    s_waitcnt lgkmcnt(15)
    v_mfma_f32_16x16x32_bf16 v[120:123], a[4:7], v[48:51], 0
    v_mfma_f32_16x16x32_bf16 v[124:127], a[4:7], v[52:55], 0
    ds_read_b128 v[76:79], v15 offset:4096
    ds_read_b64_tr_b16 a[28:29], v31 offset:0
    ds_read_b64_tr_b16 a[30:31], v31 offset:2048
    s_waitcnt lgkmcnt(12)
    v_mfma_f32_16x16x32_bf16 v[128:131], a[8:11], v[48:51], 0
    s_waitcnt lgkmcnt(0)
    v_mfma_f32_16x16x32_bf16 v[132:135], a[8:11], v[52:55], 0
    s_barrier
    v_mfma_f32_16x16x32_bf16 v[136:139], a[12:15], v[48:51], 0
    ds_read_b64_tr_b16 a[32:33], v16 offset:16384
    ds_read_b64_tr_b16 a[34:35], v16 offset:18432
    v_mfma_f32_16x16x32_bf16 v[140:143], a[12:15], v[52:55], 0
    ds_read_b64_tr_b16 a[36:37], v17 offset:16384
    ds_read_b64_tr_b16 a[38:39], v17 offset:18432
    ds_read_b64_tr_b16 a[40:41], v18 offset:16384
    ds_read_b64_tr_b16 a[42:43], v18 offset:18432
    v_mfma_f32_16x16x32_bf16 v[144:147], a[16:19], v[48:51], 0
    v_mfma_f32_16x16x32_bf16 v[148:151], a[16:19], v[52:55], 0
    ds_read_b64_tr_b16 a[44:45], v19 offset:16384
    ds_read_b64_tr_b16 a[46:47], v19 offset:18432
    ds_read_b64_tr_b16 a[0:1], v20 offset:16384
    ds_read_b64_tr_b16 a[2:3], v20 offset:18432
    v_mfma_f32_16x16x32_bf16 v[152:155], a[20:23], v[48:51], 0
    v_mfma_f32_16x16x32_bf16 v[156:159], a[20:23], v[52:55], 0
    ds_read_b64_tr_b16 a[4:5], v21 offset:16384
    ds_read_b64_tr_b16 a[6:7], v21 offset:18432
    v_mfma_f32_16x16x32_bf16 v[160:163], a[24:27], v[48:51], 0
    v_mfma_f32_16x16x32_bf16 v[164:167], a[24:27], v[52:55], 0
    ds_read_b64_tr_b16 a[8:9], v22 offset:16384
    ds_read_b64_tr_b16 a[10:11], v22 offset:18432
    v_mfma_f32_16x16x32_bf16 v[168:171], a[28:31], v[48:51], 0
    v_mfma_f32_16x16x32_bf16 v[172:175], a[28:31], v[52:55], 0
    ds_read_b64_tr_b16 a[12:13], v23 offset:16384
    ds_read_b64_tr_b16 a[14:15], v23 offset:18432
    s_waitcnt lgkmcnt(8)
    v_mfma_f32_16x16x32_bf16 v[112:115], a[32:35], v[56:59], v[112:115]
    v_mfma_f32_16x16x32_bf16 v[116:119], a[32:35], v[60:63], v[116:119]
    ds_read_b64_tr_b16 a[16:17], v24 offset:16384
    ds_read_b64_tr_b16 a[18:19], v24 offset:18432
    v_mfma_f32_16x16x32_bf16 v[120:123], a[36:39], v[56:59], v[120:123]
    v_mfma_f32_16x16x32_bf16 v[124:127], a[36:39], v[60:63], v[124:127]
    ds_read_b64_tr_b16 a[20:21], v25 offset:16384
    ds_read_b64_tr_b16 a[22:23], v25 offset:18432
    v_mfma_f32_16x16x32_bf16 v[128:131], a[40:43], v[56:59], v[128:131]
    v_mfma_f32_16x16x32_bf16 v[132:135], a[40:43], v[60:63], v[132:135]
    ds_read_b64_tr_b16 a[24:25], v26 offset:16384
    ds_read_b64_tr_b16 a[26:27], v26 offset:18432
    v_mfma_f32_16x16x32_bf16 v[136:139], a[44:47], v[56:59], v[136:139]
    v_mfma_f32_16x16x32_bf16 v[140:143], a[44:47], v[60:63], v[140:143]
    ds_read_b64_tr_b16 a[28:29], v27 offset:16384
    ds_read_b64_tr_b16 a[30:31], v27 offset:18432
    s_waitcnt lgkmcnt(8)
    v_mfma_f32_16x16x32_bf16 v[144:147], a[0:3], v[56:59], v[144:147]
    v_mfma_f32_16x16x32_bf16 v[148:151], a[0:3], v[60:63], v[148:151]
    ds_read_b64_tr_b16 a[32:33], v28 offset:16384
    ds_read_b64_tr_b16 a[34:35], v28 offset:18432
    v_mfma_f32_16x16x32_bf16 v[152:155], a[4:7], v[56:59], v[152:155]
    v_mfma_f32_16x16x32_bf16 v[156:159], a[4:7], v[60:63], v[156:159]
    ds_read_b64_tr_b16 a[36:37], v29 offset:16384
    ds_read_b64_tr_b16 a[38:39], v29 offset:18432
    v_mfma_f32_16x16x32_bf16 v[160:163], a[8:11], v[56:59], v[160:163]
    v_mfma_f32_16x16x32_bf16 v[164:167], a[8:11], v[60:63], v[164:167]
    ds_read_b64_tr_b16 a[40:41], v30 offset:16384
    ds_read_b64_tr_b16 a[42:43], v30 offset:18432
    v_mfma_f32_16x16x32_bf16 v[168:171], a[12:15], v[56:59], v[168:171]
    v_mfma_f32_16x16x32_bf16 v[172:175], a[12:15], v[60:63], v[172:175]
    ds_read_b64_tr_b16 a[44:45], v31 offset:16384
    ds_read_b64_tr_b16 a[46:47], v31 offset:18432
    s_waitcnt lgkmcnt(8)
    v_mfma_f32_16x16x32_bf16 v[112:115], a[16:19], v[64:67], v[112:115]
    v_mfma_f32_16x16x32_bf16 v[116:119], a[16:19], v[68:71], v[116:119]
    v_mfma_f32_16x16x32_bf16 v[120:123], a[20:23], v[64:67], v[120:123]
    v_mfma_f32_16x16x32_bf16 v[124:127], a[20:23], v[68:71], v[124:127]
    v_mfma_f32_16x16x32_bf16 v[128:131], a[24:27], v[64:67], v[128:131]
    s_waitcnt lgkmcnt(0)
    v_mfma_f32_16x16x32_bf16 v[132:135], a[24:27], v[68:71], v[132:135]
    s_barrier
    v_mfma_f32_16x16x32_bf16 v[136:139], a[28:31], v[64:67], v[136:139]
    ds_read_b128 v[80:83], v12 offset:32768
    ds_read_b64_tr_b16 a[0:1], v24 offset:32768
    ds_read_b64_tr_b16 a[2:3], v24 offset:34816
    v_mfma_f32_16x16x32_bf16 v[140:143], a[28:31], v[68:71], v[140:143]
    ds_read_b128 v[84:87], v12 offset:36864
    ds_read_b64_tr_b16 a[4:5], v25 offset:32768
    ds_read_b64_tr_b16 a[6:7], v25 offset:34816
    ds_read_b128 v[88:91], v13 offset:32768
    ds_read_b64_tr_b16 a[8:9], v26 offset:32768
    ds_read_b64_tr_b16 a[10:11], v26 offset:34816
    v_mfma_f32_16x16x32_bf16 v[144:147], a[32:35], v[64:67], v[144:147]
    v_mfma_f32_16x16x32_bf16 v[148:151], a[32:35], v[68:71], v[148:151]
    ds_read_b128 v[92:95], v13 offset:36864
    ds_read_b64_tr_b16 a[12:13], v27 offset:32768
    ds_read_b64_tr_b16 a[14:15], v27 offset:34816
    ds_read_b128 v[96:99], v14 offset:32768
    ds_read_b64_tr_b16 a[16:17], v28 offset:32768
    ds_read_b64_tr_b16 a[18:19], v28 offset:34816
    v_mfma_f32_16x16x32_bf16 v[152:155], a[36:39], v[64:67], v[152:155]
    v_mfma_f32_16x16x32_bf16 v[156:159], a[36:39], v[68:71], v[156:159]
    ds_read_b128 v[100:103], v14 offset:36864
    ds_read_b64_tr_b16 a[20:21], v29 offset:32768
    ds_read_b64_tr_b16 a[22:23], v29 offset:34816
    v_mfma_f32_16x16x32_bf16 v[160:163], a[40:43], v[64:67], v[160:163]
    v_mfma_f32_16x16x32_bf16 v[164:167], a[40:43], v[68:71], v[164:167]
    ds_read_b128 v[104:107], v15 offset:32768
    ds_read_b64_tr_b16 a[24:25], v30 offset:32768
    ds_read_b64_tr_b16 a[26:27], v30 offset:34816
    v_mfma_f32_16x16x32_bf16 v[168:171], a[44:47], v[64:67], v[168:171]
    v_mfma_f32_16x16x32_bf16 v[172:175], a[44:47], v[68:71], v[172:175]
    ds_read_b128 v[108:111], v15 offset:36864
    ds_read_b64_tr_b16 a[28:29], v31 offset:32768
    ds_read_b64_tr_b16 a[30:31], v31 offset:34816
    s_waitcnt lgkmcnt(12)
    v_mfma_f32_16x16x32_bf16 v[112:115], a[0:3], v[72:75], v[112:115]
    v_mfma_f32_16x16x32_bf16 v[116:119], a[0:3], v[76:79], v[116:119]
    v_mfma_f32_16x16x32_bf16 v[120:123], a[4:7], v[72:75], v[120:123]
    v_mfma_f32_16x16x32_bf16 v[124:127], a[4:7], v[76:79], v[124:127]
    v_mfma_f32_16x16x32_bf16 v[128:131], a[8:11], v[72:75], v[128:131]
    s_waitcnt lgkmcnt(0)
    v_mfma_f32_16x16x32_bf16 v[132:135], a[8:11], v[76:79], v[132:135]
    s_barrier
    v_mfma_f32_16x16x32_bf16 v[136:139], a[12:15], v[72:75], v[136:139]
    ds_read_b64_tr_b16 a[32:33], v16 offset:49152
    ds_read_b64_tr_b16 a[34:35], v16 offset:51200
    v_mfma_f32_16x16x32_bf16 v[140:143], a[12:15], v[76:79], v[140:143]
    ds_read_b64_tr_b16 a[36:37], v17 offset:49152
    ds_read_b64_tr_b16 a[38:39], v17 offset:51200
    ds_read_b64_tr_b16 a[40:41], v18 offset:49152
    ds_read_b64_tr_b16 a[42:43], v18 offset:51200
    v_mfma_f32_16x16x32_bf16 v[144:147], a[16:19], v[72:75], v[144:147]
    v_mfma_f32_16x16x32_bf16 v[148:151], a[16:19], v[76:79], v[148:151]
    ds_read_b64_tr_b16 a[44:45], v19 offset:49152
    ds_read_b64_tr_b16 a[46:47], v19 offset:51200
    ds_read_b64_tr_b16 a[0:1], v20 offset:49152
    ds_read_b64_tr_b16 a[2:3], v20 offset:51200
    v_mfma_f32_16x16x32_bf16 v[152:155], a[20:23], v[72:75], v[152:155]
    v_mfma_f32_16x16x32_bf16 v[156:159], a[20:23], v[76:79], v[156:159]
    ds_read_b64_tr_b16 a[4:5], v21 offset:49152
    ds_read_b64_tr_b16 a[6:7], v21 offset:51200
    v_mfma_f32_16x16x32_bf16 v[160:163], a[24:27], v[72:75], v[160:163]
    v_mfma_f32_16x16x32_bf16 v[164:167], a[24:27], v[76:79], v[164:167]
    ds_read_b64_tr_b16 a[8:9], v22 offset:49152
    ds_read_b64_tr_b16 a[10:11], v22 offset:51200
    v_mfma_f32_16x16x32_bf16 v[168:171], a[28:31], v[72:75], v[168:171]
    v_mfma_f32_16x16x32_bf16 v[172:175], a[28:31], v[76:79], v[172:175]
    ds_read_b64_tr_b16 a[12:13], v23 offset:49152
    ds_read_b64_tr_b16 a[14:15], v23 offset:51200
    s_waitcnt lgkmcnt(8)
    v_mfma_f32_16x16x32_bf16 v[112:115], a[32:35], v[80:83], v[112:115]
    v_mfma_f32_16x16x32_bf16 v[116:119], a[32:35], v[84:87], v[116:119]
    ds_read_b64_tr_b16 a[16:17], v24 offset:49152
    ds_read_b64_tr_b16 a[18:19], v24 offset:51200
    v_mfma_f32_16x16x32_bf16 v[120:123], a[36:39], v[80:83], v[120:123]
    v_mfma_f32_16x16x32_bf16 v[124:127], a[36:39], v[84:87], v[124:127]
    ds_read_b64_tr_b16 a[20:21], v25 offset:49152
    ds_read_b64_tr_b16 a[22:23], v25 offset:51200
    v_mfma_f32_16x16x32_bf16 v[128:131], a[40:43], v[80:83], v[128:131]
    v_mfma_f32_16x16x32_bf16 v[132:135], a[40:43], v[84:87], v[132:135]
    ds_read_b64_tr_b16 a[24:25], v26 offset:49152
    ds_read_b64_tr_b16 a[26:27], v26 offset:51200
    v_mfma_f32_16x16x32_bf16 v[136:139], a[44:47], v[80:83], v[136:139]
    v_mfma_f32_16x16x32_bf16 v[140:143], a[44:47], v[84:87], v[140:143]
    ds_read_b64_tr_b16 a[28:29], v27 offset:49152
    ds_read_b64_tr_b16 a[30:31], v27 offset:51200
    s_waitcnt lgkmcnt(8)
    v_mfma_f32_16x16x32_bf16 v[144:147], a[0:3], v[80:83], v[144:147]
    v_mfma_f32_16x16x32_bf16 v[148:151], a[0:3], v[84:87], v[148:151]
    ds_read_b64_tr_b16 a[32:33], v28 offset:49152
    ds_read_b64_tr_b16 a[34:35], v28 offset:51200
    v_mfma_f32_16x16x32_bf16 v[152:155], a[4:7], v[80:83], v[152:155]
    v_mfma_f32_16x16x32_bf16 v[156:159], a[4:7], v[84:87], v[156:159]
    ds_read_b64_tr_b16 a[36:37], v29 offset:49152
    ds_read_b64_tr_b16 a[38:39], v29 offset:51200
    v_mfma_f32_16x16x32_bf16 v[160:163], a[8:11], v[80:83], v[160:163]
    v_mfma_f32_16x16x32_bf16 v[164:167], a[8:11], v[84:87], v[164:167]
    ds_read_b64_tr_b16 a[40:41], v30 offset:49152
    ds_read_b64_tr_b16 a[42:43], v30 offset:51200
    v_mfma_f32_16x16x32_bf16 v[168:171], a[12:15], v[80:83], v[168:171]
    v_mfma_f32_16x16x32_bf16 v[172:175], a[12:15], v[84:87], v[172:175]
    ds_read_b64_tr_b16 a[44:45], v31 offset:49152
    ds_read_b64_tr_b16 a[46:47], v31 offset:51200
    s_waitcnt lgkmcnt(8)
    v_mfma_f32_16x16x32_bf16 v[112:115], a[16:19], v[88:91], v[112:115]
    v_mfma_f32_16x16x32_bf16 v[116:119], a[16:19], v[92:95], v[116:119]
    v_mfma_f32_16x16x32_bf16 v[120:123], a[20:23], v[88:91], v[120:123]
    v_mfma_f32_16x16x32_bf16 v[124:127], a[20:23], v[92:95], v[124:127]
    v_mfma_f32_16x16x32_bf16 v[128:131], a[24:27], v[88:91], v[128:131]
    s_waitcnt lgkmcnt(0)
    v_mfma_f32_16x16x32_bf16 v[132:135], a[24:27], v[92:95], v[132:135]
    s_barrier
    v_mfma_f32_16x16x32_bf16 v[136:139], a[28:31], v[88:91], v[136:139]
    ds_read_b128 v[48:51], v12 offset:0
    ds_read_b64_tr_b16 a[0:1], v24 offset:0
    ds_read_b64_tr_b16 a[2:3], v24 offset:2048
    v_mfma_f32_16x16x32_bf16 v[140:143], a[28:31], v[92:95], v[140:143]
    ds_read_b128 v[52:55], v12 offset:4096
    ds_read_b64_tr_b16 a[4:5], v25 offset:0
    ds_read_b64_tr_b16 a[6:7], v25 offset:2048
    ds_read_b128 v[56:59], v13 offset:0
    ds_read_b64_tr_b16 a[8:9], v26 offset:0
    ds_read_b64_tr_b16 a[10:11], v26 offset:2048
    v_mfma_f32_16x16x32_bf16 v[144:147], a[32:35], v[88:91], v[144:147]
    v_mfma_f32_16x16x32_bf16 v[148:151], a[32:35], v[92:95], v[148:151]
    ds_read_b128 v[60:63], v13 offset:4096
    ds_read_b64_tr_b16 a[12:13], v27 offset:0
    ds_read_b64_tr_b16 a[14:15], v27 offset:2048
    ds_read_b128 v[64:67], v14 offset:0
    ds_read_b64_tr_b16 a[16:17], v28 offset:0
    ds_read_b64_tr_b16 a[18:19], v28 offset:2048
    v_mfma_f32_16x16x32_bf16 v[152:155], a[36:39], v[88:91], v[152:155]
    v_mfma_f32_16x16x32_bf16 v[156:159], a[36:39], v[92:95], v[156:159]
    ds_read_b128 v[68:71], v14 offset:4096
    ds_read_b64_tr_b16 a[20:21], v29 offset:0
    ds_read_b64_tr_b16 a[22:23], v29 offset:2048
    v_mfma_f32_16x16x32_bf16 v[160:163], a[40:43], v[88:91], v[160:163]
    v_mfma_f32_16x16x32_bf16 v[164:167], a[40:43], v[92:95], v[164:167]
    ds_read_b128 v[72:75], v15 offset:0
    ds_read_b64_tr_b16 a[24:25], v30 offset:0
    ds_read_b64_tr_b16 a[26:27], v30 offset:2048
    v_mfma_f32_16x16x32_bf16 v[168:171], a[44:47], v[88:91], v[168:171]
    v_mfma_f32_16x16x32_bf16 v[172:175], a[44:47], v[92:95], v[172:175]
    ds_read_b128 v[76:79], v15 offset:4096
    ds_read_b64_tr_b16 a[28:29], v31 offset:0
    ds_read_b64_tr_b16 a[30:31], v31 offset:2048
    s_waitcnt lgkmcnt(12)
    v_mfma_f32_16x16x32_bf16 v[112:115], a[0:3], v[96:99], v[112:115]
    v_mfma_f32_16x16x32_bf16 v[116:119], a[0:3], v[100:103], v[116:119]
    v_mfma_f32_16x16x32_bf16 v[120:123], a[4:7], v[96:99], v[120:123]
    v_mfma_f32_16x16x32_bf16 v[124:127], a[4:7], v[100:103], v[124:127]
    v_mfma_f32_16x16x32_bf16 v[128:131], a[8:11], v[96:99], v[128:131]
    s_waitcnt lgkmcnt(0)
    v_mfma_f32_16x16x32_bf16 v[132:135], a[8:11], v[100:103], v[132:135]
    s_barrier
    v_mfma_f32_16x16x32_bf16 v[136:139], a[12:15], v[96:99], v[136:139]
    ds_read_b64_tr_b16 a[32:33], v16 offset:16384
    ds_read_b64_tr_b16 a[34:35], v16 offset:18432
    v_mfma_f32_16x16x32_bf16 v[140:143], a[12:15], v[100:103], v[140:143]
    ds_read_b64_tr_b16 a[36:37], v17 offset:16384
    ds_read_b64_tr_b16 a[38:39], v17 offset:18432
    ds_read_b64_tr_b16 a[40:41], v18 offset:16384
    ds_read_b64_tr_b16 a[42:43], v18 offset:18432
    v_mfma_f32_16x16x32_bf16 v[144:147], a[16:19], v[96:99], v[144:147]
    v_mfma_f32_16x16x32_bf16 v[148:151], a[16:19], v[100:103], v[148:151]
    ds_read_b64_tr_b16 a[44:45], v19 offset:16384
    ds_read_b64_tr_b16 a[46:47], v19 offset:18432
    ds_read_b64_tr_b16 a[0:1], v20 offset:16384
    ds_read_b64_tr_b16 a[2:3], v20 offset:18432
    v_mfma_f32_16x16x32_bf16 v[152:155], a[20:23], v[96:99], v[152:155]
    v_mfma_f32_16x16x32_bf16 v[156:159], a[20:23], v[100:103], v[156:159]
    ds_read_b64_tr_b16 a[4:5], v21 offset:16384
    ds_read_b64_tr_b16 a[6:7], v21 offset:18432
    v_mfma_f32_16x16x32_bf16 v[160:163], a[24:27], v[96:99], v[160:163]
    v_mfma_f32_16x16x32_bf16 v[164:167], a[24:27], v[100:103], v[164:167]
    ds_read_b64_tr_b16 a[8:9], v22 offset:16384
    ds_read_b64_tr_b16 a[10:11], v22 offset:18432
    v_mfma_f32_16x16x32_bf16 v[168:171], a[28:31], v[96:99], v[168:171]
    v_mfma_f32_16x16x32_bf16 v[172:175], a[28:31], v[100:103], v[172:175]
    ds_read_b64_tr_b16 a[12:13], v23 offset:16384
    ds_read_b64_tr_b16 a[14:15], v23 offset:18432
    s_waitcnt lgkmcnt(8)
    v_mfma_f32_16x16x32_bf16 v[112:115], a[32:35], v[104:107], v[112:115]
    v_mfma_f32_16x16x32_bf16 v[116:119], a[32:35], v[108:111], v[116:119]
    ds_read_b64_tr_b16 a[16:17], v24 offset:16384
    ds_read_b64_tr_b16 a[18:19], v24 offset:18432
    v_mfma_f32_16x16x32_bf16 v[120:123], a[36:39], v[104:107], v[120:123]
    v_mfma_f32_16x16x32_bf16 v[124:127], a[36:39], v[108:111], v[124:127]
    ds_read_b64_tr_b16 a[20:21], v25 offset:16384
    ds_read_b64_tr_b16 a[22:23], v25 offset:18432
    v_mfma_f32_16x16x32_bf16 v[128:131], a[40:43], v[104:107], v[128:131]
    v_mfma_f32_16x16x32_bf16 v[132:135], a[40:43], v[108:111], v[132:135]
    ds_read_b64_tr_b16 a[24:25], v26 offset:16384
    ds_read_b64_tr_b16 a[26:27], v26 offset:18432
    v_mfma_f32_16x16x32_bf16 v[136:139], a[44:47], v[104:107], v[136:139]
    v_mfma_f32_16x16x32_bf16 v[140:143], a[44:47], v[108:111], v[140:143]
    ds_read_b64_tr_b16 a[28:29], v27 offset:16384
    ds_read_b64_tr_b16 a[30:31], v27 offset:18432
    s_waitcnt lgkmcnt(8)
    v_mfma_f32_16x16x32_bf16 v[144:147], a[0:3], v[104:107], v[144:147]
    v_mfma_f32_16x16x32_bf16 v[148:151], a[0:3], v[108:111], v[148:151]
    ds_read_b64_tr_b16 a[32:33], v28 offset:16384
    ds_read_b64_tr_b16 a[34:35], v28 offset:18432
    v_mfma_f32_16x16x32_bf16 v[152:155], a[4:7], v[104:107], v[152:155]
    v_mfma_f32_16x16x32_bf16 v[156:159], a[4:7], v[108:111], v[156:159]
    ds_read_b64_tr_b16 a[36:37], v29 offset:16384
    ds_read_b64_tr_b16 a[38:39], v29 offset:18432
    v_mfma_f32_16x16x32_bf16 v[160:163], a[8:11], v[104:107], v[160:163]
    v_mfma_f32_16x16x32_bf16 v[164:167], a[8:11], v[108:111], v[164:167]
    ds_read_b64_tr_b16 a[40:41], v30 offset:16384
    ds_read_b64_tr_b16 a[42:43], v30 offset:18432
    v_mfma_f32_16x16x32_bf16 v[168:171], a[12:15], v[104:107], v[168:171]
    v_mfma_f32_16x16x32_bf16 v[172:175], a[12:15], v[108:111], v[172:175]
    ds_read_b64_tr_b16 a[44:45], v31 offset:16384
    ds_read_b64_tr_b16 a[46:47], v31 offset:18432
    s_waitcnt lgkmcnt(8)
    v_mfma_f32_16x16x32_bf16 v[112:115], a[16:19], v[48:51], v[112:115]
    v_mfma_f32_16x16x32_bf16 v[116:119], a[16:19], v[52:55], v[116:119]
    v_mfma_f32_16x16x32_bf16 v[120:123], a[20:23], v[48:51], v[120:123]
    v_mfma_f32_16x16x32_bf16 v[124:127], a[20:23], v[52:55], v[124:127]
    v_mfma_f32_16x16x32_bf16 v[128:131], a[24:27], v[48:51], v[128:131]
    s_waitcnt lgkmcnt(0)
    v_mfma_f32_16x16x32_bf16 v[132:135], a[24:27], v[52:55], v[132:135]
    s_barrier
    v_mfma_f32_16x16x32_bf16 v[136:139], a[28:31], v[48:51], v[136:139]
    ds_read_b64_tr_b16 a[0:1], v16 offset:32768
    ds_read_b64_tr_b16 a[2:3], v16 offset:34816
    v_mfma_f32_16x16x32_bf16 v[140:143], a[28:31], v[52:55], v[140:143]
    ds_read_b64_tr_b16 a[4:5], v17 offset:32768
    ds_read_b64_tr_b16 a[6:7], v17 offset:34816
    ds_read_b64_tr_b16 a[8:9], v18 offset:32768
    ds_read_b64_tr_b16 a[10:11], v18 offset:34816
    v_mfma_f32_16x16x32_bf16 v[144:147], a[32:35], v[48:51], v[144:147]
    v_mfma_f32_16x16x32_bf16 v[148:151], a[32:35], v[52:55], v[148:151]
    ds_read_b64_tr_b16 a[12:13], v19 offset:32768
    ds_read_b64_tr_b16 a[14:15], v19 offset:34816
    ds_read_b64_tr_b16 a[16:17], v20 offset:32768
    ds_read_b64_tr_b16 a[18:19], v20 offset:34816
    v_mfma_f32_16x16x32_bf16 v[152:155], a[36:39], v[48:51], v[152:155]
    v_mfma_f32_16x16x32_bf16 v[156:159], a[36:39], v[52:55], v[156:159]
    ds_read_b64_tr_b16 a[20:21], v21 offset:32768
    ds_read_b64_tr_b16 a[22:23], v21 offset:34816
    v_mfma_f32_16x16x32_bf16 v[160:163], a[40:43], v[48:51], v[160:163]
    v_mfma_f32_16x16x32_bf16 v[164:167], a[40:43], v[52:55], v[164:167]
    ds_read_b64_tr_b16 a[24:25], v22 offset:32768
    ds_read_b64_tr_b16 a[26:27], v22 offset:34816
    v_mfma_f32_16x16x32_bf16 v[168:171], a[44:47], v[48:51], v[168:171]
    v_mfma_f32_16x16x32_bf16 v[172:175], a[44:47], v[52:55], v[172:175]
    ds_read_b64_tr_b16 a[28:29], v23 offset:32768
    ds_read_b64_tr_b16 a[30:31], v23 offset:34816
    s_waitcnt lgkmcnt(8)
    v_mfma_f32_16x16x32_bf16 v[112:115], a[0:3], v[56:59], v[112:115]
    v_mfma_f32_16x16x32_bf16 v[116:119], a[0:3], v[60:63], v[116:119]
    ds_read_b64_tr_b16 a[32:33], v24 offset:32768
    ds_read_b64_tr_b16 a[34:35], v24 offset:34816
    v_mfma_f32_16x16x32_bf16 v[120:123], a[4:7], v[56:59], v[120:123]
    v_mfma_f32_16x16x32_bf16 v[124:127], a[4:7], v[60:63], v[124:127]
    ds_read_b64_tr_b16 a[36:37], v25 offset:32768
    ds_read_b64_tr_b16 a[38:39], v25 offset:34816
    v_mfma_f32_16x16x32_bf16 v[128:131], a[8:11], v[56:59], v[128:131]
    v_mfma_f32_16x16x32_bf16 v[132:135], a[8:11], v[60:63], v[132:135]
    ds_read_b64_tr_b16 a[40:41], v26 offset:32768
    ds_read_b64_tr_b16 a[42:43], v26 offset:34816
    v_mfma_f32_16x16x32_bf16 v[136:139], a[12:15], v[56:59], v[136:139]
    v_mfma_f32_16x16x32_bf16 v[140:143], a[12:15], v[60:63], v[140:143]
    ds_read_b64_tr_b16 a[44:45], v27 offset:32768
    ds_read_b64_tr_b16 a[46:47], v27 offset:34816
    s_waitcnt lgkmcnt(8)
    v_mfma_f32_16x16x32_bf16 v[144:147], a[16:19], v[56:59], v[144:147]
    v_mfma_f32_16x16x32_bf16 v[148:151], a[16:19], v[60:63], v[148:151]
    ds_read_b64_tr_b16 a[0:1], v28 offset:32768
    ds_read_b64_tr_b16 a[2:3], v28 offset:34816
    v_mfma_f32_16x16x32_bf16 v[152:155], a[20:23], v[56:59], v[152:155]
    v_mfma_f32_16x16x32_bf16 v[156:159], a[20:23], v[60:63], v[156:159]
    ds_read_b64_tr_b16 a[4:5], v29 offset:32768
    ds_read_b64_tr_b16 a[6:7], v29 offset:34816
    v_mfma_f32_16x16x32_bf16 v[160:163], a[24:27], v[56:59], v[160:163]
    v_mfma_f32_16x16x32_bf16 v[164:167], a[24:27], v[60:63], v[164:167]
    ds_read_b64_tr_b16 a[8:9], v30 offset:32768
    ds_read_b64_tr_b16 a[10:11], v30 offset:34816
    v_mfma_f32_16x16x32_bf16 v[168:171], a[28:31], v[56:59], v[168:171]
    v_mfma_f32_16x16x32_bf16 v[172:175], a[28:31], v[60:63], v[172:175]
    ds_read_b64_tr_b16 a[12:13], v31 offset:32768
    ds_read_b64_tr_b16 a[14:15], v31 offset:34816
    s_waitcnt lgkmcnt(8)
    v_mfma_f32_16x16x32_bf16 v[112:115], a[32:35], v[64:67], v[112:115]
    v_mfma_f32_16x16x32_bf16 v[116:119], a[32:35], v[68:71], v[116:119]
    v_mfma_f32_16x16x32_bf16 v[120:123], a[36:39], v[64:67], v[120:123]
    v_mfma_f32_16x16x32_bf16 v[124:127], a[36:39], v[68:71], v[124:127]
    v_mfma_f32_16x16x32_bf16 v[128:131], a[40:43], v[64:67], v[128:131]
    s_waitcnt lgkmcnt(0)
    v_mfma_f32_16x16x32_bf16 v[132:135], a[40:43], v[68:71], v[132:135]
    s_barrier
    v_mfma_f32_16x16x32_bf16 v[136:139], a[44:47], v[64:67], v[136:139]
    ds_read_b128 v[80:83], v12 offset:49152
    ds_read_b64_tr_b16 a[16:17], v24 offset:49152
    ds_read_b64_tr_b16 a[18:19], v24 offset:51200
    v_mfma_f32_16x16x32_bf16 v[140:143], a[44:47], v[68:71], v[140:143]
    ds_read_b128 v[84:87], v12 offset:53248
    ds_read_b64_tr_b16 a[20:21], v25 offset:49152
    ds_read_b64_tr_b16 a[22:23], v25 offset:51200
    ds_read_b128 v[88:91], v13 offset:49152
    ds_read_b64_tr_b16 a[24:25], v26 offset:49152
    ds_read_b64_tr_b16 a[26:27], v26 offset:51200
    v_mfma_f32_16x16x32_bf16 v[144:147], a[0:3], v[64:67], v[144:147]
    v_mfma_f32_16x16x32_bf16 v[148:151], a[0:3], v[68:71], v[148:151]
    ds_read_b128 v[92:95], v13 offset:53248
    ds_read_b64_tr_b16 a[28:29], v27 offset:49152
    ds_read_b64_tr_b16 a[30:31], v27 offset:51200
    ds_read_b128 v[96:99], v14 offset:49152
    ds_read_b64_tr_b16 a[32:33], v28 offset:49152
    ds_read_b64_tr_b16 a[34:35], v28 offset:51200
    v_mfma_f32_16x16x32_bf16 v[152:155], a[4:7], v[64:67], v[152:155]
    v_mfma_f32_16x16x32_bf16 v[156:159], a[4:7], v[68:71], v[156:159]
    ds_read_b128 v[100:103], v14 offset:53248
    ds_read_b64_tr_b16 a[36:37], v29 offset:49152
    ds_read_b64_tr_b16 a[38:39], v29 offset:51200
    v_mfma_f32_16x16x32_bf16 v[160:163], a[8:11], v[64:67], v[160:163]
    v_mfma_f32_16x16x32_bf16 v[164:167], a[8:11], v[68:71], v[164:167]
    ds_read_b128 v[104:107], v15 offset:49152
    ds_read_b64_tr_b16 a[40:41], v30 offset:49152
    ds_read_b64_tr_b16 a[42:43], v30 offset:51200
    v_mfma_f32_16x16x32_bf16 v[168:171], a[12:15], v[64:67], v[168:171]
    v_mfma_f32_16x16x32_bf16 v[172:175], a[12:15], v[68:71], v[172:175]
    ds_read_b128 v[108:111], v15 offset:53248
    ds_read_b64_tr_b16 a[44:45], v31 offset:49152
    ds_read_b64_tr_b16 a[46:47], v31 offset:51200
    s_waitcnt lgkmcnt(12)
    v_mfma_f32_16x16x32_bf16 v[112:115], a[16:19], v[72:75], v[112:115]
    v_mfma_f32_16x16x32_bf16 v[116:119], a[16:19], v[76:79], v[116:119]
    v_mfma_f32_16x16x32_bf16 v[120:123], a[20:23], v[72:75], v[120:123]
    v_mfma_f32_16x16x32_bf16 v[124:127], a[20:23], v[76:79], v[124:127]
    v_mfma_f32_16x16x32_bf16 v[128:131], a[24:27], v[72:75], v[128:131]
    s_waitcnt lgkmcnt(0)
    v_mfma_f32_16x16x32_bf16 v[132:135], a[24:27], v[76:79], v[132:135]
    s_barrier
    v_mfma_f32_16x16x32_bf16 v[136:139], a[28:31], v[72:75], v[136:139]
    ds_read_b64_tr_b16 a[0:1], v16 offset:0
    ds_read_b64_tr_b16 a[2:3], v16 offset:2048
    v_mfma_f32_16x16x32_bf16 v[140:143], a[28:31], v[76:79], v[140:143]
    ds_read_b64_tr_b16 a[4:5], v17 offset:0
    ds_read_b64_tr_b16 a[6:7], v17 offset:2048
    ds_read_b64_tr_b16 a[8:9], v18 offset:0
    ds_read_b64_tr_b16 a[10:11], v18 offset:2048
    v_mfma_f32_16x16x32_bf16 v[144:147], a[32:35], v[72:75], v[144:147]
    v_mfma_f32_16x16x32_bf16 v[148:151], a[32:35], v[76:79], v[148:151]
    ds_read_b64_tr_b16 a[12:13], v19 offset:0
    ds_read_b64_tr_b16 a[14:15], v19 offset:2048
    ds_read_b64_tr_b16 a[16:17], v20 offset:0
    ds_read_b64_tr_b16 a[18:19], v20 offset:2048
    v_mfma_f32_16x16x32_bf16 v[152:155], a[36:39], v[72:75], v[152:155]
    v_mfma_f32_16x16x32_bf16 v[156:159], a[36:39], v[76:79], v[156:159]
    ds_read_b64_tr_b16 a[20:21], v21 offset:0
    ds_read_b64_tr_b16 a[22:23], v21 offset:2048
    v_mfma_f32_16x16x32_bf16 v[160:163], a[40:43], v[72:75], v[160:163]
    v_mfma_f32_16x16x32_bf16 v[164:167], a[40:43], v[76:79], v[164:167]
    ds_read_b64_tr_b16 a[24:25], v22 offset:0
    ds_read_b64_tr_b16 a[26:27], v22 offset:2048
    v_mfma_f32_16x16x32_bf16 v[168:171], a[44:47], v[72:75], v[168:171]
    v_mfma_f32_16x16x32_bf16 v[172:175], a[44:47], v[76:79], v[172:175]
    ds_read_b64_tr_b16 a[28:29], v23 offset:0
    ds_read_b64_tr_b16 a[30:31], v23 offset:2048
    s_waitcnt lgkmcnt(8)
    v_mfma_f32_16x16x32_bf16 v[112:115], a[0:3], v[80:83], v[112:115]
    v_mfma_f32_16x16x32_bf16 v[116:119], a[0:3], v[84:87], v[116:119]
    ds_read_b64_tr_b16 a[32:33], v24 offset:0
    ds_read_b64_tr_b16 a[34:35], v24 offset:2048
    v_mfma_f32_16x16x32_bf16 v[120:123], a[4:7], v[80:83], v[120:123]
    v_mfma_f32_16x16x32_bf16 v[124:127], a[4:7], v[84:87], v[124:127]
    ds_read_b64_tr_b16 a[36:37], v25 offset:0
    ds_read_b64_tr_b16 a[38:39], v25 offset:2048
    v_mfma_f32_16x16x32_bf16 v[128:131], a[8:11], v[80:83], v[128:131]
    v_mfma_f32_16x16x32_bf16 v[132:135], a[8:11], v[84:87], v[132:135]
    ds_read_b64_tr_b16 a[40:41], v26 offset:0
    ds_read_b64_tr_b16 a[42:43], v26 offset:2048
    v_mfma_f32_16x16x32_bf16 v[136:139], a[12:15], v[80:83], v[136:139]
    v_mfma_f32_16x16x32_bf16 v[140:143], a[12:15], v[84:87], v[140:143]
    ds_read_b64_tr_b16 a[44:45], v27 offset:0
    ds_read_b64_tr_b16 a[46:47], v27 offset:2048
    s_waitcnt lgkmcnt(8)
    v_mfma_f32_16x16x32_bf16 v[144:147], a[16:19], v[80:83], v[144:147]
    v_mfma_f32_16x16x32_bf16 v[148:151], a[16:19], v[84:87], v[148:151]
    ds_read_b64_tr_b16 a[0:1], v28 offset:0
    ds_read_b64_tr_b16 a[2:3], v28 offset:2048
    v_mfma_f32_16x16x32_bf16 v[152:155], a[20:23], v[80:83], v[152:155]
    v_mfma_f32_16x16x32_bf16 v[156:159], a[20:23], v[84:87], v[156:159]
    ds_read_b64_tr_b16 a[4:5], v29 offset:0
    ds_read_b64_tr_b16 a[6:7], v29 offset:2048
    v_mfma_f32_16x16x32_bf16 v[160:163], a[24:27], v[80:83], v[160:163]
    v_mfma_f32_16x16x32_bf16 v[164:167], a[24:27], v[84:87], v[164:167]
    ds_read_b64_tr_b16 a[8:9], v30 offset:0
    ds_read_b64_tr_b16 a[10:11], v30 offset:2048
    v_mfma_f32_16x16x32_bf16 v[168:171], a[28:31], v[80:83], v[168:171]
    v_mfma_f32_16x16x32_bf16 v[172:175], a[28:31], v[84:87], v[172:175]
    ds_read_b64_tr_b16 a[12:13], v31 offset:0
    ds_read_b64_tr_b16 a[14:15], v31 offset:2048
    s_waitcnt lgkmcnt(8)
    v_mfma_f32_16x16x32_bf16 v[112:115], a[32:35], v[88:91], v[112:115]
    v_xor_b32 v12, 0, v43
    v_mfma_f32_16x16x32_bf16 v[116:119], a[32:35], v[92:95], v[116:119]
    v_mfma_f32_16x16x32_bf16 v[120:123], a[36:39], v[88:91], v[120:123]
    v_xor_b32 v13, 32, v43
    v_mfma_f32_16x16x32_bf16 v[124:127], a[36:39], v[92:95], v[124:127]
    v_mfma_f32_16x16x32_bf16 v[128:131], a[40:43], v[88:91], v[128:131]
    v_xor_b32 v14, 65536, v43
    s_waitcnt lgkmcnt(0)
    v_mfma_f32_16x16x32_bf16 v[132:135], a[40:43], v[92:95], v[132:135]
    s_barrier
    v_mfma_f32_16x16x32_bf16 v[136:139], a[44:47], v[88:91], v[136:139]
    ds_read_b64_tr_b16 a[16:17], v16 offset:16384
    ds_read_b64_tr_b16 a[18:19], v16 offset:18432
    v_xor_b32 v15, 65568, v43
    v_mfma_f32_16x16x32_bf16 v[140:143], a[44:47], v[92:95], v[140:143]
    ds_read_b64_tr_b16 a[20:21], v24 offset:16384
    ds_read_b64_tr_b16 a[22:23], v24 offset:18432
    ds_read_b64_tr_b16 a[24:25], v17 offset:16384
    ds_read_b64_tr_b16 a[26:27], v17 offset:18432
    v_mfma_f32_16x16x32_bf16 v[144:147], a[0:3], v[88:91], v[144:147]
    v_mfma_f32_16x16x32_bf16 v[148:151], a[0:3], v[92:95], v[148:151]
    ds_read_b64_tr_b16 a[28:29], v25 offset:16384
    ds_read_b64_tr_b16 a[30:31], v25 offset:18432
    ds_read_b64_tr_b16 a[32:33], v18 offset:16384
    ds_read_b64_tr_b16 a[34:35], v18 offset:18432
    v_mfma_f32_16x16x32_bf16 v[152:155], a[4:7], v[88:91], v[152:155]
    v_mfma_f32_16x16x32_bf16 v[156:159], a[4:7], v[92:95], v[156:159]
    ds_read_b64_tr_b16 a[36:37], v26 offset:16384
    ds_read_b64_tr_b16 a[38:39], v26 offset:18432
    v_mfma_f32_16x16x32_bf16 v[160:163], a[8:11], v[88:91], v[160:163]
    v_mfma_f32_16x16x32_bf16 v[164:167], a[8:11], v[92:95], v[164:167]
    ds_read_b64_tr_b16 a[40:41], v19 offset:16384
    ds_read_b64_tr_b16 a[42:43], v19 offset:18432
    v_mfma_f32_16x16x32_bf16 v[168:171], a[12:15], v[88:91], v[168:171]
    v_mfma_f32_16x16x32_bf16 v[172:175], a[12:15], v[92:95], v[172:175]
    ds_read_b64_tr_b16 a[44:45], v27 offset:16384
    ds_read_b64_tr_b16 a[46:47], v27 offset:18432
    s_waitcnt lgkmcnt(8)
    v_mfma_f32_16x16x32_bf16 v[112:115], a[16:19], v[96:99], v[112:115]
    v_mfma_f32_16x16x32_bf16 v[116:119], a[16:19], v[100:103], v[116:119]
    ds_read_b64_tr_b16 a[0:1], v20 offset:16384
    ds_read_b64_tr_b16 a[2:3], v20 offset:18432
    v_mfma_f32_16x16x32_bf16 v[112:115], a[20:23], v[104:107], v[112:115]
    v_mfma_f32_16x16x32_bf16 v[116:119], a[20:23], v[108:111], v[116:119]
    ds_read_b64_tr_b16 a[4:5], v28 offset:16384
    ds_read_b64_tr_b16 a[6:7], v28 offset:18432
    v_mfma_f32_16x16x32_bf16 v[120:123], a[24:27], v[96:99], v[120:123]
    v_mfma_f32_16x16x32_bf16 v[124:127], a[24:27], v[100:103], v[124:127]
    ds_read_b64_tr_b16 a[8:9], v21 offset:16384
    ds_read_b64_tr_b16 a[10:11], v21 offset:18432
    v_mfma_f32_16x16x32_bf16 v[120:123], a[28:31], v[104:107], v[120:123]
    v_mfma_f32_16x16x32_bf16 v[124:127], a[28:31], v[108:111], v[124:127]
    ds_read_b64_tr_b16 a[12:13], v29 offset:16384
    ds_read_b64_tr_b16 a[14:15], v29 offset:18432
    s_waitcnt lgkmcnt(8)
    v_mfma_f32_16x16x32_bf16 v[128:131], a[32:35], v[96:99], v[128:131]
    v_mfma_f32_16x16x32_bf16 v[132:135], a[32:35], v[100:103], v[132:135]
    ds_read_b64_tr_b16 a[16:17], v22 offset:16384
    ds_read_b64_tr_b16 a[18:19], v22 offset:18432
    v_mfma_f32_16x16x32_bf16 v[128:131], a[36:39], v[104:107], v[128:131]
    v_pk_mul_f32 v[112:113], v[112:113], s[96:97]
    v_pk_mul_f32 v[114:115], v[114:115], s[96:97]
    v_cvt_pk_bf16_f32 v176, v112, v113
    v_mfma_f32_16x16x32_bf16 v[132:135], a[36:39], v[108:111], v[132:135]
    ds_read_b64_tr_b16 a[20:21], v30 offset:16384
    ds_read_b64_tr_b16 a[22:23], v30 offset:18432
    v_cvt_pk_bf16_f32 v177, v114, v115
    v_pk_mul_f32 v[116:117], v[116:117], s[96:97]
    v_mfma_f32_16x16x32_bf16 v[136:139], a[40:43], v[96:99], v[136:139]
    v_pk_mul_f32 v[118:119], v[118:119], s[96:97]
    v_cvt_pk_bf16_f32 v192, v116, v117
    v_cvt_pk_bf16_f32 v193, v118, v119
    v_mfma_f32_16x16x32_bf16 v[140:143], a[40:43], v[100:103], v[140:143]
    ds_read_b64_tr_b16 a[24:25], v23 offset:16384
    ds_read_b64_tr_b16 a[26:27], v23 offset:18432
    v_pk_mul_f32 v[120:121], v[120:121], s[96:97]
    v_pk_mul_f32 v[122:123], v[122:123], s[96:97]
    v_mfma_f32_16x16x32_bf16 v[136:139], a[44:47], v[104:107], v[136:139]
    v_cvt_pk_bf16_f32 v178, v120, v121
    v_cvt_pk_bf16_f32 v179, v122, v123
    v_pk_mul_f32 v[124:125], v[124:125], s[96:97]
    v_mfma_f32_16x16x32_bf16 v[140:143], a[44:47], v[108:111], v[140:143]
    ds_read_b64_tr_b16 a[28:29], v31 offset:16384
    ds_read_b64_tr_b16 a[30:31], v31 offset:18432
    v_pk_mul_f32 v[126:127], v[126:127], s[96:97]
    v_cvt_pk_bf16_f32 v194, v124, v125
    s_waitcnt lgkmcnt(8)
    v_mfma_f32_16x16x32_bf16 v[144:147], a[0:3], v[96:99], v[144:147]
    v_cvt_pk_bf16_f32 v195, v126, v127
    v_permlane16_swap_b32 v176, v178
    v_permlane16_swap_b32 v177, v179
    v_mfma_f32_16x16x32_bf16 v[148:151], a[0:3], v[100:103], v[148:151]
    v_permlane16_swap_b32 v192, v194
    v_permlane16_swap_b32 v193, v195
    v_mfma_f32_16x16x32_bf16 v[144:147], a[4:7], v[104:107], v[144:147]
    v_pk_mul_f32 v[128:129], v[128:129], s[96:97]
    v_pk_mul_f32 v[130:131], v[130:131], s[96:97]
    v_cvt_pk_bf16_f32 v180, v128, v129
    v_mfma_f32_16x16x32_bf16 v[148:151], a[4:7], v[108:111], v[148:151]
    v_cvt_pk_bf16_f32 v181, v130, v131
    v_pk_mul_f32 v[132:133], v[132:133], s[96:97]
    v_mfma_f32_16x16x32_bf16 v[152:155], a[8:11], v[96:99], v[152:155]
    v_pk_mul_f32 v[134:135], v[134:135], s[96:97]
    v_cvt_pk_bf16_f32 v196, v132, v133
    v_cvt_pk_bf16_f32 v197, v134, v135
    v_pk_mul_f32 v[136:137], v[136:137], s[96:97]
    v_pk_mul_f32 v[138:139], v[138:139], s[96:97]
    s_waitcnt lgkmcnt(0)
    v_mfma_f32_16x16x32_bf16 v[156:159], a[8:11], v[100:103], v[156:159]
    s_barrier
    v_mfma_f32_16x16x32_bf16 v[152:155], a[12:15], v[104:107], v[152:155]
    ds_read_b128 a[32:35], v8 offset:32768
    v_cvt_pk_bf16_f32 v182, v136, v137
    v_cvt_pk_bf16_f32 v183, v138, v139
    v_pk_mul_f32 v[140:141], v[140:141], s[96:97]
    v_mfma_f32_16x16x32_bf16 v[156:159], a[12:15], v[108:111], v[156:159]
    ds_read_b128 a[36:39], v9 offset:32768
    ds_read_b128 a[40:43], v10 offset:32768
    v_pk_mul_f32 v[142:143], v[142:143], s[96:97]
    v_cvt_pk_bf16_f32 v198, v140, v141
    v_mfma_f32_16x16x32_bf16 v[160:163], a[16:19], v[96:99], v[160:163]
    v_cvt_pk_bf16_f32 v199, v142, v143
    v_permlane16_swap_b32 v180, v182
    v_permlane16_swap_b32 v181, v183
    v_mfma_f32_16x16x32_bf16 v[164:167], a[16:19], v[100:103], v[164:167]
    ds_read_b128 a[44:47], v11 offset:32768
    ds_read_b128 a[0:3], v8 offset:36864
    v_permlane16_swap_b32 v196, v198
    v_permlane16_swap_b32 v197, v199
    v_mfma_f32_16x16x32_bf16 v[160:163], a[20:23], v[104:107], v[160:163]
    v_pk_mul_f32 v[144:145], v[144:145], s[96:97]
    v_pk_mul_f32 v[146:147], v[146:147], s[96:97]
    v_cvt_pk_bf16_f32 v184, v144, v145
    v_cvt_pk_bf16_f32 v185, v146, v147
    v_pk_mul_f32 v[148:149], v[148:149], s[96:97]
    v_mfma_f32_16x16x32_bf16 v[164:167], a[20:23], v[108:111], v[164:167]
    ds_read_b128 a[4:7], v9 offset:36864
    v_pk_mul_f32 v[150:151], v[150:151], s[96:97]
    v_mfma_f32_16x16x32_bf16 v[168:171], a[24:27], v[96:99], v[168:171]
    v_cvt_pk_bf16_f32 v200, v148, v149
    v_cvt_pk_bf16_f32 v201, v150, v151
    v_pk_mul_f32 v[152:153], v[152:153], s[96:97]
    v_pk_mul_f32 v[154:155], v[154:155], s[96:97]
    v_cvt_pk_bf16_f32 v186, v152, v153
    v_mfma_f32_16x16x32_bf16 v[172:175], a[24:27], v[100:103], v[172:175]
    ds_read_b128 a[8:11], v10 offset:36864
    v_cvt_pk_bf16_f32 v187, v154, v155
    v_pk_mul_f32 v[156:157], v[156:157], s[96:97]
    v_mfma_f32_16x16x32_bf16 v[168:171], a[28:31], v[104:107], v[168:171]
    v_pk_mul_f32 v[158:159], v[158:159], s[96:97]
    v_cvt_pk_bf16_f32 v202, v156, v157
    v_cvt_pk_bf16_f32 v203, v158, v159
    v_permlane16_swap_b32 v184, v186
    v_permlane16_swap_b32 v185, v187
    v_mfma_f32_16x16x32_bf16 v[172:175], a[28:31], v[108:111], v[172:175]
    ds_read_b128 a[12:15], v11 offset:36864
    v_permlane16_swap_b32 v200, v202
    v_permlane16_swap_b32 v201, v203
    s_waitcnt lgkmcnt(4)
    v_mfma_f32_16x16x32_bf16 v[48:51], a[32:35], v[176:179], 0
    v_pk_mul_f32 v[160:161], v[160:161], s[96:97]
    v_pk_mul_f32 v[162:163], v[162:163], s[96:97]
    v_cvt_pk_bf16_f32 v188, v160, v161
    v_cvt_pk_bf16_f32 v189, v162, v163
    v_mfma_f32_16x16x32_bf16 v[56:59], a[32:35], v[192:195], 0
    ds_read_b128 a[16:19], v8 offset:40960
    v_pk_mul_f32 v[164:165], v[164:165], s[96:97]
    v_pk_mul_f32 v[166:167], v[166:167], s[96:97]
    v_mfma_f32_16x16x32_bf16 v[48:51], a[36:39], v[180:183], v[48:51]
    v_cvt_pk_bf16_f32 v204, v164, v165
    v_cvt_pk_bf16_f32 v205, v166, v167
    v_pk_mul_f32 v[168:169], v[168:169], s[96:97]
    v_pk_mul_f32 v[170:171], v[170:171], s[96:97]
    v_mfma_f32_16x16x32_bf16 v[56:59], a[36:39], v[196:199], v[56:59]
    ds_read_b128 a[20:23], v9 offset:40960
    v_cvt_pk_bf16_f32 v190, v168, v169
    v_cvt_pk_bf16_f32 v191, v170, v171
    v_pk_mul_f32 v[172:173], v[172:173], s[96:97]
    v_mfma_f32_16x16x32_bf16 v[48:51], a[40:43], v[184:187], v[48:51]
    v_pk_mul_f32 v[174:175], v[174:175], s[96:97]
    v_cvt_pk_bf16_f32 v206, v172, v173
    v_cvt_pk_bf16_f32 v207, v174, v175
    v_permlane16_swap_b32 v188, v190
    v_mfma_f32_16x16x32_bf16 v[56:59], a[40:43], v[200:203], v[56:59]
    ds_read_b128 a[24:27], v10 offset:40960
    v_permlane16_swap_b32 v189, v191
    v_permlane16_swap_b32 v204, v206
    v_permlane16_swap_b32 v205, v207
    v_mfma_f32_16x16x32_bf16 v[48:51], a[44:47], v[188:191], v[48:51]
    v_xor_b32 v16, 0, v42
    v_xor_b32 v17, 32, v42
    v_mfma_f32_16x16x32_bf16 v[56:59], a[44:47], v[204:207], v[56:59]
    ds_read_b128 a[28:31], v11 offset:40960
    v_xor_b32 v18, 64, v42
    v_xor_b32 v19, 96, v42
    s_waitcnt lgkmcnt(4)
    v_mfma_f32_16x16x32_bf16 v[52:55], a[0:3], v[176:179], 0
    v_xor_b32 v20, 128, v42
    v_xor_b32 v21, 160, v42
    v_mfma_f32_16x16x32_bf16 v[60:63], a[0:3], v[192:195], 0
    ds_read_b128 a[32:35], v8 offset:45056
    v_xor_b32 v22, 192, v42
    v_xor_b32 v23, 224, v42
    s_waitcnt vmcnt(0)
L_re_compute:
    v_mfma_f32_16x16x32_bf16 v[52:55], a[4:7], v[180:183], v[52:55]
    v_max3_f32 v36, v38, v48, v49
    v_max3_f32 v37, v39, v56, v57
    v_max3_f32 v36, v36, v50, v51
    v_max3_f32 v37, v37, v58, v59
    v_mfma_f32_16x16x32_bf16 v[60:63], a[4:7], v[196:199], v[60:63]
    ds_read_b128 a[36:39], v9 offset:45056
    v_mov_b32 v1, v36
    v_mov_b32 v2, v37
    s_nop 0
    v_permlane32_swap_b32 v1, v36
    v_permlane32_swap_b32 v2, v37
    v_mfma_f32_16x16x32_bf16 v[52:55], a[8:11], v[184:187], v[52:55]
    v_max_f32 v36, v36, v1
    v_max_f32 v37, v37, v2
    v_mov_b32 v1, v36
    v_mov_b32 v2, v37
    v_mfma_f32_16x16x32_bf16 v[60:63], a[8:11], v[200:203], v[60:63]
    ds_read_b128 a[40:43], v10 offset:45056
    v_permlane16_swap_b32 v1, v36
    v_permlane16_swap_b32 v2, v37
    v_max_f32 v36, v36, v1
    v_max_f32 v37, v37, v2
    v_mfma_f32_16x16x32_bf16 v[52:55], a[12:15], v[188:191], v[52:55]
    v_sub_f32 v80, 0, v36
    v_sub_f32 v84, 0, v37
    v_sub_f32 v81, 0, v36
    v_sub_f32 v85, 0, v37
    v_mfma_f32_16x16x32_bf16 v[60:63], a[12:15], v[204:207], v[60:63]
    ds_read_b128 a[44:47], v11 offset:45056
    v_sub_f32 v82, 0, v36
    v_sub_f32 v86, 0, v37
    v_sub_f32 v83, 0, v36
    v_sub_f32 v87, 0, v37
    s_waitcnt lgkmcnt(4)
    v_mfma_f32_16x16x32_bf16 v[64:67], a[16:19], v[176:179], v[80:83]
    v_sub_f32 v48, v48, v36
    v_sub_f32 v49, v49, v36
    v_exp_f32 v48, v48
    v_mfma_f32_16x16x32_bf16 v[72:75], a[16:19], v[192:195], v[84:87]
    v_sub_f32 v50, v50, v36
    v_exp_f32 v49, v49
    v_mfma_f32_16x16x32_bf16 v[64:67], a[20:23], v[180:183], v[64:67]
    v_sub_f32 v51, v51, v36
    v_exp_f32 v50, v50
    v_cvt_pk_bf16_f32 v88, v48, v49
    v_mfma_f32_16x16x32_bf16 v[72:75], a[20:23], v[196:199], v[72:75]
    v_sub_f32 v52, v52, v36
    v_exp_f32 v51, v51
    v_mfma_f32_16x16x32_bf16 v[64:67], a[24:27], v[184:187], v[64:67]
    v_sub_f32 v53, v53, v36
    v_exp_f32 v52, v52
    v_cvt_pk_bf16_f32 v89, v50, v51
    v_sub_f32 v54, v54, v36
    v_exp_f32 v53, v53
    s_waitcnt lgkmcnt(0)
    v_mfma_f32_16x16x32_bf16 v[72:75], a[24:27], v[200:203], v[72:75]
    s_barrier
    v_mfma_f32_16x16x32_bf16 v[64:67], a[28:31], v[188:191], v[64:67]
    ds_read_b128 a[0:3], v8 offset:49152
    v_sub_f32 v55, v55, v36
    v_exp_f32 v54, v54
    v_cvt_pk_bf16_f32 v90, v52, v53
    v_mfma_f32_16x16x32_bf16 v[72:75], a[28:31], v[204:207], v[72:75]
    ds_read_b128 a[4:7], v9 offset:49152
    ds_read_b128 a[8:11], v10 offset:49152
    v_sub_f32 v56, v56, v37
    v_exp_f32 v55, v55
    v_mfma_f32_16x16x32_bf16 v[68:71], a[32:35], v[176:179], v[80:83]
    v_sub_f32 v57, v57, v37
    v_exp_f32 v56, v56
    v_cvt_pk_bf16_f32 v91, v54, v55
    v_mfma_f32_16x16x32_bf16 v[76:79], a[32:35], v[192:195], v[84:87]
    ds_read_b128 a[12:15], v11 offset:49152
    ds_read_b128 a[16:19], v8 offset:53248
    v_sub_f32 v58, v58, v37
    v_exp_f32 v57, v57
    v_mfma_f32_16x16x32_bf16 v[68:71], a[36:39], v[180:183], v[68:71]
    v_sub_f32 v59, v59, v37
    v_exp_f32 v58, v58
    v_cvt_pk_bf16_f32 v92, v56, v57
    v_mfma_f32_16x16x32_bf16 v[76:79], a[36:39], v[196:199], v[76:79]
    ds_read_b128 a[20:23], v9 offset:53248
    v_sub_f32 v60, v60, v37
    v_exp_f32 v59, v59
    v_mfma_f32_16x16x32_bf16 v[68:71], a[40:43], v[184:187], v[68:71]
    v_sub_f32 v61, v61, v37
    v_exp_f32 v60, v60
    v_cvt_pk_bf16_f32 v93, v58, v59
    v_mfma_f32_16x16x32_bf16 v[76:79], a[40:43], v[200:203], v[76:79]
    ds_read_b128 a[24:27], v10 offset:53248
    v_sub_f32 v62, v62, v37
    v_exp_f32 v61, v61
    v_mfma_f32_16x16x32_bf16 v[68:71], a[44:47], v[188:191], v[68:71]
    v_sub_f32 v63, v63, v37
    v_exp_f32 v62, v62
    v_cvt_pk_bf16_f32 v94, v60, v61
    v_mfma_f32_16x16x32_bf16 v[76:79], a[44:47], v[204:207], v[76:79]
    ds_read_b128 a[28:31], v11 offset:53248
    v_exp_f32 v63, v63
    s_nop 0
    v_cvt_pk_bf16_f32 v95, v62, v63
    s_waitcnt lgkmcnt(4)
    v_mfma_f32_16x16x32_bf16 v[48:51], a[0:3], v[176:179], v[80:83]
    v_exp_f32 v64, v64
    v_mfma_f32_16x16x32_bf16 v[56:59], a[0:3], v[192:195], v[84:87]
    ds_read_b64_tr_b16 a[32:33], v16 offset:49152
    ds_read_b64_tr_b16 a[34:35], v16 offset:53248
    v_mfma_f32_16x16x32_bf16 v[48:51], a[4:7], v[180:183], v[48:51]
    v_exp_f32 v65, v65
    v_mfma_f32_16x16x32_bf16 v[56:59], a[4:7], v[196:199], v[56:59]
    ds_read_b64_tr_b16 a[36:37], v17 offset:49152
    ds_read_b64_tr_b16 a[38:39], v17 offset:53248
    v_mfma_f32_16x16x32_bf16 v[48:51], a[8:11], v[184:187], v[48:51]
    v_exp_f32 v66, v66
    v_mfma_f32_16x16x32_bf16 v[56:59], a[8:11], v[200:203], v[56:59]
    ds_read_b64_tr_b16 a[40:41], v18 offset:49152
    ds_read_b64_tr_b16 a[42:43], v18 offset:53248
    v_mfma_f32_16x16x32_bf16 v[48:51], a[12:15], v[188:191], v[48:51]
    v_exp_f32 v67, v67
    v_mfma_f32_16x16x32_bf16 v[56:59], a[12:15], v[204:207], v[56:59]
    ds_read_b64_tr_b16 a[44:45], v19 offset:49152
    ds_read_b64_tr_b16 a[46:47], v19 offset:53248
    v_mfma_f32_16x16x32_bf16 v[104:107], v[44:47], v[88:91], 0
    s_waitcnt lgkmcnt(8)
    v_mfma_f32_16x16x32_bf16 v[52:55], a[16:19], v[176:179], v[80:83]
    v_exp_f32 v68, v68
    v_mfma_f32_16x16x32_bf16 v[60:63], a[16:19], v[192:195], v[84:87]
    ds_read_b64_tr_b16 a[0:1], v20 offset:49152
    ds_read_b64_tr_b16 a[2:3], v20 offset:53248
    v_mfma_f32_16x16x32_bf16 v[52:55], a[20:23], v[180:183], v[52:55]
    v_exp_f32 v69, v69
    v_mfma_f32_16x16x32_bf16 v[60:63], a[20:23], v[196:199], v[60:63]
    ds_read_b64_tr_b16 a[4:5], v21 offset:49152
    ds_read_b64_tr_b16 a[6:7], v21 offset:53248
    v_mfma_f32_16x16x32_bf16 v[52:55], a[24:27], v[184:187], v[52:55]
    v_exp_f32 v70, v70
    v_mfma_f32_16x16x32_bf16 v[60:63], a[24:27], v[200:203], v[60:63]
    ds_read_b64_tr_b16 a[8:9], v22 offset:49152
    ds_read_b64_tr_b16 a[10:11], v22 offset:53248
    v_mfma_f32_16x16x32_bf16 v[52:55], a[28:31], v[188:191], v[52:55]
    v_exp_f32 v71, v71
    v_mfma_f32_16x16x32_bf16 v[60:63], a[28:31], v[204:207], v[60:63]
    ds_read_b64_tr_b16 a[12:13], v23 offset:49152
    ds_read_b64_tr_b16 a[14:15], v23 offset:53248
    v_mfma_f32_16x16x32_bf16 v[108:111], v[44:47], v[92:95], 0
    s_waitcnt lgkmcnt(8)
    v_mfma_f32_16x16x32_bf16 v[112:115], a[32:35], v[88:91], 0
    v_exp_f32 v72, v72
    v_mfma_f32_16x16x32_bf16 v[116:119], a[32:35], v[92:95], 0
    ds_read_b128 a[16:19], v8 offset:57344
    v_cvt_pk_bf16_f32 v96, v64, v65
    v_mfma_f32_16x16x32_bf16 v[120:123], a[36:39], v[88:91], 0
    v_exp_f32 v73, v73
    v_mfma_f32_16x16x32_bf16 v[124:127], a[36:39], v[92:95], 0
    ds_read_b128 a[20:23], v9 offset:57344
    v_cvt_pk_bf16_f32 v97, v66, v67
    v_mfma_f32_16x16x32_bf16 v[128:131], a[40:43], v[88:91], 0
    v_exp_f32 v74, v74
    v_mfma_f32_16x16x32_bf16 v[132:135], a[40:43], v[92:95], 0
    ds_read_b128 a[24:27], v10 offset:57344
    v_cvt_pk_bf16_f32 v98, v68, v69
    v_mfma_f32_16x16x32_bf16 v[136:139], a[44:47], v[88:91], 0
    v_exp_f32 v75, v75
    v_mfma_f32_16x16x32_bf16 v[140:143], a[44:47], v[92:95], 0
    ds_read_b128 a[28:31], v11 offset:57344
    v_cvt_pk_bf16_f32 v99, v70, v71
    s_waitcnt lgkmcnt(4)
    v_mfma_f32_16x16x32_bf16 v[144:147], a[0:3], v[88:91], 0
    v_exp_f32 v76, v76
    v_mfma_f32_16x16x32_bf16 v[148:151], a[0:3], v[92:95], 0
    ds_read_b128 a[32:35], v8 offset:61440
    v_cvt_pk_bf16_f32 v100, v72, v73
    v_mfma_f32_16x16x32_bf16 v[152:155], a[4:7], v[88:91], 0
    v_exp_f32 v77, v77
    v_mfma_f32_16x16x32_bf16 v[156:159], a[4:7], v[92:95], 0
    ds_read_b128 a[36:39], v9 offset:61440
    v_cvt_pk_bf16_f32 v101, v74, v75
    v_mfma_f32_16x16x32_bf16 v[160:163], a[8:11], v[88:91], 0
    v_exp_f32 v78, v78
    v_mfma_f32_16x16x32_bf16 v[164:167], a[8:11], v[92:95], 0
    ds_read_b128 a[40:43], v10 offset:61440
    v_cvt_pk_bf16_f32 v102, v76, v77
    v_mfma_f32_16x16x32_bf16 v[168:171], a[12:15], v[88:91], 0
    v_exp_f32 v79, v79
    v_mfma_f32_16x16x32_bf16 v[172:175], a[12:15], v[92:95], 0
    ds_read_b128 a[44:47], v11 offset:61440
    v_cvt_pk_bf16_f32 v103, v78, v79
    s_waitcnt lgkmcnt(4)
    v_mfma_f32_16x16x32_bf16 v[64:67], a[16:19], v[176:179], v[80:83]
    v_exp_f32 v48, v48
    v_mfma_f32_16x16x32_bf16 v[72:75], a[16:19], v[192:195], v[84:87]
    ds_read_b64_tr_b16 a[0:1], v16 offset:57344
    ds_read_b64_tr_b16 a[2:3], v16 offset:61440
    v_mfma_f32_16x16x32_bf16 v[64:67], a[20:23], v[180:183], v[64:67]
    v_exp_f32 v49, v49
    v_mfma_f32_16x16x32_bf16 v[72:75], a[20:23], v[196:199], v[72:75]
    ds_read_b64_tr_b16 a[4:5], v17 offset:57344
    ds_read_b64_tr_b16 a[6:7], v17 offset:61440
    v_mfma_f32_16x16x32_bf16 v[64:67], a[24:27], v[184:187], v[64:67]
    v_exp_f32 v50, v50
    v_mfma_f32_16x16x32_bf16 v[72:75], a[24:27], v[200:203], v[72:75]
    ds_read_b64_tr_b16 a[8:9], v18 offset:57344
    ds_read_b64_tr_b16 a[10:11], v18 offset:61440
    v_mfma_f32_16x16x32_bf16 v[64:67], a[28:31], v[188:191], v[64:67]
    v_exp_f32 v51, v51
    v_mfma_f32_16x16x32_bf16 v[72:75], a[28:31], v[204:207], v[72:75]
    ds_read_b64_tr_b16 a[12:13], v19 offset:57344
    ds_read_b64_tr_b16 a[14:15], v19 offset:61440
    v_mfma_f32_16x16x32_bf16 v[104:107], v[44:47], v[96:99], v[104:107]
    s_waitcnt lgkmcnt(8)
    v_mfma_f32_16x16x32_bf16 v[68:71], a[32:35], v[176:179], v[80:83]
    v_exp_f32 v52, v52
    v_mfma_f32_16x16x32_bf16 v[76:79], a[32:35], v[192:195], v[84:87]
    ds_read_b64_tr_b16 a[16:17], v20 offset:57344
    ds_read_b64_tr_b16 a[18:19], v20 offset:61440
    v_mfma_f32_16x16x32_bf16 v[68:71], a[36:39], v[180:183], v[68:71]
    v_exp_f32 v53, v53
    v_mfma_f32_16x16x32_bf16 v[76:79], a[36:39], v[196:199], v[76:79]
    ds_read_b64_tr_b16 a[20:21], v21 offset:57344
    ds_read_b64_tr_b16 a[22:23], v21 offset:61440
    v_mfma_f32_16x16x32_bf16 v[68:71], a[40:43], v[184:187], v[68:71]
    v_exp_f32 v54, v54
    v_mfma_f32_16x16x32_bf16 v[76:79], a[40:43], v[200:203], v[76:79]
    ds_read_b64_tr_b16 a[24:25], v22 offset:57344
    ds_read_b64_tr_b16 a[26:27], v22 offset:61440
    v_mfma_f32_16x16x32_bf16 v[68:71], a[44:47], v[188:191], v[68:71]
    v_exp_f32 v55, v55
    v_mfma_f32_16x16x32_bf16 v[76:79], a[44:47], v[204:207], v[76:79]
    ds_read_b64_tr_b16 a[28:29], v23 offset:57344
    ds_read_b64_tr_b16 a[30:31], v23 offset:61440
    v_mfma_f32_16x16x32_bf16 v[108:111], v[44:47], v[100:103], v[108:111]
    s_waitcnt lgkmcnt(8)
    v_mfma_f32_16x16x32_bf16 v[112:115], a[0:3], v[96:99], v[112:115]
    v_exp_f32 v56, v56
    v_mfma_f32_16x16x32_bf16 v[116:119], a[0:3], v[100:103], v[116:119]
    v_cvt_pk_bf16_f32 v88, v48, v49
    v_mfma_f32_16x16x32_bf16 v[120:123], a[4:7], v[96:99], v[120:123]
    v_exp_f32 v57, v57
    v_mfma_f32_16x16x32_bf16 v[124:127], a[4:7], v[100:103], v[124:127]
    v_cvt_pk_bf16_f32 v89, v50, v51
    v_mfma_f32_16x16x32_bf16 v[128:131], a[8:11], v[96:99], v[128:131]
    v_exp_f32 v58, v58
    v_cvt_pk_bf16_f32 v90, v52, v53
    s_waitcnt lgkmcnt(0)
    v_mfma_f32_16x16x32_bf16 v[132:135], a[8:11], v[100:103], v[132:135]
    s_barrier
    v_mfma_f32_16x16x32_bf16 v[136:139], a[12:15], v[96:99], v[136:139]
    ds_read_b128 a[32:35], v8 offset:0
    v_exp_f32 v59, v59
    v_mfma_f32_16x16x32_bf16 v[140:143], a[12:15], v[100:103], v[140:143]
    ds_read_b128 a[36:39], v9 offset:0
    ds_read_b128 a[40:43], v10 offset:0
    v_cvt_pk_bf16_f32 v91, v54, v55
    v_mfma_f32_16x16x32_bf16 v[144:147], a[16:19], v[96:99], v[144:147]
    v_exp_f32 v60, v60
    v_mfma_f32_16x16x32_bf16 v[148:151], a[16:19], v[100:103], v[148:151]
    ds_read_b128 a[44:47], v11 offset:0
    ds_read_b128 a[0:3], v8 offset:4096
    v_cvt_pk_bf16_f32 v92, v56, v57
    v_mfma_f32_16x16x32_bf16 v[152:155], a[20:23], v[96:99], v[152:155]
    v_exp_f32 v61, v61
    v_mfma_f32_16x16x32_bf16 v[156:159], a[20:23], v[100:103], v[156:159]
    ds_read_b128 a[4:7], v9 offset:4096
    v_cvt_pk_bf16_f32 v93, v58, v59
    v_mfma_f32_16x16x32_bf16 v[160:163], a[24:27], v[96:99], v[160:163]
    v_exp_f32 v62, v62
    v_mfma_f32_16x16x32_bf16 v[164:167], a[24:27], v[100:103], v[164:167]
    ds_read_b128 a[8:11], v10 offset:4096
    v_cvt_pk_bf16_f32 v94, v60, v61
    v_mfma_f32_16x16x32_bf16 v[168:171], a[28:31], v[96:99], v[168:171]
    v_exp_f32 v63, v63
    v_mfma_f32_16x16x32_bf16 v[172:175], a[28:31], v[100:103], v[172:175]
    ds_read_b128 a[12:15], v11 offset:4096
    v_cvt_pk_bf16_f32 v95, v62, v63
    s_waitcnt lgkmcnt(4)
    v_mfma_f32_16x16x32_bf16 v[48:51], a[32:35], v[176:179], v[80:83]
    v_exp_f32 v64, v64
    v_mfma_f32_16x16x32_bf16 v[56:59], a[32:35], v[192:195], v[84:87]
    ds_read_b64_tr_b16 a[16:17], v16 offset:0
    ds_read_b64_tr_b16 a[18:19], v16 offset:4096
    v_mfma_f32_16x16x32_bf16 v[48:51], a[36:39], v[180:183], v[48:51]
    v_exp_f32 v65, v65
    v_mfma_f32_16x16x32_bf16 v[56:59], a[36:39], v[196:199], v[56:59]
    ds_read_b64_tr_b16 a[20:21], v17 offset:0
    ds_read_b64_tr_b16 a[22:23], v17 offset:4096
    v_mfma_f32_16x16x32_bf16 v[48:51], a[40:43], v[184:187], v[48:51]
    v_exp_f32 v66, v66
    v_mfma_f32_16x16x32_bf16 v[56:59], a[40:43], v[200:203], v[56:59]
    ds_read_b64_tr_b16 a[24:25], v18 offset:0
    ds_read_b64_tr_b16 a[26:27], v18 offset:4096
    v_mfma_f32_16x16x32_bf16 v[48:51], a[44:47], v[188:191], v[48:51]
    v_exp_f32 v67, v67
    v_mfma_f32_16x16x32_bf16 v[56:59], a[44:47], v[204:207], v[56:59]
    ds_read_b64_tr_b16 a[28:29], v19 offset:0
    ds_read_b64_tr_b16 a[30:31], v19 offset:4096
    v_mfma_f32_16x16x32_bf16 v[104:107], v[44:47], v[88:91], v[104:107]
    s_waitcnt lgkmcnt(8)
    v_mfma_f32_16x16x32_bf16 v[52:55], a[0:3], v[176:179], v[80:83]
    v_exp_f32 v68, v68
    v_mfma_f32_16x16x32_bf16 v[60:63], a[0:3], v[192:195], v[84:87]
    ds_read_b64_tr_b16 a[32:33], v20 offset:0
    ds_read_b64_tr_b16 a[34:35], v20 offset:4096
    v_mfma_f32_16x16x32_bf16 v[52:55], a[4:7], v[180:183], v[52:55]
    v_exp_f32 v69, v69
    v_mfma_f32_16x16x32_bf16 v[60:63], a[4:7], v[196:199], v[60:63]
    ds_read_b64_tr_b16 a[36:37], v21 offset:0
    ds_read_b64_tr_b16 a[38:39], v21 offset:4096
    v_mfma_f32_16x16x32_bf16 v[52:55], a[8:11], v[184:187], v[52:55]
    v_exp_f32 v70, v70
    v_mfma_f32_16x16x32_bf16 v[60:63], a[8:11], v[200:203], v[60:63]
    ds_read_b64_tr_b16 a[40:41], v22 offset:0
    ds_read_b64_tr_b16 a[42:43], v22 offset:4096
    v_mfma_f32_16x16x32_bf16 v[52:55], a[12:15], v[188:191], v[52:55]
    v_exp_f32 v71, v71
    v_mfma_f32_16x16x32_bf16 v[60:63], a[12:15], v[204:207], v[60:63]
    ds_read_b64_tr_b16 a[44:45], v23 offset:0
    ds_read_b64_tr_b16 a[46:47], v23 offset:4096
    v_mfma_f32_16x16x32_bf16 v[108:111], v[44:47], v[92:95], v[108:111]
    s_waitcnt lgkmcnt(8)
    v_mfma_f32_16x16x32_bf16 v[112:115], a[16:19], v[88:91], v[112:115]
    v_exp_f32 v72, v72
    v_mfma_f32_16x16x32_bf16 v[116:119], a[16:19], v[92:95], v[116:119]
    ds_read_b128 a[0:3], v8 offset:8192
    v_cvt_pk_bf16_f32 v96, v64, v65
    v_mfma_f32_16x16x32_bf16 v[120:123], a[20:23], v[88:91], v[120:123]
    v_exp_f32 v73, v73
    v_mfma_f32_16x16x32_bf16 v[124:127], a[20:23], v[92:95], v[124:127]
    ds_read_b128 a[4:7], v9 offset:8192
    v_cvt_pk_bf16_f32 v97, v66, v67
    v_mfma_f32_16x16x32_bf16 v[128:131], a[24:27], v[88:91], v[128:131]
    v_exp_f32 v74, v74
    v_mfma_f32_16x16x32_bf16 v[132:135], a[24:27], v[92:95], v[132:135]
    ds_read_b128 a[8:11], v10 offset:8192
    v_cvt_pk_bf16_f32 v98, v68, v69
    v_mfma_f32_16x16x32_bf16 v[136:139], a[28:31], v[88:91], v[136:139]
    v_exp_f32 v75, v75
    v_mfma_f32_16x16x32_bf16 v[140:143], a[28:31], v[92:95], v[140:143]
    ds_read_b128 a[12:15], v11 offset:8192
    v_cvt_pk_bf16_f32 v99, v70, v71
    s_waitcnt lgkmcnt(4)
    v_mfma_f32_16x16x32_bf16 v[144:147], a[32:35], v[88:91], v[144:147]
    v_exp_f32 v76, v76
    v_mfma_f32_16x16x32_bf16 v[148:151], a[32:35], v[92:95], v[148:151]
    ds_read_b128 a[16:19], v8 offset:12288
    v_cvt_pk_bf16_f32 v100, v72, v73
    v_mfma_f32_16x16x32_bf16 v[152:155], a[36:39], v[88:91], v[152:155]
    v_exp_f32 v77, v77
    v_mfma_f32_16x16x32_bf16 v[156:159], a[36:39], v[92:95], v[156:159]
    ds_read_b128 a[20:23], v9 offset:12288
    v_cvt_pk_bf16_f32 v101, v74, v75
    v_mfma_f32_16x16x32_bf16 v[160:163], a[40:43], v[88:91], v[160:163]
    v_exp_f32 v78, v78
    v_mfma_f32_16x16x32_bf16 v[164:167], a[40:43], v[92:95], v[164:167]
    ds_read_b128 a[24:27], v10 offset:12288
    v_cvt_pk_bf16_f32 v102, v76, v77
    v_mfma_f32_16x16x32_bf16 v[168:171], a[44:47], v[88:91], v[168:171]
    v_exp_f32 v79, v79
    v_mfma_f32_16x16x32_bf16 v[172:175], a[44:47], v[92:95], v[172:175]
    ds_read_b128 a[28:31], v11 offset:12288
    v_cvt_pk_bf16_f32 v103, v78, v79
    s_waitcnt lgkmcnt(4)
    v_mfma_f32_16x16x32_bf16 v[64:67], a[0:3], v[176:179], v[80:83]
    v_exp_f32 v48, v48
    v_mfma_f32_16x16x32_bf16 v[72:75], a[0:3], v[192:195], v[84:87]
    ds_read_b64_tr_b16 a[32:33], v16 offset:8192
    ds_read_b64_tr_b16 a[34:35], v16 offset:12288
    v_mfma_f32_16x16x32_bf16 v[64:67], a[4:7], v[180:183], v[64:67]
    v_exp_f32 v49, v49
    v_mfma_f32_16x16x32_bf16 v[72:75], a[4:7], v[196:199], v[72:75]
    ds_read_b64_tr_b16 a[36:37], v17 offset:8192
    ds_read_b64_tr_b16 a[38:39], v17 offset:12288
    v_mfma_f32_16x16x32_bf16 v[64:67], a[8:11], v[184:187], v[64:67]
    v_exp_f32 v50, v50
    v_mfma_f32_16x16x32_bf16 v[72:75], a[8:11], v[200:203], v[72:75]
    ds_read_b64_tr_b16 a[40:41], v18 offset:8192
    ds_read_b64_tr_b16 a[42:43], v18 offset:12288
    v_mfma_f32_16x16x32_bf16 v[64:67], a[12:15], v[188:191], v[64:67]
    v_exp_f32 v51, v51
    v_mfma_f32_16x16x32_bf16 v[72:75], a[12:15], v[204:207], v[72:75]
    ds_read_b64_tr_b16 a[44:45], v19 offset:8192
    ds_read_b64_tr_b16 a[46:47], v19 offset:12288
    v_mfma_f32_16x16x32_bf16 v[104:107], v[44:47], v[96:99], v[104:107]
    s_waitcnt lgkmcnt(8)
    v_mfma_f32_16x16x32_bf16 v[68:71], a[16:19], v[176:179], v[80:83]
    v_exp_f32 v52, v52
    v_mfma_f32_16x16x32_bf16 v[76:79], a[16:19], v[192:195], v[84:87]
    ds_read_b64_tr_b16 a[0:1], v20 offset:8192
    ds_read_b64_tr_b16 a[2:3], v20 offset:12288
    v_mfma_f32_16x16x32_bf16 v[68:71], a[20:23], v[180:183], v[68:71]
    v_exp_f32 v53, v53
    v_mfma_f32_16x16x32_bf16 v[76:79], a[20:23], v[196:199], v[76:79]
    ds_read_b64_tr_b16 a[4:5], v21 offset:8192
    ds_read_b64_tr_b16 a[6:7], v21 offset:12288
    v_mfma_f32_16x16x32_bf16 v[68:71], a[24:27], v[184:187], v[68:71]
    v_exp_f32 v54, v54
    v_mfma_f32_16x16x32_bf16 v[76:79], a[24:27], v[200:203], v[76:79]
    ds_read_b64_tr_b16 a[8:9], v22 offset:8192
    ds_read_b64_tr_b16 a[10:11], v22 offset:12288
    v_mfma_f32_16x16x32_bf16 v[68:71], a[28:31], v[188:191], v[68:71]
    v_exp_f32 v55, v55
    v_mfma_f32_16x16x32_bf16 v[76:79], a[28:31], v[204:207], v[76:79]
    ds_read_b64_tr_b16 a[12:13], v23 offset:8192
    ds_read_b64_tr_b16 a[14:15], v23 offset:12288
    v_mfma_f32_16x16x32_bf16 v[108:111], v[44:47], v[100:103], v[108:111]
    s_waitcnt lgkmcnt(8)
    v_mfma_f32_16x16x32_bf16 v[112:115], a[32:35], v[96:99], v[112:115]
    v_exp_f32 v56, v56
    v_mfma_f32_16x16x32_bf16 v[116:119], a[32:35], v[100:103], v[116:119]
    v_cvt_pk_bf16_f32 v88, v48, v49
    v_mfma_f32_16x16x32_bf16 v[120:123], a[36:39], v[96:99], v[120:123]
    v_exp_f32 v57, v57
    v_mfma_f32_16x16x32_bf16 v[124:127], a[36:39], v[100:103], v[124:127]
    v_cvt_pk_bf16_f32 v89, v50, v51
    v_mfma_f32_16x16x32_bf16 v[128:131], a[40:43], v[96:99], v[128:131]
    v_exp_f32 v58, v58
    v_cvt_pk_bf16_f32 v90, v52, v53
    s_waitcnt lgkmcnt(0)
    v_mfma_f32_16x16x32_bf16 v[132:135], a[40:43], v[100:103], v[132:135]
    s_barrier
    v_mfma_f32_16x16x32_bf16 v[136:139], a[44:47], v[96:99], v[136:139]
    ds_read_b128 a[16:19], v8 offset:16384
    v_exp_f32 v59, v59
    v_mfma_f32_16x16x32_bf16 v[140:143], a[44:47], v[100:103], v[140:143]
    ds_read_b128 a[20:23], v9 offset:16384
    ds_read_b128 a[24:27], v10 offset:16384
    v_cvt_pk_bf16_f32 v91, v54, v55
    v_mfma_f32_16x16x32_bf16 v[144:147], a[0:3], v[96:99], v[144:147]
    v_exp_f32 v60, v60
    v_mfma_f32_16x16x32_bf16 v[148:151], a[0:3], v[100:103], v[148:151]
    ds_read_b128 a[28:31], v11 offset:16384
    ds_read_b128 a[32:35], v8 offset:20480
    v_cvt_pk_bf16_f32 v92, v56, v57
    v_mfma_f32_16x16x32_bf16 v[152:155], a[4:7], v[96:99], v[152:155]
    v_exp_f32 v61, v61
    v_mfma_f32_16x16x32_bf16 v[156:159], a[4:7], v[100:103], v[156:159]
    ds_read_b128 a[36:39], v9 offset:20480
    v_cvt_pk_bf16_f32 v93, v58, v59
    v_mfma_f32_16x16x32_bf16 v[160:163], a[8:11], v[96:99], v[160:163]
    v_exp_f32 v62, v62
    v_mfma_f32_16x16x32_bf16 v[164:167], a[8:11], v[100:103], v[164:167]
    ds_read_b128 a[40:43], v10 offset:20480
    v_cvt_pk_bf16_f32 v94, v60, v61
    v_mfma_f32_16x16x32_bf16 v[168:171], a[12:15], v[96:99], v[168:171]
    v_exp_f32 v63, v63
    v_mfma_f32_16x16x32_bf16 v[172:175], a[12:15], v[100:103], v[172:175]
    ds_read_b128 a[44:47], v11 offset:20480
    v_cvt_pk_bf16_f32 v95, v62, v63
    s_waitcnt lgkmcnt(4)
    v_mfma_f32_16x16x32_bf16 v[48:51], a[16:19], v[176:179], v[80:83]
    v_exp_f32 v64, v64
    v_mfma_f32_16x16x32_bf16 v[56:59], a[16:19], v[192:195], v[84:87]
    ds_read_b64_tr_b16 a[0:1], v16 offset:16384
    ds_read_b64_tr_b16 a[2:3], v16 offset:20480
    v_mfma_f32_16x16x32_bf16 v[48:51], a[20:23], v[180:183], v[48:51]
    v_exp_f32 v65, v65
    v_mfma_f32_16x16x32_bf16 v[56:59], a[20:23], v[196:199], v[56:59]
    ds_read_b64_tr_b16 a[4:5], v17 offset:16384
    ds_read_b64_tr_b16 a[6:7], v17 offset:20480
    v_mfma_f32_16x16x32_bf16 v[48:51], a[24:27], v[184:187], v[48:51]
    v_exp_f32 v66, v66
    v_mfma_f32_16x16x32_bf16 v[56:59], a[24:27], v[200:203], v[56:59]
    ds_read_b64_tr_b16 a[8:9], v18 offset:16384
    ds_read_b64_tr_b16 a[10:11], v18 offset:20480
    v_mfma_f32_16x16x32_bf16 v[48:51], a[28:31], v[188:191], v[48:51]
    v_exp_f32 v67, v67
    v_mfma_f32_16x16x32_bf16 v[56:59], a[28:31], v[204:207], v[56:59]
    ds_read_b64_tr_b16 a[12:13], v19 offset:16384
    ds_read_b64_tr_b16 a[14:15], v19 offset:20480
    v_mfma_f32_16x16x32_bf16 v[104:107], v[44:47], v[88:91], v[104:107]
    s_waitcnt lgkmcnt(8)
    v_mfma_f32_16x16x32_bf16 v[52:55], a[32:35], v[176:179], v[80:83]
    v_exp_f32 v68, v68
    v_mfma_f32_16x16x32_bf16 v[60:63], a[32:35], v[192:195], v[84:87]
    ds_read_b64_tr_b16 a[16:17], v20 offset:16384
    ds_read_b64_tr_b16 a[18:19], v20 offset:20480
    v_mfma_f32_16x16x32_bf16 v[52:55], a[36:39], v[180:183], v[52:55]
    v_exp_f32 v69, v69
    v_mfma_f32_16x16x32_bf16 v[60:63], a[36:39], v[196:199], v[60:63]
    ds_read_b64_tr_b16 a[20:21], v21 offset:16384
    ds_read_b64_tr_b16 a[22:23], v21 offset:20480
    v_mfma_f32_16x16x32_bf16 v[52:55], a[40:43], v[184:187], v[52:55]
    v_exp_f32 v70, v70
    v_mfma_f32_16x16x32_bf16 v[60:63], a[40:43], v[200:203], v[60:63]
    ds_read_b64_tr_b16 a[24:25], v22 offset:16384
    ds_read_b64_tr_b16 a[26:27], v22 offset:20480
    v_mfma_f32_16x16x32_bf16 v[52:55], a[44:47], v[188:191], v[52:55]
    v_exp_f32 v71, v71
    v_mfma_f32_16x16x32_bf16 v[60:63], a[44:47], v[204:207], v[60:63]
    ds_read_b64_tr_b16 a[28:29], v23 offset:16384
    ds_read_b64_tr_b16 a[30:31], v23 offset:20480
    v_mfma_f32_16x16x32_bf16 v[108:111], v[44:47], v[92:95], v[108:111]
    s_waitcnt lgkmcnt(8)
    v_mfma_f32_16x16x32_bf16 v[112:115], a[0:3], v[88:91], v[112:115]
    v_exp_f32 v72, v72
    v_mfma_f32_16x16x32_bf16 v[116:119], a[0:3], v[92:95], v[116:119]
    ds_read_b128 a[32:35], v8 offset:24576
    v_cvt_pk_bf16_f32 v96, v64, v65
    v_mfma_f32_16x16x32_bf16 v[120:123], a[4:7], v[88:91], v[120:123]
    v_exp_f32 v73, v73
    v_mfma_f32_16x16x32_bf16 v[124:127], a[4:7], v[92:95], v[124:127]
    ds_read_b128 a[36:39], v9 offset:24576
    v_cvt_pk_bf16_f32 v97, v66, v67
    v_mfma_f32_16x16x32_bf16 v[128:131], a[8:11], v[88:91], v[128:131]
    v_exp_f32 v74, v74
    v_mfma_f32_16x16x32_bf16 v[132:135], a[8:11], v[92:95], v[132:135]
    ds_read_b128 a[40:43], v10 offset:24576
    v_cvt_pk_bf16_f32 v98, v68, v69
    v_mfma_f32_16x16x32_bf16 v[136:139], a[12:15], v[88:91], v[136:139]
    v_exp_f32 v75, v75
    v_mfma_f32_16x16x32_bf16 v[140:143], a[12:15], v[92:95], v[140:143]
    ds_read_b128 a[44:47], v11 offset:24576
    v_cvt_pk_bf16_f32 v99, v70, v71
    s_waitcnt lgkmcnt(4)
    v_mfma_f32_16x16x32_bf16 v[144:147], a[16:19], v[88:91], v[144:147]
    v_exp_f32 v76, v76
    v_mfma_f32_16x16x32_bf16 v[148:151], a[16:19], v[92:95], v[148:151]
    ds_read_b128 a[0:3], v8 offset:28672
    v_cvt_pk_bf16_f32 v100, v72, v73
    v_mfma_f32_16x16x32_bf16 v[152:155], a[20:23], v[88:91], v[152:155]
    v_exp_f32 v77, v77
    v_mfma_f32_16x16x32_bf16 v[156:159], a[20:23], v[92:95], v[156:159]
    ds_read_b128 a[4:7], v9 offset:28672
    v_cvt_pk_bf16_f32 v101, v74, v75
    v_mfma_f32_16x16x32_bf16 v[160:163], a[24:27], v[88:91], v[160:163]
    v_exp_f32 v78, v78
    v_mfma_f32_16x16x32_bf16 v[164:167], a[24:27], v[92:95], v[164:167]
    ds_read_b128 a[8:11], v10 offset:28672
    v_cvt_pk_bf16_f32 v102, v76, v77
    v_mfma_f32_16x16x32_bf16 v[168:171], a[28:31], v[88:91], v[168:171]
    v_exp_f32 v79, v79
    v_mfma_f32_16x16x32_bf16 v[172:175], a[28:31], v[92:95], v[172:175]
    ds_read_b128 a[12:15], v11 offset:28672
    v_cvt_pk_bf16_f32 v103, v78, v79
    s_waitcnt lgkmcnt(4)
    v_mfma_f32_16x16x32_bf16 v[64:67], a[32:35], v[176:179], v[80:83]
    v_exp_f32 v48, v48
    v_mfma_f32_16x16x32_bf16 v[72:75], a[32:35], v[192:195], v[84:87]
    ds_read_b64_tr_b16 a[16:17], v16 offset:24576
    ds_read_b64_tr_b16 a[18:19], v16 offset:28672
    v_mfma_f32_16x16x32_bf16 v[64:67], a[36:39], v[180:183], v[64:67]
    v_exp_f32 v49, v49
    v_mfma_f32_16x16x32_bf16 v[72:75], a[36:39], v[196:199], v[72:75]
    ds_read_b64_tr_b16 a[20:21], v17 offset:24576
    ds_read_b64_tr_b16 a[22:23], v17 offset:28672
    v_mfma_f32_16x16x32_bf16 v[64:67], a[40:43], v[184:187], v[64:67]
    v_exp_f32 v50, v50
    v_mfma_f32_16x16x32_bf16 v[72:75], a[40:43], v[200:203], v[72:75]
    ds_read_b64_tr_b16 a[24:25], v18 offset:24576
    ds_read_b64_tr_b16 a[26:27], v18 offset:28672
    v_mfma_f32_16x16x32_bf16 v[64:67], a[44:47], v[188:191], v[64:67]
    v_exp_f32 v51, v51
    v_mfma_f32_16x16x32_bf16 v[72:75], a[44:47], v[204:207], v[72:75]
    ds_read_b64_tr_b16 a[28:29], v19 offset:24576
    ds_read_b64_tr_b16 a[30:31], v19 offset:28672
    v_mfma_f32_16x16x32_bf16 v[104:107], v[44:47], v[96:99], v[104:107]
    s_waitcnt lgkmcnt(8)
    v_mfma_f32_16x16x32_bf16 v[68:71], a[0:3], v[176:179], v[80:83]
    v_exp_f32 v52, v52
    v_mfma_f32_16x16x32_bf16 v[76:79], a[0:3], v[192:195], v[84:87]
    ds_read_b64_tr_b16 a[32:33], v20 offset:24576
    ds_read_b64_tr_b16 a[34:35], v20 offset:28672
    v_mfma_f32_16x16x32_bf16 v[68:71], a[4:7], v[180:183], v[68:71]
    v_exp_f32 v53, v53
    v_mfma_f32_16x16x32_bf16 v[76:79], a[4:7], v[196:199], v[76:79]
    ds_read_b64_tr_b16 a[36:37], v21 offset:24576
    ds_read_b64_tr_b16 a[38:39], v21 offset:28672
    v_mfma_f32_16x16x32_bf16 v[68:71], a[8:11], v[184:187], v[68:71]
    v_exp_f32 v54, v54
    v_mfma_f32_16x16x32_bf16 v[76:79], a[8:11], v[200:203], v[76:79]
    ds_read_b64_tr_b16 a[40:41], v22 offset:24576
    ds_read_b64_tr_b16 a[42:43], v22 offset:28672
    v_mfma_f32_16x16x32_bf16 v[68:71], a[12:15], v[188:191], v[68:71]
    v_exp_f32 v55, v55
    v_mfma_f32_16x16x32_bf16 v[76:79], a[12:15], v[204:207], v[76:79]
    ds_read_b64_tr_b16 a[44:45], v23 offset:24576
    ds_read_b64_tr_b16 a[46:47], v23 offset:28672
    v_mfma_f32_16x16x32_bf16 v[108:111], v[44:47], v[100:103], v[108:111]
    s_waitcnt lgkmcnt(8)
    v_mfma_f32_16x16x32_bf16 v[112:115], a[16:19], v[96:99], v[112:115]
    v_exp_f32 v56, v56
    v_mfma_f32_16x16x32_bf16 v[116:119], a[16:19], v[100:103], v[116:119]
    v_cvt_pk_bf16_f32 v88, v48, v49
    v_mfma_f32_16x16x32_bf16 v[120:123], a[20:23], v[96:99], v[120:123]
    v_exp_f32 v57, v57
    v_mfma_f32_16x16x32_bf16 v[124:127], a[20:23], v[100:103], v[124:127]
    v_cvt_pk_bf16_f32 v89, v50, v51
    v_mfma_f32_16x16x32_bf16 v[128:131], a[24:27], v[96:99], v[128:131]
    v_exp_f32 v58, v58
    v_cvt_pk_bf16_f32 v90, v52, v53
    s_waitcnt lgkmcnt(0)
    v_mfma_f32_16x16x32_bf16 v[132:135], a[24:27], v[100:103], v[132:135]
    s_barrier
    v_mfma_f32_16x16x32_bf16 v[136:139], a[28:31], v[96:99], v[136:139]
    ds_read_b128 a[0:3], v8 offset:32768
    v_exp_f32 v59, v59
    v_mfma_f32_16x16x32_bf16 v[140:143], a[28:31], v[100:103], v[140:143]
    ds_read_b128 a[4:7], v9 offset:32768
    ds_read_b128 a[8:11], v10 offset:32768
    v_cvt_pk_bf16_f32 v91, v54, v55
    v_mfma_f32_16x16x32_bf16 v[144:147], a[32:35], v[96:99], v[144:147]
    v_exp_f32 v60, v60
    v_mfma_f32_16x16x32_bf16 v[148:151], a[32:35], v[100:103], v[148:151]
    ds_read_b128 a[12:15], v11 offset:32768
    ds_read_b128 a[16:19], v8 offset:36864
    v_cvt_pk_bf16_f32 v92, v56, v57
    v_mfma_f32_16x16x32_bf16 v[152:155], a[36:39], v[96:99], v[152:155]
    v_exp_f32 v61, v61
    v_mfma_f32_16x16x32_bf16 v[156:159], a[36:39], v[100:103], v[156:159]
    ds_read_b128 a[20:23], v9 offset:36864
    v_cvt_pk_bf16_f32 v93, v58, v59
    v_mfma_f32_16x16x32_bf16 v[160:163], a[40:43], v[96:99], v[160:163]
    v_exp_f32 v62, v62
    v_mfma_f32_16x16x32_bf16 v[164:167], a[40:43], v[100:103], v[164:167]
    ds_read_b128 a[24:27], v10 offset:36864
    v_cvt_pk_bf16_f32 v94, v60, v61
    v_mfma_f32_16x16x32_bf16 v[168:171], a[44:47], v[96:99], v[168:171]
    v_exp_f32 v63, v63
    v_mfma_f32_16x16x32_bf16 v[172:175], a[44:47], v[100:103], v[172:175]
    ds_read_b128 a[28:31], v11 offset:36864
    v_cvt_pk_bf16_f32 v95, v62, v63
    s_waitcnt lgkmcnt(4)
    v_mfma_f32_16x16x32_bf16 v[48:51], a[0:3], v[176:179], v[80:83]
    v_exp_f32 v64, v64
    v_mfma_f32_16x16x32_bf16 v[56:59], a[0:3], v[192:195], v[84:87]
    ds_read_b64_tr_b16 a[32:33], v16 offset:32768
    ds_read_b64_tr_b16 a[34:35], v16 offset:36864
    v_mfma_f32_16x16x32_bf16 v[48:51], a[4:7], v[180:183], v[48:51]
    v_exp_f32 v65, v65
    v_mfma_f32_16x16x32_bf16 v[56:59], a[4:7], v[196:199], v[56:59]
    ds_read_b64_tr_b16 a[36:37], v17 offset:32768
    ds_read_b64_tr_b16 a[38:39], v17 offset:36864
    v_mfma_f32_16x16x32_bf16 v[48:51], a[8:11], v[184:187], v[48:51]
    v_exp_f32 v66, v66
    v_mfma_f32_16x16x32_bf16 v[56:59], a[8:11], v[200:203], v[56:59]
    ds_read_b64_tr_b16 a[40:41], v18 offset:32768
    ds_read_b64_tr_b16 a[42:43], v18 offset:36864
    v_mfma_f32_16x16x32_bf16 v[48:51], a[12:15], v[188:191], v[48:51]
    v_exp_f32 v67, v67
    v_mfma_f32_16x16x32_bf16 v[56:59], a[12:15], v[204:207], v[56:59]
    ds_read_b64_tr_b16 a[44:45], v19 offset:32768
    ds_read_b64_tr_b16 a[46:47], v19 offset:36864
    v_mfma_f32_16x16x32_bf16 v[104:107], v[44:47], v[88:91], v[104:107]
    s_waitcnt lgkmcnt(8)
    v_mfma_f32_16x16x32_bf16 v[52:55], a[16:19], v[176:179], v[80:83]
    v_exp_f32 v68, v68
    v_mfma_f32_16x16x32_bf16 v[60:63], a[16:19], v[192:195], v[84:87]
    ds_read_b64_tr_b16 a[0:1], v20 offset:32768
    ds_read_b64_tr_b16 a[2:3], v20 offset:36864
    v_mfma_f32_16x16x32_bf16 v[52:55], a[20:23], v[180:183], v[52:55]
    v_exp_f32 v69, v69
    v_mfma_f32_16x16x32_bf16 v[60:63], a[20:23], v[196:199], v[60:63]
    ds_read_b64_tr_b16 a[4:5], v21 offset:32768
    ds_read_b64_tr_b16 a[6:7], v21 offset:36864
    v_mfma_f32_16x16x32_bf16 v[52:55], a[24:27], v[184:187], v[52:55]
    v_exp_f32 v70, v70
    v_mfma_f32_16x16x32_bf16 v[60:63], a[24:27], v[200:203], v[60:63]
    ds_read_b64_tr_b16 a[8:9], v22 offset:32768
    ds_read_b64_tr_b16 a[10:11], v22 offset:36864
    v_mfma_f32_16x16x32_bf16 v[52:55], a[28:31], v[188:191], v[52:55]
    v_exp_f32 v71, v71
    v_mfma_f32_16x16x32_bf16 v[60:63], a[28:31], v[204:207], v[60:63]
    ds_read_b64_tr_b16 a[12:13], v23 offset:32768
    ds_read_b64_tr_b16 a[14:15], v23 offset:36864
    v_mfma_f32_16x16x32_bf16 v[108:111], v[44:47], v[92:95], v[108:111]
    s_waitcnt lgkmcnt(8)
    v_mfma_f32_16x16x32_bf16 v[112:115], a[32:35], v[88:91], v[112:115]
    v_exp_f32 v72, v72
    v_mfma_f32_16x16x32_bf16 v[116:119], a[32:35], v[92:95], v[116:119]
    ds_read_b128 a[16:19], v8 offset:40960
    v_cvt_pk_bf16_f32 v96, v64, v65
    v_mfma_f32_16x16x32_bf16 v[120:123], a[36:39], v[88:91], v[120:123]
    v_exp_f32 v73, v73
    v_mfma_f32_16x16x32_bf16 v[124:127], a[36:39], v[92:95], v[124:127]
    ds_read_b128 a[20:23], v9 offset:40960
    v_cvt_pk_bf16_f32 v97, v66, v67
    v_mfma_f32_16x16x32_bf16 v[128:131], a[40:43], v[88:91], v[128:131]
    v_exp_f32 v74, v74
    v_mfma_f32_16x16x32_bf16 v[132:135], a[40:43], v[92:95], v[132:135]
    ds_read_b128 a[24:27], v10 offset:40960
    v_cvt_pk_bf16_f32 v98, v68, v69
    v_mfma_f32_16x16x32_bf16 v[136:139], a[44:47], v[88:91], v[136:139]
    v_exp_f32 v75, v75
    v_mfma_f32_16x16x32_bf16 v[140:143], a[44:47], v[92:95], v[140:143]
    ds_read_b128 a[28:31], v11 offset:40960
    v_cvt_pk_bf16_f32 v99, v70, v71
    s_waitcnt lgkmcnt(4)
    v_mfma_f32_16x16x32_bf16 v[144:147], a[0:3], v[88:91], v[144:147]
    v_exp_f32 v76, v76
    v_mfma_f32_16x16x32_bf16 v[148:151], a[0:3], v[92:95], v[148:151]
    ds_read_b128 a[32:35], v8 offset:45056
    v_cvt_pk_bf16_f32 v100, v72, v73
    v_mfma_f32_16x16x32_bf16 v[152:155], a[4:7], v[88:91], v[152:155]
    v_exp_f32 v77, v77
    v_mfma_f32_16x16x32_bf16 v[156:159], a[4:7], v[92:95], v[156:159]
    ds_read_b128 a[36:39], v9 offset:45056
    v_cvt_pk_bf16_f32 v101, v74, v75
    v_mfma_f32_16x16x32_bf16 v[160:163], a[8:11], v[88:91], v[160:163]
    v_exp_f32 v78, v78
    v_mfma_f32_16x16x32_bf16 v[164:167], a[8:11], v[92:95], v[164:167]
    ds_read_b128 a[40:43], v10 offset:45056
    v_cvt_pk_bf16_f32 v102, v76, v77
    v_mfma_f32_16x16x32_bf16 v[168:171], a[12:15], v[88:91], v[168:171]
    v_exp_f32 v79, v79
    v_mfma_f32_16x16x32_bf16 v[172:175], a[12:15], v[92:95], v[172:175]
    ds_read_b128 a[44:47], v11 offset:45056
    v_cvt_pk_bf16_f32 v103, v78, v79
    s_waitcnt lgkmcnt(4)
    v_mfma_f32_16x16x32_bf16 v[64:67], a[16:19], v[176:179], v[80:83]
    v_exp_f32 v48, v48
    v_mfma_f32_16x16x32_bf16 v[72:75], a[16:19], v[192:195], v[84:87]
    ds_read_b64_tr_b16 a[0:1], v16 offset:40960
    ds_read_b64_tr_b16 a[2:3], v16 offset:45056
    v_mfma_f32_16x16x32_bf16 v[64:67], a[20:23], v[180:183], v[64:67]
    v_exp_f32 v49, v49
    v_mfma_f32_16x16x32_bf16 v[72:75], a[20:23], v[196:199], v[72:75]
    ds_read_b64_tr_b16 a[4:5], v17 offset:40960
    ds_read_b64_tr_b16 a[6:7], v17 offset:45056
    v_mfma_f32_16x16x32_bf16 v[64:67], a[24:27], v[184:187], v[64:67]
    v_exp_f32 v50, v50
    v_mfma_f32_16x16x32_bf16 v[72:75], a[24:27], v[200:203], v[72:75]
    ds_read_b64_tr_b16 a[8:9], v18 offset:40960
    ds_read_b64_tr_b16 a[10:11], v18 offset:45056
    v_mfma_f32_16x16x32_bf16 v[64:67], a[28:31], v[188:191], v[64:67]
    v_exp_f32 v51, v51
    v_mfma_f32_16x16x32_bf16 v[72:75], a[28:31], v[204:207], v[72:75]
    ds_read_b64_tr_b16 a[12:13], v19 offset:40960
    ds_read_b64_tr_b16 a[14:15], v19 offset:45056
    v_mfma_f32_16x16x32_bf16 v[104:107], v[44:47], v[96:99], v[104:107]
    s_waitcnt lgkmcnt(8)
    v_mfma_f32_16x16x32_bf16 v[68:71], a[32:35], v[176:179], v[80:83]
    v_exp_f32 v52, v52
    v_mfma_f32_16x16x32_bf16 v[76:79], a[32:35], v[192:195], v[84:87]
    ds_read_b64_tr_b16 a[16:17], v20 offset:40960
    ds_read_b64_tr_b16 a[18:19], v20 offset:45056
    v_mfma_f32_16x16x32_bf16 v[68:71], a[36:39], v[180:183], v[68:71]
    v_exp_f32 v53, v53
    v_mfma_f32_16x16x32_bf16 v[76:79], a[36:39], v[196:199], v[76:79]
    ds_read_b64_tr_b16 a[20:21], v21 offset:40960
    ds_read_b64_tr_b16 a[22:23], v21 offset:45056
    v_mfma_f32_16x16x32_bf16 v[68:71], a[40:43], v[184:187], v[68:71]
    v_exp_f32 v54, v54
    v_mfma_f32_16x16x32_bf16 v[76:79], a[40:43], v[200:203], v[76:79]
    ds_read_b64_tr_b16 a[24:25], v22 offset:40960
    ds_read_b64_tr_b16 a[26:27], v22 offset:45056
    v_mfma_f32_16x16x32_bf16 v[68:71], a[44:47], v[188:191], v[68:71]
    v_exp_f32 v55, v55
    v_mfma_f32_16x16x32_bf16 v[76:79], a[44:47], v[204:207], v[76:79]
    ds_read_b64_tr_b16 a[28:29], v23 offset:40960
    ds_read_b64_tr_b16 a[30:31], v23 offset:45056
    v_mfma_f32_16x16x32_bf16 v[108:111], v[44:47], v[100:103], v[108:111]
    s_waitcnt lgkmcnt(8)
    v_mfma_f32_16x16x32_bf16 v[112:115], a[0:3], v[96:99], v[112:115]
    v_exp_f32 v56, v56
    v_mfma_f32_16x16x32_bf16 v[116:119], a[0:3], v[100:103], v[116:119]
    v_cvt_pk_bf16_f32 v88, v48, v49
    v_mfma_f32_16x16x32_bf16 v[120:123], a[4:7], v[96:99], v[120:123]
    v_exp_f32 v57, v57
    v_mfma_f32_16x16x32_bf16 v[124:127], a[4:7], v[100:103], v[124:127]
    v_cvt_pk_bf16_f32 v89, v50, v51
    v_mfma_f32_16x16x32_bf16 v[128:131], a[8:11], v[96:99], v[128:131]
    v_exp_f32 v58, v58
    v_cvt_pk_bf16_f32 v90, v52, v53
    s_waitcnt lgkmcnt(0)
    v_mfma_f32_16x16x32_bf16 v[132:135], a[8:11], v[100:103], v[132:135]
    s_barrier
    v_mfma_f32_16x16x32_bf16 v[136:139], a[12:15], v[96:99], v[136:139]
    ds_read_b128 a[32:35], v8 offset:49152
    v_exp_f32 v59, v59
    v_mfma_f32_16x16x32_bf16 v[140:143], a[12:15], v[100:103], v[140:143]
    ds_read_b128 a[36:39], v9 offset:49152
    ds_read_b128 a[40:43], v10 offset:49152
    v_cvt_pk_bf16_f32 v91, v54, v55
    v_mfma_f32_16x16x32_bf16 v[144:147], a[16:19], v[96:99], v[144:147]
    v_exp_f32 v60, v60
    v_mfma_f32_16x16x32_bf16 v[148:151], a[16:19], v[100:103], v[148:151]
    ds_read_b128 a[44:47], v11 offset:49152
    ds_read_b128 a[0:3], v8 offset:53248
    v_cvt_pk_bf16_f32 v92, v56, v57
    v_mfma_f32_16x16x32_bf16 v[152:155], a[20:23], v[96:99], v[152:155]
    v_exp_f32 v61, v61
    v_mfma_f32_16x16x32_bf16 v[156:159], a[20:23], v[100:103], v[156:159]
    ds_read_b128 a[4:7], v9 offset:53248
    v_cvt_pk_bf16_f32 v93, v58, v59
    v_mfma_f32_16x16x32_bf16 v[160:163], a[24:27], v[96:99], v[160:163]
    v_exp_f32 v62, v62
    v_mfma_f32_16x16x32_bf16 v[164:167], a[24:27], v[100:103], v[164:167]
    ds_read_b128 a[8:11], v10 offset:53248
    v_cvt_pk_bf16_f32 v94, v60, v61
    v_mfma_f32_16x16x32_bf16 v[168:171], a[28:31], v[96:99], v[168:171]
    v_exp_f32 v63, v63
    v_mfma_f32_16x16x32_bf16 v[172:175], a[28:31], v[100:103], v[172:175]
    ds_read_b128 a[12:15], v11 offset:53248
    v_cvt_pk_bf16_f32 v95, v62, v63
    s_waitcnt lgkmcnt(4)
    v_mfma_f32_16x16x32_bf16 v[48:51], a[32:35], v[176:179], v[80:83]
    v_exp_f32 v64, v64
    v_mfma_f32_16x16x32_bf16 v[56:59], a[32:35], v[192:195], v[84:87]
    ds_read_b64_tr_b16 a[16:17], v16 offset:49152
    ds_read_b64_tr_b16 a[18:19], v16 offset:53248
    v_mfma_f32_16x16x32_bf16 v[48:51], a[36:39], v[180:183], v[48:51]
    v_exp_f32 v65, v65
    v_mfma_f32_16x16x32_bf16 v[56:59], a[36:39], v[196:199], v[56:59]
    ds_read_b64_tr_b16 a[20:21], v17 offset:49152
    ds_read_b64_tr_b16 a[22:23], v17 offset:53248
    v_mfma_f32_16x16x32_bf16 v[48:51], a[40:43], v[184:187], v[48:51]
    v_exp_f32 v66, v66
    v_mfma_f32_16x16x32_bf16 v[56:59], a[40:43], v[200:203], v[56:59]
    ds_read_b64_tr_b16 a[24:25], v18 offset:49152
    ds_read_b64_tr_b16 a[26:27], v18 offset:53248
    v_mfma_f32_16x16x32_bf16 v[48:51], a[44:47], v[188:191], v[48:51]
    v_exp_f32 v67, v67
    v_mfma_f32_16x16x32_bf16 v[56:59], a[44:47], v[204:207], v[56:59]
    ds_read_b64_tr_b16 a[28:29], v19 offset:49152
    ds_read_b64_tr_b16 a[30:31], v19 offset:53248
    v_mfma_f32_16x16x32_bf16 v[104:107], v[44:47], v[88:91], v[104:107]
    s_waitcnt lgkmcnt(8)
    v_mfma_f32_16x16x32_bf16 v[52:55], a[0:3], v[176:179], v[80:83]
    v_exp_f32 v68, v68
    v_mfma_f32_16x16x32_bf16 v[60:63], a[0:3], v[192:195], v[84:87]
    ds_read_b64_tr_b16 a[32:33], v20 offset:49152
    ds_read_b64_tr_b16 a[34:35], v20 offset:53248
    v_mfma_f32_16x16x32_bf16 v[52:55], a[4:7], v[180:183], v[52:55]
    v_exp_f32 v69, v69
    v_mfma_f32_16x16x32_bf16 v[60:63], a[4:7], v[196:199], v[60:63]
    ds_read_b64_tr_b16 a[36:37], v21 offset:49152
    ds_read_b64_tr_b16 a[38:39], v21 offset:53248
    v_mfma_f32_16x16x32_bf16 v[52:55], a[8:11], v[184:187], v[52:55]
    v_exp_f32 v70, v70
    v_mfma_f32_16x16x32_bf16 v[60:63], a[8:11], v[200:203], v[60:63]
    ds_read_b64_tr_b16 a[40:41], v22 offset:49152
    ds_read_b64_tr_b16 a[42:43], v22 offset:53248
    v_mfma_f32_16x16x32_bf16 v[52:55], a[12:15], v[188:191], v[52:55]
    v_exp_f32 v71, v71
    v_mfma_f32_16x16x32_bf16 v[60:63], a[12:15], v[204:207], v[60:63]
    ds_read_b64_tr_b16 a[44:45], v23 offset:49152
    ds_read_b64_tr_b16 a[46:47], v23 offset:53248
    v_mfma_f32_16x16x32_bf16 v[108:111], v[44:47], v[92:95], v[108:111]
    s_waitcnt lgkmcnt(8)
    v_mfma_f32_16x16x32_bf16 v[112:115], a[16:19], v[88:91], v[112:115]
    v_exp_f32 v72, v72
    v_mfma_f32_16x16x32_bf16 v[116:119], a[16:19], v[92:95], v[116:119]
    ds_read_b128 a[0:3], v8 offset:57344
    v_cvt_pk_bf16_f32 v96, v64, v65
    v_mfma_f32_16x16x32_bf16 v[120:123], a[20:23], v[88:91], v[120:123]
    v_exp_f32 v73, v73
    v_mfma_f32_16x16x32_bf16 v[124:127], a[20:23], v[92:95], v[124:127]
    ds_read_b128 a[4:7], v9 offset:57344
    v_cvt_pk_bf16_f32 v97, v66, v67
    v_mfma_f32_16x16x32_bf16 v[128:131], a[24:27], v[88:91], v[128:131]
    v_exp_f32 v74, v74
    v_mfma_f32_16x16x32_bf16 v[132:135], a[24:27], v[92:95], v[132:135]
    ds_read_b128 a[8:11], v10 offset:57344
    v_cvt_pk_bf16_f32 v98, v68, v69
    v_mfma_f32_16x16x32_bf16 v[136:139], a[28:31], v[88:91], v[136:139]
    v_exp_f32 v75, v75
    v_mfma_f32_16x16x32_bf16 v[140:143], a[28:31], v[92:95], v[140:143]
    ds_read_b128 a[12:15], v11 offset:57344
    v_cvt_pk_bf16_f32 v99, v70, v71
    s_waitcnt lgkmcnt(4)
    v_mfma_f32_16x16x32_bf16 v[144:147], a[32:35], v[88:91], v[144:147]
    v_exp_f32 v76, v76
    v_mfma_f32_16x16x32_bf16 v[148:151], a[32:35], v[92:95], v[148:151]
    ds_read_b128 a[16:19], v8 offset:61440
    v_cvt_pk_bf16_f32 v100, v72, v73
    v_mfma_f32_16x16x32_bf16 v[152:155], a[36:39], v[88:91], v[152:155]
    v_exp_f32 v77, v77
    v_mfma_f32_16x16x32_bf16 v[156:159], a[36:39], v[92:95], v[156:159]
    ds_read_b128 a[20:23], v9 offset:61440
    v_cvt_pk_bf16_f32 v101, v74, v75
    v_mfma_f32_16x16x32_bf16 v[160:163], a[40:43], v[88:91], v[160:163]
    v_exp_f32 v78, v78
    v_mfma_f32_16x16x32_bf16 v[164:167], a[40:43], v[92:95], v[164:167]
    ds_read_b128 a[24:27], v10 offset:61440
    v_cvt_pk_bf16_f32 v102, v76, v77
    v_mfma_f32_16x16x32_bf16 v[168:171], a[44:47], v[88:91], v[168:171]
    v_exp_f32 v79, v79
    v_mfma_f32_16x16x32_bf16 v[172:175], a[44:47], v[92:95], v[172:175]
    ds_read_b128 a[28:31], v11 offset:61440
    v_cvt_pk_bf16_f32 v103, v78, v79
    s_waitcnt lgkmcnt(4)
    v_mfma_f32_16x16x32_bf16 v[64:67], a[0:3], v[176:179], v[80:83]
    v_exp_f32 v48, v48
    v_mfma_f32_16x16x32_bf16 v[72:75], a[0:3], v[192:195], v[84:87]
    ds_read_b64_tr_b16 a[32:33], v16 offset:57344
    ds_read_b64_tr_b16 a[34:35], v16 offset:61440
    v_mfma_f32_16x16x32_bf16 v[64:67], a[4:7], v[180:183], v[64:67]
    v_exp_f32 v49, v49
    v_mfma_f32_16x16x32_bf16 v[72:75], a[4:7], v[196:199], v[72:75]
    ds_read_b64_tr_b16 a[36:37], v17 offset:57344
    ds_read_b64_tr_b16 a[38:39], v17 offset:61440
    v_mfma_f32_16x16x32_bf16 v[64:67], a[8:11], v[184:187], v[64:67]
    v_exp_f32 v50, v50
    v_mfma_f32_16x16x32_bf16 v[72:75], a[8:11], v[200:203], v[72:75]
    ds_read_b64_tr_b16 a[40:41], v18 offset:57344
    ds_read_b64_tr_b16 a[42:43], v18 offset:61440
    v_mfma_f32_16x16x32_bf16 v[64:67], a[12:15], v[188:191], v[64:67]
    v_exp_f32 v51, v51
    v_mfma_f32_16x16x32_bf16 v[72:75], a[12:15], v[204:207], v[72:75]
    ds_read_b64_tr_b16 a[44:45], v19 offset:57344
    ds_read_b64_tr_b16 a[46:47], v19 offset:61440
    v_mfma_f32_16x16x32_bf16 v[104:107], v[44:47], v[96:99], v[104:107]
    s_waitcnt lgkmcnt(8)
    v_mfma_f32_16x16x32_bf16 v[68:71], a[16:19], v[176:179], v[80:83]
    v_exp_f32 v52, v52
    v_mfma_f32_16x16x32_bf16 v[76:79], a[16:19], v[192:195], v[84:87]
    ds_read_b64_tr_b16 a[0:1], v20 offset:57344
    ds_read_b64_tr_b16 a[2:3], v20 offset:61440
    v_mfma_f32_16x16x32_bf16 v[68:71], a[20:23], v[180:183], v[68:71]
    v_exp_f32 v53, v53
    v_mfma_f32_16x16x32_bf16 v[76:79], a[20:23], v[196:199], v[76:79]
    ds_read_b64_tr_b16 a[4:5], v21 offset:57344
    ds_read_b64_tr_b16 a[6:7], v21 offset:61440
    v_mfma_f32_16x16x32_bf16 v[68:71], a[24:27], v[184:187], v[68:71]
    v_exp_f32 v54, v54
    v_mfma_f32_16x16x32_bf16 v[76:79], a[24:27], v[200:203], v[76:79]
    ds_read_b64_tr_b16 a[8:9], v22 offset:57344
    ds_read_b64_tr_b16 a[10:11], v22 offset:61440
    v_mfma_f32_16x16x32_bf16 v[68:71], a[28:31], v[188:191], v[68:71]
    v_exp_f32 v55, v55
    v_mfma_f32_16x16x32_bf16 v[76:79], a[28:31], v[204:207], v[76:79]
    ds_read_b64_tr_b16 a[12:13], v23 offset:57344
    ds_read_b64_tr_b16 a[14:15], v23 offset:61440
    v_mfma_f32_16x16x32_bf16 v[108:111], v[44:47], v[100:103], v[108:111]
    s_waitcnt lgkmcnt(8)
    v_mfma_f32_16x16x32_bf16 v[112:115], a[32:35], v[96:99], v[112:115]
    v_exp_f32 v56, v56
    v_mfma_f32_16x16x32_bf16 v[116:119], a[32:35], v[100:103], v[116:119]
    v_cvt_pk_bf16_f32 v88, v48, v49
    v_mfma_f32_16x16x32_bf16 v[120:123], a[36:39], v[96:99], v[120:123]
    v_exp_f32 v57, v57
    v_mfma_f32_16x16x32_bf16 v[124:127], a[36:39], v[100:103], v[124:127]
    v_cvt_pk_bf16_f32 v89, v50, v51
    v_mfma_f32_16x16x32_bf16 v[128:131], a[40:43], v[96:99], v[128:131]
    v_exp_f32 v58, v58
    v_cvt_pk_bf16_f32 v90, v52, v53
    s_waitcnt lgkmcnt(0)
    v_mfma_f32_16x16x32_bf16 v[132:135], a[40:43], v[100:103], v[132:135]
    s_barrier
    v_mfma_f32_16x16x32_bf16 v[136:139], a[44:47], v[96:99], v[136:139]
    ds_read_b128 a[16:19], v8 offset:0
    v_exp_f32 v59, v59
    v_mfma_f32_16x16x32_bf16 v[140:143], a[44:47], v[100:103], v[140:143]
    ds_read_b128 a[20:23], v9 offset:0
    ds_read_b128 a[24:27], v10 offset:0
    v_cvt_pk_bf16_f32 v91, v54, v55
    v_mfma_f32_16x16x32_bf16 v[144:147], a[0:3], v[96:99], v[144:147]
    v_exp_f32 v60, v60
    v_mfma_f32_16x16x32_bf16 v[148:151], a[0:3], v[100:103], v[148:151]
    ds_read_b128 a[28:31], v11 offset:0
    ds_read_b128 a[32:35], v8 offset:4096
    v_cvt_pk_bf16_f32 v92, v56, v57
    v_mfma_f32_16x16x32_bf16 v[152:155], a[4:7], v[96:99], v[152:155]
    v_exp_f32 v61, v61
    v_mfma_f32_16x16x32_bf16 v[156:159], a[4:7], v[100:103], v[156:159]
    ds_read_b128 a[36:39], v9 offset:4096
    v_cvt_pk_bf16_f32 v93, v58, v59
    v_mfma_f32_16x16x32_bf16 v[160:163], a[8:11], v[96:99], v[160:163]
    v_exp_f32 v62, v62
    v_mfma_f32_16x16x32_bf16 v[164:167], a[8:11], v[100:103], v[164:167]
    ds_read_b128 a[40:43], v10 offset:4096
    v_cvt_pk_bf16_f32 v94, v60, v61
    v_mfma_f32_16x16x32_bf16 v[168:171], a[12:15], v[96:99], v[168:171]
    v_exp_f32 v63, v63
    v_mfma_f32_16x16x32_bf16 v[172:175], a[12:15], v[100:103], v[172:175]
    ds_read_b128 a[44:47], v11 offset:4096
    v_cvt_pk_bf16_f32 v95, v62, v63
    s_waitcnt lgkmcnt(4)
    v_mfma_f32_16x16x32_bf16 v[48:51], a[16:19], v[176:179], v[80:83]
    v_exp_f32 v64, v64
    v_mfma_f32_16x16x32_bf16 v[56:59], a[16:19], v[192:195], v[84:87]
    ds_read_b64_tr_b16 a[0:1], v16 offset:0
    ds_read_b64_tr_b16 a[2:3], v16 offset:4096
    v_mfma_f32_16x16x32_bf16 v[48:51], a[20:23], v[180:183], v[48:51]
    v_exp_f32 v65, v65
    v_mfma_f32_16x16x32_bf16 v[56:59], a[20:23], v[196:199], v[56:59]
    ds_read_b64_tr_b16 a[4:5], v17 offset:0
    ds_read_b64_tr_b16 a[6:7], v17 offset:4096
    v_mfma_f32_16x16x32_bf16 v[48:51], a[24:27], v[184:187], v[48:51]
    v_exp_f32 v66, v66
    v_mfma_f32_16x16x32_bf16 v[56:59], a[24:27], v[200:203], v[56:59]
    ds_read_b64_tr_b16 a[8:9], v18 offset:0
    ds_read_b64_tr_b16 a[10:11], v18 offset:4096
    v_mfma_f32_16x16x32_bf16 v[48:51], a[28:31], v[188:191], v[48:51]
    v_exp_f32 v67, v67
    v_mfma_f32_16x16x32_bf16 v[56:59], a[28:31], v[204:207], v[56:59]
    ds_read_b64_tr_b16 a[12:13], v19 offset:0
    ds_read_b64_tr_b16 a[14:15], v19 offset:4096
    v_mfma_f32_16x16x32_bf16 v[104:107], v[44:47], v[88:91], v[104:107]
    s_waitcnt lgkmcnt(8)
    v_mfma_f32_16x16x32_bf16 v[52:55], a[32:35], v[176:179], v[80:83]
    v_exp_f32 v68, v68
    v_mfma_f32_16x16x32_bf16 v[60:63], a[32:35], v[192:195], v[84:87]
    ds_read_b64_tr_b16 a[16:17], v20 offset:0
    ds_read_b64_tr_b16 a[18:19], v20 offset:4096
    v_mfma_f32_16x16x32_bf16 v[52:55], a[36:39], v[180:183], v[52:55]
    v_exp_f32 v69, v69
    v_mfma_f32_16x16x32_bf16 v[60:63], a[36:39], v[196:199], v[60:63]
    ds_read_b64_tr_b16 a[20:21], v21 offset:0
    ds_read_b64_tr_b16 a[22:23], v21 offset:4096
    v_mfma_f32_16x16x32_bf16 v[52:55], a[40:43], v[184:187], v[52:55]
    v_exp_f32 v70, v70
    v_mfma_f32_16x16x32_bf16 v[60:63], a[40:43], v[200:203], v[60:63]
    ds_read_b64_tr_b16 a[24:25], v22 offset:0
    ds_read_b64_tr_b16 a[26:27], v22 offset:4096
    v_mfma_f32_16x16x32_bf16 v[52:55], a[44:47], v[188:191], v[52:55]
    v_exp_f32 v71, v71
    v_mfma_f32_16x16x32_bf16 v[60:63], a[44:47], v[204:207], v[60:63]
    ds_read_b64_tr_b16 a[28:29], v23 offset:0
    ds_read_b64_tr_b16 a[30:31], v23 offset:4096
    v_mfma_f32_16x16x32_bf16 v[108:111], v[44:47], v[92:95], v[108:111]
    s_waitcnt lgkmcnt(8)
    v_mfma_f32_16x16x32_bf16 v[112:115], a[0:3], v[88:91], v[112:115]
    v_exp_f32 v72, v72
    v_mfma_f32_16x16x32_bf16 v[116:119], a[0:3], v[92:95], v[116:119]
    ds_read_b128 a[32:35], v8 offset:8192
    v_cvt_pk_bf16_f32 v96, v64, v65
    v_mfma_f32_16x16x32_bf16 v[120:123], a[4:7], v[88:91], v[120:123]
    v_exp_f32 v73, v73
    v_mfma_f32_16x16x32_bf16 v[124:127], a[4:7], v[92:95], v[124:127]
    ds_read_b128 a[36:39], v9 offset:8192
    v_cvt_pk_bf16_f32 v97, v66, v67
    v_mfma_f32_16x16x32_bf16 v[128:131], a[8:11], v[88:91], v[128:131]
    v_exp_f32 v74, v74
    v_mfma_f32_16x16x32_bf16 v[132:135], a[8:11], v[92:95], v[132:135]
    ds_read_b128 a[40:43], v10 offset:8192
    v_cvt_pk_bf16_f32 v98, v68, v69
    v_mfma_f32_16x16x32_bf16 v[136:139], a[12:15], v[88:91], v[136:139]
    v_exp_f32 v75, v75
    v_mfma_f32_16x16x32_bf16 v[140:143], a[12:15], v[92:95], v[140:143]
    ds_read_b128 a[44:47], v11 offset:8192
    v_cvt_pk_bf16_f32 v99, v70, v71
    s_waitcnt lgkmcnt(4)
    v_mfma_f32_16x16x32_bf16 v[144:147], a[16:19], v[88:91], v[144:147]
    v_exp_f32 v76, v76
    v_mfma_f32_16x16x32_bf16 v[148:151], a[16:19], v[92:95], v[148:151]
    ds_read_b128 a[0:3], v8 offset:12288
    v_cvt_pk_bf16_f32 v100, v72, v73
    v_mfma_f32_16x16x32_bf16 v[152:155], a[20:23], v[88:91], v[152:155]
    v_exp_f32 v77, v77
    v_mfma_f32_16x16x32_bf16 v[156:159], a[20:23], v[92:95], v[156:159]
    ds_read_b128 a[4:7], v9 offset:12288
    v_cvt_pk_bf16_f32 v101, v74, v75
    v_mfma_f32_16x16x32_bf16 v[160:163], a[24:27], v[88:91], v[160:163]
    v_exp_f32 v78, v78
    v_mfma_f32_16x16x32_bf16 v[164:167], a[24:27], v[92:95], v[164:167]
    ds_read_b128 a[8:11], v10 offset:12288
    v_cvt_pk_bf16_f32 v102, v76, v77
    v_mfma_f32_16x16x32_bf16 v[168:171], a[28:31], v[88:91], v[168:171]
    v_exp_f32 v79, v79
    v_mfma_f32_16x16x32_bf16 v[172:175], a[28:31], v[92:95], v[172:175]
    ds_read_b128 a[12:15], v11 offset:12288
    v_cvt_pk_bf16_f32 v103, v78, v79
    s_waitcnt lgkmcnt(4)
    v_mfma_f32_16x16x32_bf16 v[64:67], a[32:35], v[176:179], v[80:83]
    v_exp_f32 v48, v48
    v_mfma_f32_16x16x32_bf16 v[72:75], a[32:35], v[192:195], v[84:87]
    ds_read_b64_tr_b16 a[16:17], v16 offset:8192
    ds_read_b64_tr_b16 a[18:19], v16 offset:12288
    v_mfma_f32_16x16x32_bf16 v[64:67], a[36:39], v[180:183], v[64:67]
    v_exp_f32 v49, v49
    v_mfma_f32_16x16x32_bf16 v[72:75], a[36:39], v[196:199], v[72:75]
    ds_read_b64_tr_b16 a[20:21], v17 offset:8192
    ds_read_b64_tr_b16 a[22:23], v17 offset:12288
    v_mfma_f32_16x16x32_bf16 v[64:67], a[40:43], v[184:187], v[64:67]
    v_exp_f32 v50, v50
    v_mfma_f32_16x16x32_bf16 v[72:75], a[40:43], v[200:203], v[72:75]
    ds_read_b64_tr_b16 a[24:25], v18 offset:8192
    ds_read_b64_tr_b16 a[26:27], v18 offset:12288
    v_mfma_f32_16x16x32_bf16 v[64:67], a[44:47], v[188:191], v[64:67]
    v_exp_f32 v51, v51
    v_mfma_f32_16x16x32_bf16 v[72:75], a[44:47], v[204:207], v[72:75]
    ds_read_b64_tr_b16 a[28:29], v19 offset:8192
    ds_read_b64_tr_b16 a[30:31], v19 offset:12288
    v_mfma_f32_16x16x32_bf16 v[104:107], v[44:47], v[96:99], v[104:107]
    s_waitcnt lgkmcnt(8)
    v_mfma_f32_16x16x32_bf16 v[68:71], a[0:3], v[176:179], v[80:83]
    v_exp_f32 v52, v52
    v_mfma_f32_16x16x32_bf16 v[76:79], a[0:3], v[192:195], v[84:87]
    ds_read_b64_tr_b16 a[32:33], v20 offset:8192
    ds_read_b64_tr_b16 a[34:35], v20 offset:12288
    v_mfma_f32_16x16x32_bf16 v[68:71], a[4:7], v[180:183], v[68:71]
    v_exp_f32 v53, v53
    v_mfma_f32_16x16x32_bf16 v[76:79], a[4:7], v[196:199], v[76:79]
    ds_read_b64_tr_b16 a[36:37], v21 offset:8192
    ds_read_b64_tr_b16 a[38:39], v21 offset:12288
    v_mfma_f32_16x16x32_bf16 v[68:71], a[8:11], v[184:187], v[68:71]
    v_exp_f32 v54, v54
    v_mfma_f32_16x16x32_bf16 v[76:79], a[8:11], v[200:203], v[76:79]
    ds_read_b64_tr_b16 a[40:41], v22 offset:8192
    ds_read_b64_tr_b16 a[42:43], v22 offset:12288
    v_mfma_f32_16x16x32_bf16 v[68:71], a[12:15], v[188:191], v[68:71]
    v_exp_f32 v55, v55
    v_mfma_f32_16x16x32_bf16 v[76:79], a[12:15], v[204:207], v[76:79]
    ds_read_b64_tr_b16 a[44:45], v23 offset:8192
    ds_read_b64_tr_b16 a[46:47], v23 offset:12288
    v_mfma_f32_16x16x32_bf16 v[108:111], v[44:47], v[100:103], v[108:111]
    s_waitcnt lgkmcnt(8)
    v_mfma_f32_16x16x32_bf16 v[112:115], a[16:19], v[96:99], v[112:115]
    v_exp_f32 v56, v56
    v_mfma_f32_16x16x32_bf16 v[116:119], a[16:19], v[100:103], v[116:119]
    v_cvt_pk_bf16_f32 v88, v48, v49
    v_mfma_f32_16x16x32_bf16 v[120:123], a[20:23], v[96:99], v[120:123]
    v_exp_f32 v57, v57
    v_mfma_f32_16x16x32_bf16 v[124:127], a[20:23], v[100:103], v[124:127]
    v_cvt_pk_bf16_f32 v89, v50, v51
    v_mfma_f32_16x16x32_bf16 v[128:131], a[24:27], v[96:99], v[128:131]
    v_exp_f32 v58, v58
    v_cvt_pk_bf16_f32 v90, v52, v53
    s_waitcnt lgkmcnt(0)
    v_mfma_f32_16x16x32_bf16 v[132:135], a[24:27], v[100:103], v[132:135]
    s_barrier
    v_mfma_f32_16x16x32_bf16 v[136:139], a[28:31], v[96:99], v[136:139]
    ds_read_b128 a[0:3], v8 offset:16384
    v_exp_f32 v59, v59
    v_mfma_f32_16x16x32_bf16 v[140:143], a[28:31], v[100:103], v[140:143]
    ds_read_b128 a[4:7], v9 offset:16384
    ds_read_b128 a[8:11], v10 offset:16384
    v_cvt_pk_bf16_f32 v91, v54, v55
    v_mfma_f32_16x16x32_bf16 v[144:147], a[32:35], v[96:99], v[144:147]
    v_exp_f32 v60, v60
    v_mfma_f32_16x16x32_bf16 v[148:151], a[32:35], v[100:103], v[148:151]
    ds_read_b128 a[12:15], v11 offset:16384
    ds_read_b128 a[16:19], v8 offset:20480
    v_cvt_pk_bf16_f32 v92, v56, v57
    v_mfma_f32_16x16x32_bf16 v[152:155], a[36:39], v[96:99], v[152:155]
    v_exp_f32 v61, v61
    v_mfma_f32_16x16x32_bf16 v[156:159], a[36:39], v[100:103], v[156:159]
    ds_read_b128 a[20:23], v9 offset:20480
    v_cvt_pk_bf16_f32 v93, v58, v59
    v_mfma_f32_16x16x32_bf16 v[160:163], a[40:43], v[96:99], v[160:163]
    v_exp_f32 v62, v62
    v_mfma_f32_16x16x32_bf16 v[164:167], a[40:43], v[100:103], v[164:167]
    ds_read_b128 a[24:27], v10 offset:20480
    v_cvt_pk_bf16_f32 v94, v60, v61
    v_mfma_f32_16x16x32_bf16 v[168:171], a[44:47], v[96:99], v[168:171]
    v_exp_f32 v63, v63
    v_mfma_f32_16x16x32_bf16 v[172:175], a[44:47], v[100:103], v[172:175]
    ds_read_b128 a[28:31], v11 offset:20480
    v_cvt_pk_bf16_f32 v95, v62, v63
    s_waitcnt lgkmcnt(4)
    v_mfma_f32_16x16x32_bf16 v[48:51], a[0:3], v[176:179], v[80:83]
    v_exp_f32 v64, v64
    v_mfma_f32_16x16x32_bf16 v[56:59], a[0:3], v[192:195], v[84:87]
    ds_read_b64_tr_b16 a[32:33], v16 offset:16384
    ds_read_b64_tr_b16 a[34:35], v16 offset:20480
    v_mfma_f32_16x16x32_bf16 v[48:51], a[4:7], v[180:183], v[48:51]
    v_exp_f32 v65, v65
    v_mfma_f32_16x16x32_bf16 v[56:59], a[4:7], v[196:199], v[56:59]
    ds_read_b64_tr_b16 a[36:37], v17 offset:16384
    ds_read_b64_tr_b16 a[38:39], v17 offset:20480
    v_mfma_f32_16x16x32_bf16 v[48:51], a[8:11], v[184:187], v[48:51]
    v_exp_f32 v66, v66
    v_mfma_f32_16x16x32_bf16 v[56:59], a[8:11], v[200:203], v[56:59]
    ds_read_b64_tr_b16 a[40:41], v18 offset:16384
    ds_read_b64_tr_b16 a[42:43], v18 offset:20480
    v_mfma_f32_16x16x32_bf16 v[48:51], a[12:15], v[188:191], v[48:51]
    v_exp_f32 v67, v67
    v_mfma_f32_16x16x32_bf16 v[56:59], a[12:15], v[204:207], v[56:59]
    ds_read_b64_tr_b16 a[44:45], v19 offset:16384
    ds_read_b64_tr_b16 a[46:47], v19 offset:20480
    v_mfma_f32_16x16x32_bf16 v[104:107], v[44:47], v[88:91], v[104:107]
    s_waitcnt lgkmcnt(8)
    v_mfma_f32_16x16x32_bf16 v[52:55], a[16:19], v[176:179], v[80:83]
    v_exp_f32 v68, v68
    v_mfma_f32_16x16x32_bf16 v[60:63], a[16:19], v[192:195], v[84:87]
    ds_read_b64_tr_b16 a[0:1], v20 offset:16384
    ds_read_b64_tr_b16 a[2:3], v20 offset:20480
    v_mfma_f32_16x16x32_bf16 v[52:55], a[20:23], v[180:183], v[52:55]
    v_exp_f32 v69, v69
    v_mfma_f32_16x16x32_bf16 v[60:63], a[20:23], v[196:199], v[60:63]
    ds_read_b64_tr_b16 a[4:5], v21 offset:16384
    ds_read_b64_tr_b16 a[6:7], v21 offset:20480
    v_mfma_f32_16x16x32_bf16 v[52:55], a[24:27], v[184:187], v[52:55]
    v_exp_f32 v70, v70
    v_mfma_f32_16x16x32_bf16 v[60:63], a[24:27], v[200:203], v[60:63]
    ds_read_b64_tr_b16 a[8:9], v22 offset:16384
    ds_read_b64_tr_b16 a[10:11], v22 offset:20480
    v_mfma_f32_16x16x32_bf16 v[52:55], a[28:31], v[188:191], v[52:55]
    v_exp_f32 v71, v71
    v_mfma_f32_16x16x32_bf16 v[60:63], a[28:31], v[204:207], v[60:63]
    ds_read_b64_tr_b16 a[12:13], v23 offset:16384
    ds_read_b64_tr_b16 a[14:15], v23 offset:20480
    v_mfma_f32_16x16x32_bf16 v[108:111], v[44:47], v[92:95], v[108:111]
    s_waitcnt lgkmcnt(8)
    v_mfma_f32_16x16x32_bf16 v[112:115], a[32:35], v[88:91], v[112:115]
    v_exp_f32 v72, v72
    v_mfma_f32_16x16x32_bf16 v[116:119], a[32:35], v[92:95], v[116:119]
    ds_read_b128 a[16:19], v8 offset:24576
    v_cvt_pk_bf16_f32 v96, v64, v65
    v_mfma_f32_16x16x32_bf16 v[120:123], a[36:39], v[88:91], v[120:123]
    v_exp_f32 v73, v73
    v_mfma_f32_16x16x32_bf16 v[124:127], a[36:39], v[92:95], v[124:127]
    ds_read_b128 a[20:23], v9 offset:24576
    v_cvt_pk_bf16_f32 v97, v66, v67
    v_mfma_f32_16x16x32_bf16 v[128:131], a[40:43], v[88:91], v[128:131]
    v_exp_f32 v74, v74
    v_mfma_f32_16x16x32_bf16 v[132:135], a[40:43], v[92:95], v[132:135]
    ds_read_b128 a[24:27], v10 offset:24576
    v_cvt_pk_bf16_f32 v98, v68, v69
    v_mfma_f32_16x16x32_bf16 v[136:139], a[44:47], v[88:91], v[136:139]
    v_exp_f32 v75, v75
    v_mfma_f32_16x16x32_bf16 v[140:143], a[44:47], v[92:95], v[140:143]
    ds_read_b128 a[28:31], v11 offset:24576
    v_cvt_pk_bf16_f32 v99, v70, v71
    s_waitcnt lgkmcnt(4)
    v_mfma_f32_16x16x32_bf16 v[144:147], a[0:3], v[88:91], v[144:147]
    v_exp_f32 v76, v76
    v_mfma_f32_16x16x32_bf16 v[148:151], a[0:3], v[92:95], v[148:151]
    ds_read_b128 a[32:35], v8 offset:28672
    v_cvt_pk_bf16_f32 v100, v72, v73
    v_mfma_f32_16x16x32_bf16 v[152:155], a[4:7], v[88:91], v[152:155]
    v_exp_f32 v77, v77
    v_mfma_f32_16x16x32_bf16 v[156:159], a[4:7], v[92:95], v[156:159]
    ds_read_b128 a[36:39], v9 offset:28672
    v_cvt_pk_bf16_f32 v101, v74, v75
    v_mfma_f32_16x16x32_bf16 v[160:163], a[8:11], v[88:91], v[160:163]
    v_exp_f32 v78, v78
    v_mfma_f32_16x16x32_bf16 v[164:167], a[8:11], v[92:95], v[164:167]
    ds_read_b128 a[40:43], v10 offset:28672
    v_cvt_pk_bf16_f32 v102, v76, v77
    v_mfma_f32_16x16x32_bf16 v[168:171], a[12:15], v[88:91], v[168:171]
    v_exp_f32 v79, v79
    v_mfma_f32_16x16x32_bf16 v[172:175], a[12:15], v[92:95], v[172:175]
    ds_read_b128 a[44:47], v11 offset:28672
    v_cvt_pk_bf16_f32 v103, v78, v79
    s_waitcnt lgkmcnt(4)
    v_mfma_f32_16x16x32_bf16 v[64:67], a[16:19], v[176:179], v[80:83]
    v_exp_f32 v48, v48
    v_mfma_f32_16x16x32_bf16 v[72:75], a[16:19], v[192:195], v[84:87]
    ds_read_b64_tr_b16 a[0:1], v16 offset:24576
    ds_read_b64_tr_b16 a[2:3], v16 offset:28672
    v_mfma_f32_16x16x32_bf16 v[64:67], a[20:23], v[180:183], v[64:67]
    v_exp_f32 v49, v49
    v_mfma_f32_16x16x32_bf16 v[72:75], a[20:23], v[196:199], v[72:75]
    ds_read_b64_tr_b16 a[4:5], v17 offset:24576
    ds_read_b64_tr_b16 a[6:7], v17 offset:28672
    v_mfma_f32_16x16x32_bf16 v[64:67], a[24:27], v[184:187], v[64:67]
    v_exp_f32 v50, v50
    v_mfma_f32_16x16x32_bf16 v[72:75], a[24:27], v[200:203], v[72:75]
    ds_read_b64_tr_b16 a[8:9], v18 offset:24576
    ds_read_b64_tr_b16 a[10:11], v18 offset:28672
    v_mfma_f32_16x16x32_bf16 v[64:67], a[28:31], v[188:191], v[64:67]
    v_exp_f32 v51, v51
    v_mfma_f32_16x16x32_bf16 v[72:75], a[28:31], v[204:207], v[72:75]
    ds_read_b64_tr_b16 a[12:13], v19 offset:24576
    ds_read_b64_tr_b16 a[14:15], v19 offset:28672
    v_mfma_f32_16x16x32_bf16 v[104:107], v[44:47], v[96:99], v[104:107]
    s_waitcnt lgkmcnt(8)
    v_mfma_f32_16x16x32_bf16 v[68:71], a[32:35], v[176:179], v[80:83]
    v_exp_f32 v52, v52
    v_mfma_f32_16x16x32_bf16 v[76:79], a[32:35], v[192:195], v[84:87]
    ds_read_b64_tr_b16 a[16:17], v20 offset:24576
    ds_read_b64_tr_b16 a[18:19], v20 offset:28672
    v_mfma_f32_16x16x32_bf16 v[68:71], a[36:39], v[180:183], v[68:71]
    v_exp_f32 v53, v53
    v_mfma_f32_16x16x32_bf16 v[76:79], a[36:39], v[196:199], v[76:79]
    ds_read_b64_tr_b16 a[20:21], v21 offset:24576
    ds_read_b64_tr_b16 a[22:23], v21 offset:28672
    v_mfma_f32_16x16x32_bf16 v[68:71], a[40:43], v[184:187], v[68:71]
    v_exp_f32 v54, v54
    v_mfma_f32_16x16x32_bf16 v[76:79], a[40:43], v[200:203], v[76:79]
    ds_read_b64_tr_b16 a[24:25], v22 offset:24576
    ds_read_b64_tr_b16 a[26:27], v22 offset:28672
    v_mfma_f32_16x16x32_bf16 v[68:71], a[44:47], v[188:191], v[68:71]
    v_exp_f32 v55, v55
    v_mfma_f32_16x16x32_bf16 v[76:79], a[44:47], v[204:207], v[76:79]
    ds_read_b64_tr_b16 a[28:29], v23 offset:24576
    ds_read_b64_tr_b16 a[30:31], v23 offset:28672
    v_mfma_f32_16x16x32_bf16 v[108:111], v[44:47], v[100:103], v[108:111]
    s_waitcnt lgkmcnt(8)
    v_mfma_f32_16x16x32_bf16 v[112:115], a[0:3], v[96:99], v[112:115]
    v_exp_f32 v56, v56
    v_mfma_f32_16x16x32_bf16 v[116:119], a[0:3], v[100:103], v[116:119]
    v_cvt_pk_bf16_f32 v88, v48, v49
    v_mfma_f32_16x16x32_bf16 v[120:123], a[4:7], v[96:99], v[120:123]
    v_exp_f32 v57, v57
    v_mfma_f32_16x16x32_bf16 v[124:127], a[4:7], v[100:103], v[124:127]
    v_cvt_pk_bf16_f32 v89, v50, v51
    v_mfma_f32_16x16x32_bf16 v[128:131], a[8:11], v[96:99], v[128:131]
    v_exp_f32 v58, v58
    v_cvt_pk_bf16_f32 v90, v52, v53
    s_waitcnt lgkmcnt(0)
    v_mfma_f32_16x16x32_bf16 v[132:135], a[8:11], v[100:103], v[132:135]
    s_barrier
    v_mfma_f32_16x16x32_bf16 v[136:139], a[12:15], v[96:99], v[136:139]
    ds_read_b128 a[32:35], v8 offset:32768
    v_exp_f32 v59, v59
    v_mfma_f32_16x16x32_bf16 v[140:143], a[12:15], v[100:103], v[140:143]
    ds_read_b128 a[36:39], v9 offset:32768
    ds_read_b128 a[40:43], v10 offset:32768
    v_cvt_pk_bf16_f32 v91, v54, v55
    v_mfma_f32_16x16x32_bf16 v[144:147], a[16:19], v[96:99], v[144:147]
    v_exp_f32 v60, v60
    v_mfma_f32_16x16x32_bf16 v[148:151], a[16:19], v[100:103], v[148:151]
    ds_read_b128 a[44:47], v11 offset:32768
    ds_read_b128 a[0:3], v8 offset:36864
    v_cvt_pk_bf16_f32 v92, v56, v57
    v_mfma_f32_16x16x32_bf16 v[152:155], a[20:23], v[96:99], v[152:155]
    v_exp_f32 v61, v61
    v_mfma_f32_16x16x32_bf16 v[156:159], a[20:23], v[100:103], v[156:159]
    ds_read_b128 a[4:7], v9 offset:36864
    v_cvt_pk_bf16_f32 v93, v58, v59
    v_mfma_f32_16x16x32_bf16 v[160:163], a[24:27], v[96:99], v[160:163]
    v_exp_f32 v62, v62
    v_mfma_f32_16x16x32_bf16 v[164:167], a[24:27], v[100:103], v[164:167]
    ds_read_b128 a[8:11], v10 offset:36864
    v_cvt_pk_bf16_f32 v94, v60, v61
    v_mfma_f32_16x16x32_bf16 v[168:171], a[28:31], v[96:99], v[168:171]
    v_exp_f32 v63, v63
    v_mfma_f32_16x16x32_bf16 v[172:175], a[28:31], v[100:103], v[172:175]
    ds_read_b128 a[12:15], v11 offset:36864
    v_cvt_pk_bf16_f32 v95, v62, v63
    s_waitcnt lgkmcnt(4)
    v_mfma_f32_16x16x32_bf16 v[48:51], a[32:35], v[176:179], v[80:83]
    v_exp_f32 v64, v64
    v_mfma_f32_16x16x32_bf16 v[56:59], a[32:35], v[192:195], v[84:87]
    ds_read_b64_tr_b16 a[16:17], v16 offset:32768
    ds_read_b64_tr_b16 a[18:19], v16 offset:36864
    v_mfma_f32_16x16x32_bf16 v[48:51], a[36:39], v[180:183], v[48:51]
    v_exp_f32 v65, v65
    v_mfma_f32_16x16x32_bf16 v[56:59], a[36:39], v[196:199], v[56:59]
    ds_read_b64_tr_b16 a[20:21], v17 offset:32768
    ds_read_b64_tr_b16 a[22:23], v17 offset:36864
    v_mfma_f32_16x16x32_bf16 v[48:51], a[40:43], v[184:187], v[48:51]
    v_exp_f32 v66, v66
    v_mfma_f32_16x16x32_bf16 v[56:59], a[40:43], v[200:203], v[56:59]
    ds_read_b64_tr_b16 a[24:25], v18 offset:32768
    ds_read_b64_tr_b16 a[26:27], v18 offset:36864
    v_mfma_f32_16x16x32_bf16 v[48:51], a[44:47], v[188:191], v[48:51]
    v_exp_f32 v67, v67
    v_mfma_f32_16x16x32_bf16 v[56:59], a[44:47], v[204:207], v[56:59]
    ds_read_b64_tr_b16 a[28:29], v19 offset:32768
    ds_read_b64_tr_b16 a[30:31], v19 offset:36864
    v_mfma_f32_16x16x32_bf16 v[104:107], v[44:47], v[88:91], v[104:107]
    s_waitcnt lgkmcnt(8)
    v_mfma_f32_16x16x32_bf16 v[52:55], a[0:3], v[176:179], v[80:83]
    v_exp_f32 v68, v68
    v_mfma_f32_16x16x32_bf16 v[60:63], a[0:3], v[192:195], v[84:87]
    ds_read_b64_tr_b16 a[32:33], v20 offset:32768
    ds_read_b64_tr_b16 a[34:35], v20 offset:36864
    v_mfma_f32_16x16x32_bf16 v[52:55], a[4:7], v[180:183], v[52:55]
    v_exp_f32 v69, v69
    v_mfma_f32_16x16x32_bf16 v[60:63], a[4:7], v[196:199], v[60:63]
    ds_read_b64_tr_b16 a[36:37], v21 offset:32768
    ds_read_b64_tr_b16 a[38:39], v21 offset:36864
    v_mfma_f32_16x16x32_bf16 v[52:55], a[8:11], v[184:187], v[52:55]
    v_exp_f32 v70, v70
    v_mfma_f32_16x16x32_bf16 v[60:63], a[8:11], v[200:203], v[60:63]
    ds_read_b64_tr_b16 a[40:41], v22 offset:32768
    ds_read_b64_tr_b16 a[42:43], v22 offset:36864
    v_mfma_f32_16x16x32_bf16 v[52:55], a[12:15], v[188:191], v[52:55]
    v_exp_f32 v71, v71
    v_mfma_f32_16x16x32_bf16 v[60:63], a[12:15], v[204:207], v[60:63]
    ds_read_b64_tr_b16 a[44:45], v23 offset:32768
    ds_read_b64_tr_b16 a[46:47], v23 offset:36864
    v_mfma_f32_16x16x32_bf16 v[108:111], v[44:47], v[92:95], v[108:111]
    s_waitcnt lgkmcnt(8)
    v_mfma_f32_16x16x32_bf16 v[112:115], a[16:19], v[88:91], v[112:115]
    v_exp_f32 v72, v72
    v_mfma_f32_16x16x32_bf16 v[116:119], a[16:19], v[92:95], v[116:119]
    ds_read_b128 a[0:3], v8 offset:40960
    v_cvt_pk_bf16_f32 v96, v64, v65
    v_mfma_f32_16x16x32_bf16 v[120:123], a[20:23], v[88:91], v[120:123]
    v_exp_f32 v73, v73
    v_mfma_f32_16x16x32_bf16 v[124:127], a[20:23], v[92:95], v[124:127]
    ds_read_b128 a[4:7], v9 offset:40960
    v_cvt_pk_bf16_f32 v97, v66, v67
    v_mfma_f32_16x16x32_bf16 v[128:131], a[24:27], v[88:91], v[128:131]
    v_exp_f32 v74, v74
    v_mfma_f32_16x16x32_bf16 v[132:135], a[24:27], v[92:95], v[132:135]
    ds_read_b128 a[8:11], v10 offset:40960
    v_cvt_pk_bf16_f32 v98, v68, v69
    v_mfma_f32_16x16x32_bf16 v[136:139], a[28:31], v[88:91], v[136:139]
    v_exp_f32 v75, v75
    v_mfma_f32_16x16x32_bf16 v[140:143], a[28:31], v[92:95], v[140:143]
    ds_read_b128 a[12:15], v11 offset:40960
    v_cvt_pk_bf16_f32 v99, v70, v71
    s_waitcnt lgkmcnt(4)
    v_mfma_f32_16x16x32_bf16 v[144:147], a[32:35], v[88:91], v[144:147]
    v_exp_f32 v76, v76
    v_mfma_f32_16x16x32_bf16 v[148:151], a[32:35], v[92:95], v[148:151]
    ds_read_b128 a[16:19], v8 offset:45056
    v_cvt_pk_bf16_f32 v100, v72, v73
    v_mfma_f32_16x16x32_bf16 v[152:155], a[36:39], v[88:91], v[152:155]
    v_exp_f32 v77, v77
    v_mfma_f32_16x16x32_bf16 v[156:159], a[36:39], v[92:95], v[156:159]
    ds_read_b128 a[20:23], v9 offset:45056
    v_cvt_pk_bf16_f32 v101, v74, v75
    v_mfma_f32_16x16x32_bf16 v[160:163], a[40:43], v[88:91], v[160:163]
    v_exp_f32 v78, v78
    v_mfma_f32_16x16x32_bf16 v[164:167], a[40:43], v[92:95], v[164:167]
    ds_read_b128 a[24:27], v10 offset:45056
    v_cvt_pk_bf16_f32 v102, v76, v77
    v_mfma_f32_16x16x32_bf16 v[168:171], a[44:47], v[88:91], v[168:171]
    v_exp_f32 v79, v79
    v_mfma_f32_16x16x32_bf16 v[172:175], a[44:47], v[92:95], v[172:175]
    ds_read_b128 a[28:31], v11 offset:45056
    v_cvt_pk_bf16_f32 v103, v78, v79
    s_waitcnt lgkmcnt(4)
    v_mfma_f32_16x16x32_bf16 v[64:67], a[0:3], v[176:179], v[80:83]
    v_exp_f32 v48, v48
    v_mfma_f32_16x16x32_bf16 v[72:75], a[0:3], v[192:195], v[84:87]
    ds_read_b64_tr_b16 a[32:33], v16 offset:40960
    ds_read_b64_tr_b16 a[34:35], v16 offset:45056
    v_mfma_f32_16x16x32_bf16 v[64:67], a[4:7], v[180:183], v[64:67]
    v_exp_f32 v49, v49
    v_mfma_f32_16x16x32_bf16 v[72:75], a[4:7], v[196:199], v[72:75]
    ds_read_b64_tr_b16 a[36:37], v17 offset:40960
    ds_read_b64_tr_b16 a[38:39], v17 offset:45056
    v_mfma_f32_16x16x32_bf16 v[64:67], a[8:11], v[184:187], v[64:67]
    v_exp_f32 v50, v50
    v_mfma_f32_16x16x32_bf16 v[72:75], a[8:11], v[200:203], v[72:75]
    ds_read_b64_tr_b16 a[40:41], v18 offset:40960
    ds_read_b64_tr_b16 a[42:43], v18 offset:45056
    v_mfma_f32_16x16x32_bf16 v[64:67], a[12:15], v[188:191], v[64:67]
    v_exp_f32 v51, v51
    v_mfma_f32_16x16x32_bf16 v[72:75], a[12:15], v[204:207], v[72:75]
    ds_read_b64_tr_b16 a[44:45], v19 offset:40960
    ds_read_b64_tr_b16 a[46:47], v19 offset:45056
    v_mfma_f32_16x16x32_bf16 v[104:107], v[44:47], v[96:99], v[104:107]
    s_waitcnt lgkmcnt(8)
    v_mfma_f32_16x16x32_bf16 v[68:71], a[16:19], v[176:179], v[80:83]
    v_exp_f32 v52, v52
    v_mfma_f32_16x16x32_bf16 v[76:79], a[16:19], v[192:195], v[84:87]
    ds_read_b64_tr_b16 a[0:1], v20 offset:40960
    ds_read_b64_tr_b16 a[2:3], v20 offset:45056
    v_mfma_f32_16x16x32_bf16 v[68:71], a[20:23], v[180:183], v[68:71]
    v_exp_f32 v53, v53
    v_mfma_f32_16x16x32_bf16 v[76:79], a[20:23], v[196:199], v[76:79]
    ds_read_b64_tr_b16 a[4:5], v21 offset:40960
    ds_read_b64_tr_b16 a[6:7], v21 offset:45056
    v_mfma_f32_16x16x32_bf16 v[68:71], a[24:27], v[184:187], v[68:71]
    v_exp_f32 v54, v54
    v_mfma_f32_16x16x32_bf16 v[76:79], a[24:27], v[200:203], v[76:79]
    ds_read_b64_tr_b16 a[8:9], v22 offset:40960
    ds_read_b64_tr_b16 a[10:11], v22 offset:45056
    v_mfma_f32_16x16x32_bf16 v[68:71], a[28:31], v[188:191], v[68:71]
    v_exp_f32 v55, v55
    v_mfma_f32_16x16x32_bf16 v[76:79], a[28:31], v[204:207], v[76:79]
    ds_read_b64_tr_b16 a[12:13], v23 offset:40960
    ds_read_b64_tr_b16 a[14:15], v23 offset:45056
    v_mfma_f32_16x16x32_bf16 v[108:111], v[44:47], v[100:103], v[108:111]
    s_waitcnt lgkmcnt(8)
    v_mfma_f32_16x16x32_bf16 v[112:115], a[32:35], v[96:99], v[112:115]
    v_exp_f32 v56, v56
    v_mfma_f32_16x16x32_bf16 v[116:119], a[32:35], v[100:103], v[116:119]
    v_cvt_pk_bf16_f32 v88, v48, v49
    v_mfma_f32_16x16x32_bf16 v[120:123], a[36:39], v[96:99], v[120:123]
    v_exp_f32 v57, v57
    v_mfma_f32_16x16x32_bf16 v[124:127], a[36:39], v[100:103], v[124:127]
    v_cvt_pk_bf16_f32 v89, v50, v51
    v_mfma_f32_16x16x32_bf16 v[128:131], a[40:43], v[96:99], v[128:131]
    v_exp_f32 v58, v58
    v_cvt_pk_bf16_f32 v90, v52, v53
    s_waitcnt lgkmcnt(0)
    v_mfma_f32_16x16x32_bf16 v[132:135], a[40:43], v[100:103], v[132:135]
    s_barrier
    v_mfma_f32_16x16x32_bf16 v[136:139], a[44:47], v[96:99], v[136:139]
    ds_read_b128 a[16:19], v8 offset:49152
    v_exp_f32 v59, v59
    v_mfma_f32_16x16x32_bf16 v[140:143], a[44:47], v[100:103], v[140:143]
    ds_read_b128 a[20:23], v9 offset:49152
    ds_read_b128 a[24:27], v10 offset:49152
    v_cvt_pk_bf16_f32 v91, v54, v55
    v_mfma_f32_16x16x32_bf16 v[144:147], a[0:3], v[96:99], v[144:147]
    v_exp_f32 v60, v60
    v_mfma_f32_16x16x32_bf16 v[148:151], a[0:3], v[100:103], v[148:151]
    ds_read_b128 a[28:31], v11 offset:49152
    ds_read_b128 a[32:35], v8 offset:53248
    v_cvt_pk_bf16_f32 v92, v56, v57
    v_mfma_f32_16x16x32_bf16 v[152:155], a[4:7], v[96:99], v[152:155]
    v_exp_f32 v61, v61
    v_mfma_f32_16x16x32_bf16 v[156:159], a[4:7], v[100:103], v[156:159]
    ds_read_b128 a[36:39], v9 offset:53248
    v_cvt_pk_bf16_f32 v93, v58, v59
    v_mfma_f32_16x16x32_bf16 v[160:163], a[8:11], v[96:99], v[160:163]
    v_exp_f32 v62, v62
    v_mfma_f32_16x16x32_bf16 v[164:167], a[8:11], v[100:103], v[164:167]
    ds_read_b128 a[40:43], v10 offset:53248
    v_cvt_pk_bf16_f32 v94, v60, v61
    v_mfma_f32_16x16x32_bf16 v[168:171], a[12:15], v[96:99], v[168:171]
    v_exp_f32 v63, v63
    v_mfma_f32_16x16x32_bf16 v[172:175], a[12:15], v[100:103], v[172:175]
    ds_read_b128 a[44:47], v11 offset:53248
    v_cvt_pk_bf16_f32 v95, v62, v63
    s_waitcnt lgkmcnt(4)
    v_mfma_f32_16x16x32_bf16 v[48:51], a[16:19], v[176:179], v[80:83]
    v_exp_f32 v64, v64
    v_mfma_f32_16x16x32_bf16 v[56:59], a[16:19], v[192:195], v[84:87]
    ds_read_b64_tr_b16 a[0:1], v16 offset:49152
    ds_read_b64_tr_b16 a[2:3], v16 offset:53248
    v_mfma_f32_16x16x32_bf16 v[48:51], a[20:23], v[180:183], v[48:51]
    v_exp_f32 v65, v65
    v_mfma_f32_16x16x32_bf16 v[56:59], a[20:23], v[196:199], v[56:59]
    ds_read_b64_tr_b16 a[4:5], v17 offset:49152
    ds_read_b64_tr_b16 a[6:7], v17 offset:53248
    v_mfma_f32_16x16x32_bf16 v[48:51], a[24:27], v[184:187], v[48:51]
    v_exp_f32 v66, v66
    v_mfma_f32_16x16x32_bf16 v[56:59], a[24:27], v[200:203], v[56:59]
    ds_read_b64_tr_b16 a[8:9], v18 offset:49152
    ds_read_b64_tr_b16 a[10:11], v18 offset:53248
    v_mfma_f32_16x16x32_bf16 v[48:51], a[28:31], v[188:191], v[48:51]
    v_exp_f32 v67, v67
    v_mfma_f32_16x16x32_bf16 v[56:59], a[28:31], v[204:207], v[56:59]
    ds_read_b64_tr_b16 a[12:13], v19 offset:49152
    ds_read_b64_tr_b16 a[14:15], v19 offset:53248
    v_mfma_f32_16x16x32_bf16 v[104:107], v[44:47], v[88:91], v[104:107]
    s_waitcnt lgkmcnt(8)
    v_mfma_f32_16x16x32_bf16 v[52:55], a[32:35], v[176:179], v[80:83]
    v_exp_f32 v68, v68
    v_mfma_f32_16x16x32_bf16 v[60:63], a[32:35], v[192:195], v[84:87]
    ds_read_b64_tr_b16 a[16:17], v20 offset:49152
    ds_read_b64_tr_b16 a[18:19], v20 offset:53248
    v_mfma_f32_16x16x32_bf16 v[52:55], a[36:39], v[180:183], v[52:55]
    v_exp_f32 v69, v69
    v_mfma_f32_16x16x32_bf16 v[60:63], a[36:39], v[196:199], v[60:63]
    ds_read_b64_tr_b16 a[20:21], v21 offset:49152
    ds_read_b64_tr_b16 a[22:23], v21 offset:53248
    v_mfma_f32_16x16x32_bf16 v[52:55], a[40:43], v[184:187], v[52:55]
    v_exp_f32 v70, v70
    v_mfma_f32_16x16x32_bf16 v[60:63], a[40:43], v[200:203], v[60:63]
    ds_read_b64_tr_b16 a[24:25], v22 offset:49152
    ds_read_b64_tr_b16 a[26:27], v22 offset:53248
    v_mfma_f32_16x16x32_bf16 v[52:55], a[44:47], v[188:191], v[52:55]
    v_exp_f32 v71, v71
    v_mfma_f32_16x16x32_bf16 v[60:63], a[44:47], v[204:207], v[60:63]
    ds_read_b64_tr_b16 a[28:29], v23 offset:49152
    ds_read_b64_tr_b16 a[30:31], v23 offset:53248
    v_mfma_f32_16x16x32_bf16 v[108:111], v[44:47], v[92:95], v[108:111]
    s_waitcnt lgkmcnt(8)
    v_mfma_f32_16x16x32_bf16 v[112:115], a[0:3], v[88:91], v[112:115]
    v_exp_f32 v72, v72
    v_mfma_f32_16x16x32_bf16 v[116:119], a[0:3], v[92:95], v[116:119]
    ds_read_b128 a[32:35], v8 offset:57344
    v_cvt_pk_bf16_f32 v96, v64, v65
    v_mfma_f32_16x16x32_bf16 v[120:123], a[4:7], v[88:91], v[120:123]
    v_exp_f32 v73, v73
    v_mfma_f32_16x16x32_bf16 v[124:127], a[4:7], v[92:95], v[124:127]
    ds_read_b128 a[36:39], v9 offset:57344
    v_cvt_pk_bf16_f32 v97, v66, v67
    v_mfma_f32_16x16x32_bf16 v[128:131], a[8:11], v[88:91], v[128:131]
    v_exp_f32 v74, v74
    v_mfma_f32_16x16x32_bf16 v[132:135], a[8:11], v[92:95], v[132:135]
    ds_read_b128 a[40:43], v10 offset:57344
    v_cvt_pk_bf16_f32 v98, v68, v69
    v_mfma_f32_16x16x32_bf16 v[136:139], a[12:15], v[88:91], v[136:139]
    v_exp_f32 v75, v75
    v_mfma_f32_16x16x32_bf16 v[140:143], a[12:15], v[92:95], v[140:143]
    ds_read_b128 a[44:47], v11 offset:57344
    v_cvt_pk_bf16_f32 v99, v70, v71
    s_waitcnt lgkmcnt(4)
    v_mfma_f32_16x16x32_bf16 v[144:147], a[16:19], v[88:91], v[144:147]
    v_exp_f32 v76, v76
    v_mfma_f32_16x16x32_bf16 v[148:151], a[16:19], v[92:95], v[148:151]
    ds_read_b128 a[0:3], v8 offset:61440
    v_cvt_pk_bf16_f32 v100, v72, v73
    v_mfma_f32_16x16x32_bf16 v[152:155], a[20:23], v[88:91], v[152:155]
    v_exp_f32 v77, v77
    v_mfma_f32_16x16x32_bf16 v[156:159], a[20:23], v[92:95], v[156:159]
    ds_read_b128 a[4:7], v9 offset:61440
    v_cvt_pk_bf16_f32 v101, v74, v75
    v_mfma_f32_16x16x32_bf16 v[160:163], a[24:27], v[88:91], v[160:163]
    v_exp_f32 v78, v78
    v_mfma_f32_16x16x32_bf16 v[164:167], a[24:27], v[92:95], v[164:167]
    ds_read_b128 a[8:11], v10 offset:61440
    v_cvt_pk_bf16_f32 v102, v76, v77
    v_mfma_f32_16x16x32_bf16 v[168:171], a[28:31], v[88:91], v[168:171]
    v_exp_f32 v79, v79
    v_mfma_f32_16x16x32_bf16 v[172:175], a[28:31], v[92:95], v[172:175]
    ds_read_b128 a[12:15], v11 offset:61440
    v_cvt_pk_bf16_f32 v103, v78, v79
    s_waitcnt lgkmcnt(4)
    v_mfma_f32_16x16x32_bf16 v[64:67], a[32:35], v[176:179], v[80:83]
    v_exp_f32 v48, v48
    v_mfma_f32_16x16x32_bf16 v[72:75], a[32:35], v[192:195], v[84:87]
    ds_read_b64_tr_b16 a[16:17], v16 offset:57344
    ds_read_b64_tr_b16 a[18:19], v16 offset:61440
    v_mfma_f32_16x16x32_bf16 v[64:67], a[36:39], v[180:183], v[64:67]
    v_exp_f32 v49, v49
    v_mfma_f32_16x16x32_bf16 v[72:75], a[36:39], v[196:199], v[72:75]
    ds_read_b64_tr_b16 a[20:21], v17 offset:57344
    ds_read_b64_tr_b16 a[22:23], v17 offset:61440
    v_mfma_f32_16x16x32_bf16 v[64:67], a[40:43], v[184:187], v[64:67]
    v_exp_f32 v50, v50
    v_mfma_f32_16x16x32_bf16 v[72:75], a[40:43], v[200:203], v[72:75]
    ds_read_b64_tr_b16 a[24:25], v18 offset:57344
    ds_read_b64_tr_b16 a[26:27], v18 offset:61440
    v_mfma_f32_16x16x32_bf16 v[64:67], a[44:47], v[188:191], v[64:67]
    v_exp_f32 v51, v51
    v_mfma_f32_16x16x32_bf16 v[72:75], a[44:47], v[204:207], v[72:75]
    ds_read_b64_tr_b16 a[28:29], v19 offset:57344
    ds_read_b64_tr_b16 a[30:31], v19 offset:61440
    v_mfma_f32_16x16x32_bf16 v[104:107], v[44:47], v[96:99], v[104:107]
    s_waitcnt lgkmcnt(8)
    v_mfma_f32_16x16x32_bf16 v[68:71], a[0:3], v[176:179], v[80:83]
    v_exp_f32 v52, v52
    v_mfma_f32_16x16x32_bf16 v[76:79], a[0:3], v[192:195], v[84:87]
    ds_read_b64_tr_b16 a[32:33], v20 offset:57344
    ds_read_b64_tr_b16 a[34:35], v20 offset:61440
    v_mfma_f32_16x16x32_bf16 v[68:71], a[4:7], v[180:183], v[68:71]
    v_exp_f32 v53, v53
    v_mfma_f32_16x16x32_bf16 v[76:79], a[4:7], v[196:199], v[76:79]
    ds_read_b64_tr_b16 a[36:37], v21 offset:57344
    ds_read_b64_tr_b16 a[38:39], v21 offset:61440
    v_mfma_f32_16x16x32_bf16 v[68:71], a[8:11], v[184:187], v[68:71]
    v_exp_f32 v54, v54
    v_mfma_f32_16x16x32_bf16 v[76:79], a[8:11], v[200:203], v[76:79]
    ds_read_b64_tr_b16 a[40:41], v22 offset:57344
    ds_read_b64_tr_b16 a[42:43], v22 offset:61440
    v_mfma_f32_16x16x32_bf16 v[68:71], a[12:15], v[188:191], v[68:71]
    v_exp_f32 v55, v55
    v_mfma_f32_16x16x32_bf16 v[76:79], a[12:15], v[204:207], v[76:79]
    ds_read_b64_tr_b16 a[44:45], v23 offset:57344
    ds_read_b64_tr_b16 a[46:47], v23 offset:61440
    v_mfma_f32_16x16x32_bf16 v[108:111], v[44:47], v[100:103], v[108:111]
    s_waitcnt lgkmcnt(8)
    v_mfma_f32_16x16x32_bf16 v[112:115], a[16:19], v[96:99], v[112:115]
    v_exp_f32 v56, v56
    v_mfma_f32_16x16x32_bf16 v[116:119], a[16:19], v[100:103], v[116:119]
    v_cvt_pk_bf16_f32 v88, v48, v49
    v_mfma_f32_16x16x32_bf16 v[120:123], a[20:23], v[96:99], v[120:123]
    v_exp_f32 v57, v57
    v_mfma_f32_16x16x32_bf16 v[124:127], a[20:23], v[100:103], v[124:127]
    v_cvt_pk_bf16_f32 v89, v50, v51
    v_mfma_f32_16x16x32_bf16 v[128:131], a[24:27], v[96:99], v[128:131]
    v_exp_f32 v58, v58
    v_cvt_pk_bf16_f32 v90, v52, v53
    s_waitcnt lgkmcnt(0)
    v_mfma_f32_16x16x32_bf16 v[132:135], a[24:27], v[100:103], v[132:135]
    s_barrier
    v_mfma_f32_16x16x32_bf16 v[136:139], a[28:31], v[96:99], v[136:139]
    ds_read_b128 a[0:3], v8 offset:0
    v_exp_f32 v59, v59
    v_mfma_f32_16x16x32_bf16 v[140:143], a[28:31], v[100:103], v[140:143]
    ds_read_b128 a[4:7], v9 offset:0
    ds_read_b128 a[8:11], v10 offset:0
    v_cvt_pk_bf16_f32 v91, v54, v55
    v_mfma_f32_16x16x32_bf16 v[144:147], a[32:35], v[96:99], v[144:147]
    v_exp_f32 v60, v60
    v_mfma_f32_16x16x32_bf16 v[148:151], a[32:35], v[100:103], v[148:151]
    ds_read_b128 a[12:15], v11 offset:0
    ds_read_b128 a[16:19], v8 offset:4096
    v_cvt_pk_bf16_f32 v92, v56, v57
    v_mfma_f32_16x16x32_bf16 v[152:155], a[36:39], v[96:99], v[152:155]
    v_exp_f32 v61, v61
    v_mfma_f32_16x16x32_bf16 v[156:159], a[36:39], v[100:103], v[156:159]
    ds_read_b128 a[20:23], v9 offset:4096
    v_cvt_pk_bf16_f32 v93, v58, v59
    v_mfma_f32_16x16x32_bf16 v[160:163], a[40:43], v[96:99], v[160:163]
    v_exp_f32 v62, v62
    v_mfma_f32_16x16x32_bf16 v[164:167], a[40:43], v[100:103], v[164:167]
    ds_read_b128 a[24:27], v10 offset:4096
    v_cvt_pk_bf16_f32 v94, v60, v61
    v_mfma_f32_16x16x32_bf16 v[168:171], a[44:47], v[96:99], v[168:171]
    v_exp_f32 v63, v63
    v_mfma_f32_16x16x32_bf16 v[172:175], a[44:47], v[100:103], v[172:175]
    ds_read_b128 a[28:31], v11 offset:4096
    v_cvt_pk_bf16_f32 v95, v62, v63
    s_waitcnt lgkmcnt(4)
    v_mfma_f32_16x16x32_bf16 v[48:51], a[0:3], v[176:179], v[80:83]
    v_exp_f32 v64, v64
    v_mfma_f32_16x16x32_bf16 v[56:59], a[0:3], v[192:195], v[84:87]
    ds_read_b64_tr_b16 a[32:33], v16 offset:0
    ds_read_b64_tr_b16 a[34:35], v16 offset:4096
    v_mfma_f32_16x16x32_bf16 v[48:51], a[4:7], v[180:183], v[48:51]
    v_exp_f32 v65, v65
    v_mfma_f32_16x16x32_bf16 v[56:59], a[4:7], v[196:199], v[56:59]
    ds_read_b64_tr_b16 a[36:37], v17 offset:0
    ds_read_b64_tr_b16 a[38:39], v17 offset:4096
    v_mfma_f32_16x16x32_bf16 v[48:51], a[8:11], v[184:187], v[48:51]
    v_exp_f32 v66, v66
    v_mfma_f32_16x16x32_bf16 v[56:59], a[8:11], v[200:203], v[56:59]
    ds_read_b64_tr_b16 a[40:41], v18 offset:0
    ds_read_b64_tr_b16 a[42:43], v18 offset:4096
    v_mfma_f32_16x16x32_bf16 v[48:51], a[12:15], v[188:191], v[48:51]
    v_exp_f32 v67, v67
    v_mfma_f32_16x16x32_bf16 v[56:59], a[12:15], v[204:207], v[56:59]
    ds_read_b64_tr_b16 a[44:45], v19 offset:0
    ds_read_b64_tr_b16 a[46:47], v19 offset:4096
    v_mfma_f32_16x16x32_bf16 v[104:107], v[44:47], v[88:91], v[104:107]
    s_waitcnt lgkmcnt(8)
    v_mfma_f32_16x16x32_bf16 v[52:55], a[16:19], v[176:179], v[80:83]
    v_exp_f32 v68, v68
    v_mfma_f32_16x16x32_bf16 v[60:63], a[16:19], v[192:195], v[84:87]
    ds_read_b64_tr_b16 a[0:1], v20 offset:0
    ds_read_b64_tr_b16 a[2:3], v20 offset:4096
    v_mfma_f32_16x16x32_bf16 v[52:55], a[20:23], v[180:183], v[52:55]
    v_exp_f32 v69, v69
    v_mfma_f32_16x16x32_bf16 v[60:63], a[20:23], v[196:199], v[60:63]
    ds_read_b64_tr_b16 a[4:5], v21 offset:0
    ds_read_b64_tr_b16 a[6:7], v21 offset:4096
    v_mfma_f32_16x16x32_bf16 v[52:55], a[24:27], v[184:187], v[52:55]
    v_exp_f32 v70, v70
    v_mfma_f32_16x16x32_bf16 v[60:63], a[24:27], v[200:203], v[60:63]
    ds_read_b64_tr_b16 a[8:9], v22 offset:0
    ds_read_b64_tr_b16 a[10:11], v22 offset:4096
    v_mfma_f32_16x16x32_bf16 v[52:55], a[28:31], v[188:191], v[52:55]
    v_exp_f32 v71, v71
    v_mfma_f32_16x16x32_bf16 v[60:63], a[28:31], v[204:207], v[60:63]
    ds_read_b64_tr_b16 a[12:13], v23 offset:0
    ds_read_b64_tr_b16 a[14:15], v23 offset:4096
    v_mfma_f32_16x16x32_bf16 v[108:111], v[44:47], v[92:95], v[108:111]
    s_waitcnt lgkmcnt(8)
    v_mfma_f32_16x16x32_bf16 v[112:115], a[32:35], v[88:91], v[112:115]
    v_exp_f32 v72, v72
    v_mfma_f32_16x16x32_bf16 v[116:119], a[32:35], v[92:95], v[116:119]
    ds_read_b128 a[16:19], v8 offset:8192
    v_cvt_pk_bf16_f32 v96, v64, v65
    v_mfma_f32_16x16x32_bf16 v[120:123], a[36:39], v[88:91], v[120:123]
    v_exp_f32 v73, v73
    v_mfma_f32_16x16x32_bf16 v[124:127], a[36:39], v[92:95], v[124:127]
    ds_read_b128 a[20:23], v9 offset:8192
    v_cvt_pk_bf16_f32 v97, v66, v67
    v_mfma_f32_16x16x32_bf16 v[128:131], a[40:43], v[88:91], v[128:131]
    v_exp_f32 v74, v74
    v_mfma_f32_16x16x32_bf16 v[132:135], a[40:43], v[92:95], v[132:135]
    ds_read_b128 a[24:27], v10 offset:8192
    v_cvt_pk_bf16_f32 v98, v68, v69
    v_mfma_f32_16x16x32_bf16 v[136:139], a[44:47], v[88:91], v[136:139]
    v_exp_f32 v75, v75
    v_mfma_f32_16x16x32_bf16 v[140:143], a[44:47], v[92:95], v[140:143]
    ds_read_b128 a[28:31], v11 offset:8192
    v_cvt_pk_bf16_f32 v99, v70, v71
    s_waitcnt lgkmcnt(4)
    v_mfma_f32_16x16x32_bf16 v[144:147], a[0:3], v[88:91], v[144:147]
    v_exp_f32 v76, v76
    v_mfma_f32_16x16x32_bf16 v[148:151], a[0:3], v[92:95], v[148:151]
    ds_read_b128 a[32:35], v8 offset:12288
    v_cvt_pk_bf16_f32 v100, v72, v73
    v_mfma_f32_16x16x32_bf16 v[152:155], a[4:7], v[88:91], v[152:155]
    v_exp_f32 v77, v77
    v_mfma_f32_16x16x32_bf16 v[156:159], a[4:7], v[92:95], v[156:159]
    ds_read_b128 a[36:39], v9 offset:12288
    v_cvt_pk_bf16_f32 v101, v74, v75
    v_mfma_f32_16x16x32_bf16 v[160:163], a[8:11], v[88:91], v[160:163]
    v_exp_f32 v78, v78
    v_mfma_f32_16x16x32_bf16 v[164:167], a[8:11], v[92:95], v[164:167]
    ds_read_b128 a[40:43], v10 offset:12288
    v_cvt_pk_bf16_f32 v102, v76, v77
    v_mfma_f32_16x16x32_bf16 v[168:171], a[12:15], v[88:91], v[168:171]
    v_exp_f32 v79, v79
    v_mfma_f32_16x16x32_bf16 v[172:175], a[12:15], v[92:95], v[172:175]
    ds_read_b128 a[44:47], v11 offset:12288
    v_cvt_pk_bf16_f32 v103, v78, v79
    s_waitcnt lgkmcnt(4)
    v_mfma_f32_16x16x32_bf16 v[64:67], a[16:19], v[176:179], v[80:83]
    v_exp_f32 v48, v48
    v_mfma_f32_16x16x32_bf16 v[72:75], a[16:19], v[192:195], v[84:87]
    ds_read_b64_tr_b16 a[0:1], v16 offset:8192
    ds_read_b64_tr_b16 a[2:3], v16 offset:12288
    v_mfma_f32_16x16x32_bf16 v[64:67], a[20:23], v[180:183], v[64:67]
    v_exp_f32 v49, v49
    v_mfma_f32_16x16x32_bf16 v[72:75], a[20:23], v[196:199], v[72:75]
    ds_read_b64_tr_b16 a[4:5], v17 offset:8192
    ds_read_b64_tr_b16 a[6:7], v17 offset:12288
    v_mfma_f32_16x16x32_bf16 v[64:67], a[24:27], v[184:187], v[64:67]
    v_exp_f32 v50, v50
    v_mfma_f32_16x16x32_bf16 v[72:75], a[24:27], v[200:203], v[72:75]
    ds_read_b64_tr_b16 a[8:9], v18 offset:8192
    ds_read_b64_tr_b16 a[10:11], v18 offset:12288
    v_mfma_f32_16x16x32_bf16 v[64:67], a[28:31], v[188:191], v[64:67]
    v_exp_f32 v51, v51
    v_mfma_f32_16x16x32_bf16 v[72:75], a[28:31], v[204:207], v[72:75]
    ds_read_b64_tr_b16 a[12:13], v19 offset:8192
    ds_read_b64_tr_b16 a[14:15], v19 offset:12288
    v_mfma_f32_16x16x32_bf16 v[104:107], v[44:47], v[96:99], v[104:107]
    s_waitcnt lgkmcnt(8)
    v_mfma_f32_16x16x32_bf16 v[68:71], a[32:35], v[176:179], v[80:83]
    v_exp_f32 v52, v52
    v_mfma_f32_16x16x32_bf16 v[76:79], a[32:35], v[192:195], v[84:87]
    ds_read_b64_tr_b16 a[16:17], v20 offset:8192
    ds_read_b64_tr_b16 a[18:19], v20 offset:12288
    v_mfma_f32_16x16x32_bf16 v[68:71], a[36:39], v[180:183], v[68:71]
    v_exp_f32 v53, v53
    v_mfma_f32_16x16x32_bf16 v[76:79], a[36:39], v[196:199], v[76:79]
    ds_read_b64_tr_b16 a[20:21], v21 offset:8192
    ds_read_b64_tr_b16 a[22:23], v21 offset:12288
    v_mfma_f32_16x16x32_bf16 v[68:71], a[40:43], v[184:187], v[68:71]
    v_exp_f32 v54, v54
    v_mfma_f32_16x16x32_bf16 v[76:79], a[40:43], v[200:203], v[76:79]
    ds_read_b64_tr_b16 a[24:25], v22 offset:8192
    ds_read_b64_tr_b16 a[26:27], v22 offset:12288
    v_mfma_f32_16x16x32_bf16 v[68:71], a[44:47], v[188:191], v[68:71]
    v_exp_f32 v55, v55
    v_mfma_f32_16x16x32_bf16 v[76:79], a[44:47], v[204:207], v[76:79]
    ds_read_b64_tr_b16 a[28:29], v23 offset:8192
    ds_read_b64_tr_b16 a[30:31], v23 offset:12288
    v_mfma_f32_16x16x32_bf16 v[108:111], v[44:47], v[100:103], v[108:111]
    s_waitcnt lgkmcnt(8)
    v_mfma_f32_16x16x32_bf16 v[112:115], a[0:3], v[96:99], v[112:115]
    v_exp_f32 v56, v56
    v_mfma_f32_16x16x32_bf16 v[116:119], a[0:3], v[100:103], v[116:119]
    v_cvt_pk_bf16_f32 v88, v48, v49
    v_mfma_f32_16x16x32_bf16 v[120:123], a[4:7], v[96:99], v[120:123]
    v_exp_f32 v57, v57
    v_mfma_f32_16x16x32_bf16 v[124:127], a[4:7], v[100:103], v[124:127]
    v_cvt_pk_bf16_f32 v89, v50, v51
    v_mfma_f32_16x16x32_bf16 v[128:131], a[8:11], v[96:99], v[128:131]
    v_exp_f32 v58, v58
    v_cvt_pk_bf16_f32 v90, v52, v53
    s_waitcnt lgkmcnt(0)
    v_mfma_f32_16x16x32_bf16 v[132:135], a[8:11], v[100:103], v[132:135]
    s_barrier
    v_mfma_f32_16x16x32_bf16 v[136:139], a[12:15], v[96:99], v[136:139]
    ds_read_b128 a[32:35], v8 offset:16384
    v_exp_f32 v59, v59
    v_mfma_f32_16x16x32_bf16 v[140:143], a[12:15], v[100:103], v[140:143]
    ds_read_b128 a[36:39], v9 offset:16384
    ds_read_b128 a[40:43], v10 offset:16384
    v_cvt_pk_bf16_f32 v91, v54, v55
    v_mfma_f32_16x16x32_bf16 v[144:147], a[16:19], v[96:99], v[144:147]
    v_exp_f32 v60, v60
    v_mfma_f32_16x16x32_bf16 v[148:151], a[16:19], v[100:103], v[148:151]
    ds_read_b128 a[44:47], v11 offset:16384
    ds_read_b128 a[0:3], v8 offset:20480
    v_cvt_pk_bf16_f32 v92, v56, v57
    v_mfma_f32_16x16x32_bf16 v[152:155], a[20:23], v[96:99], v[152:155]
    v_exp_f32 v61, v61
    v_mfma_f32_16x16x32_bf16 v[156:159], a[20:23], v[100:103], v[156:159]
    ds_read_b128 a[4:7], v9 offset:20480
    v_cvt_pk_bf16_f32 v93, v58, v59
    v_mfma_f32_16x16x32_bf16 v[160:163], a[24:27], v[96:99], v[160:163]
    v_exp_f32 v62, v62
    v_mfma_f32_16x16x32_bf16 v[164:167], a[24:27], v[100:103], v[164:167]
    ds_read_b128 a[8:11], v10 offset:20480
    v_cvt_pk_bf16_f32 v94, v60, v61
    v_mfma_f32_16x16x32_bf16 v[168:171], a[28:31], v[96:99], v[168:171]
    v_exp_f32 v63, v63
    v_mfma_f32_16x16x32_bf16 v[172:175], a[28:31], v[100:103], v[172:175]
    ds_read_b128 a[12:15], v11 offset:20480
    v_cvt_pk_bf16_f32 v95, v62, v63
    s_waitcnt lgkmcnt(4)
    v_mfma_f32_16x16x32_bf16 v[48:51], a[32:35], v[176:179], v[80:83]
    v_exp_f32 v64, v64
    v_mfma_f32_16x16x32_bf16 v[56:59], a[32:35], v[192:195], v[84:87]
    ds_read_b64_tr_b16 a[16:17], v16 offset:16384
    ds_read_b64_tr_b16 a[18:19], v16 offset:20480
    v_mfma_f32_16x16x32_bf16 v[48:51], a[36:39], v[180:183], v[48:51]
    v_exp_f32 v65, v65
    v_mfma_f32_16x16x32_bf16 v[56:59], a[36:39], v[196:199], v[56:59]
    ds_read_b64_tr_b16 a[20:21], v17 offset:16384
    ds_read_b64_tr_b16 a[22:23], v17 offset:20480
    v_mfma_f32_16x16x32_bf16 v[48:51], a[40:43], v[184:187], v[48:51]
    v_exp_f32 v66, v66
    v_mfma_f32_16x16x32_bf16 v[56:59], a[40:43], v[200:203], v[56:59]
    ds_read_b64_tr_b16 a[24:25], v18 offset:16384
    ds_read_b64_tr_b16 a[26:27], v18 offset:20480
    v_mfma_f32_16x16x32_bf16 v[48:51], a[44:47], v[188:191], v[48:51]
    v_exp_f32 v67, v67
    v_mfma_f32_16x16x32_bf16 v[56:59], a[44:47], v[204:207], v[56:59]
    ds_read_b64_tr_b16 a[28:29], v19 offset:16384
    ds_read_b64_tr_b16 a[30:31], v19 offset:20480
    v_mfma_f32_16x16x32_bf16 v[104:107], v[44:47], v[88:91], v[104:107]
    s_waitcnt lgkmcnt(8)
    v_mfma_f32_16x16x32_bf16 v[52:55], a[0:3], v[176:179], v[80:83]
    v_exp_f32 v68, v68
    v_mfma_f32_16x16x32_bf16 v[60:63], a[0:3], v[192:195], v[84:87]
    ds_read_b64_tr_b16 a[32:33], v20 offset:16384
    ds_read_b64_tr_b16 a[34:35], v20 offset:20480
    v_mfma_f32_16x16x32_bf16 v[52:55], a[4:7], v[180:183], v[52:55]
    v_exp_f32 v69, v69
    v_mfma_f32_16x16x32_bf16 v[60:63], a[4:7], v[196:199], v[60:63]
    ds_read_b64_tr_b16 a[36:37], v21 offset:16384
    ds_read_b64_tr_b16 a[38:39], v21 offset:20480
    v_mfma_f32_16x16x32_bf16 v[52:55], a[8:11], v[184:187], v[52:55]
    v_exp_f32 v70, v70
    v_mfma_f32_16x16x32_bf16 v[60:63], a[8:11], v[200:203], v[60:63]
    ds_read_b64_tr_b16 a[40:41], v22 offset:16384
    ds_read_b64_tr_b16 a[42:43], v22 offset:20480
    v_mfma_f32_16x16x32_bf16 v[52:55], a[12:15], v[188:191], v[52:55]
    v_exp_f32 v71, v71
    v_mfma_f32_16x16x32_bf16 v[60:63], a[12:15], v[204:207], v[60:63]
    ds_read_b64_tr_b16 a[44:45], v23 offset:16384
    ds_read_b64_tr_b16 a[46:47], v23 offset:20480
    v_mfma_f32_16x16x32_bf16 v[108:111], v[44:47], v[92:95], v[108:111]
    s_waitcnt lgkmcnt(8)
    v_mfma_f32_16x16x32_bf16 v[112:115], a[16:19], v[88:91], v[112:115]
    v_exp_f32 v72, v72
    v_mfma_f32_16x16x32_bf16 v[116:119], a[16:19], v[92:95], v[116:119]
    ds_read_b128 a[0:3], v8 offset:24576
    v_cvt_pk_bf16_f32 v96, v64, v65
    v_mfma_f32_16x16x32_bf16 v[120:123], a[20:23], v[88:91], v[120:123]
    v_exp_f32 v73, v73
    v_mfma_f32_16x16x32_bf16 v[124:127], a[20:23], v[92:95], v[124:127]
    ds_read_b128 a[4:7], v9 offset:24576
    v_cvt_pk_bf16_f32 v97, v66, v67
    v_mfma_f32_16x16x32_bf16 v[128:131], a[24:27], v[88:91], v[128:131]
    v_exp_f32 v74, v74
    v_mfma_f32_16x16x32_bf16 v[132:135], a[24:27], v[92:95], v[132:135]
    ds_read_b128 a[8:11], v10 offset:24576
    v_cvt_pk_bf16_f32 v98, v68, v69
    v_mfma_f32_16x16x32_bf16 v[136:139], a[28:31], v[88:91], v[136:139]
    v_exp_f32 v75, v75
    v_mfma_f32_16x16x32_bf16 v[140:143], a[28:31], v[92:95], v[140:143]
    ds_read_b128 a[12:15], v11 offset:24576
    v_cvt_pk_bf16_f32 v99, v70, v71
    s_waitcnt lgkmcnt(4)
    v_mfma_f32_16x16x32_bf16 v[144:147], a[32:35], v[88:91], v[144:147]
    v_exp_f32 v76, v76
    v_mfma_f32_16x16x32_bf16 v[148:151], a[32:35], v[92:95], v[148:151]
    ds_read_b128 a[16:19], v8 offset:28672
    v_cvt_pk_bf16_f32 v100, v72, v73
    v_mfma_f32_16x16x32_bf16 v[152:155], a[36:39], v[88:91], v[152:155]
    v_exp_f32 v77, v77
    v_mfma_f32_16x16x32_bf16 v[156:159], a[36:39], v[92:95], v[156:159]
    ds_read_b128 a[20:23], v9 offset:28672
    v_cvt_pk_bf16_f32 v101, v74, v75
    v_mfma_f32_16x16x32_bf16 v[160:163], a[40:43], v[88:91], v[160:163]
    v_exp_f32 v78, v78
    v_mfma_f32_16x16x32_bf16 v[164:167], a[40:43], v[92:95], v[164:167]
    ds_read_b128 a[24:27], v10 offset:28672
    v_cvt_pk_bf16_f32 v102, v76, v77
    v_mfma_f32_16x16x32_bf16 v[168:171], a[44:47], v[88:91], v[168:171]
    v_exp_f32 v79, v79
    v_mfma_f32_16x16x32_bf16 v[172:175], a[44:47], v[92:95], v[172:175]
    ds_read_b128 a[28:31], v11 offset:28672
    v_cvt_pk_bf16_f32 v103, v78, v79
    s_waitcnt lgkmcnt(4)
    v_mfma_f32_16x16x32_bf16 v[64:67], a[0:3], v[176:179], v[80:83]
    v_exp_f32 v48, v48
    v_mfma_f32_16x16x32_bf16 v[72:75], a[0:3], v[192:195], v[84:87]
    ds_read_b64_tr_b16 a[32:33], v16 offset:24576
    ds_read_b64_tr_b16 a[34:35], v16 offset:28672
    v_mfma_f32_16x16x32_bf16 v[64:67], a[4:7], v[180:183], v[64:67]
    v_exp_f32 v49, v49
    v_mfma_f32_16x16x32_bf16 v[72:75], a[4:7], v[196:199], v[72:75]
    ds_read_b64_tr_b16 a[36:37], v17 offset:24576
    ds_read_b64_tr_b16 a[38:39], v17 offset:28672
    v_mfma_f32_16x16x32_bf16 v[64:67], a[8:11], v[184:187], v[64:67]
    v_exp_f32 v50, v50
    v_mfma_f32_16x16x32_bf16 v[72:75], a[8:11], v[200:203], v[72:75]
    ds_read_b64_tr_b16 a[40:41], v18 offset:24576
    ds_read_b64_tr_b16 a[42:43], v18 offset:28672
    v_mfma_f32_16x16x32_bf16 v[64:67], a[12:15], v[188:191], v[64:67]
    v_exp_f32 v51, v51
    v_mfma_f32_16x16x32_bf16 v[72:75], a[12:15], v[204:207], v[72:75]
    ds_read_b64_tr_b16 a[44:45], v19 offset:24576
    ds_read_b64_tr_b16 a[46:47], v19 offset:28672
    v_mfma_f32_16x16x32_bf16 v[104:107], v[44:47], v[96:99], v[104:107]
    s_waitcnt lgkmcnt(8)
    v_mfma_f32_16x16x32_bf16 v[68:71], a[16:19], v[176:179], v[80:83]
    v_exp_f32 v52, v52
    v_mfma_f32_16x16x32_bf16 v[76:79], a[16:19], v[192:195], v[84:87]
    ds_read_b64_tr_b16 a[0:1], v20 offset:24576
    ds_read_b64_tr_b16 a[2:3], v20 offset:28672
    v_mfma_f32_16x16x32_bf16 v[68:71], a[20:23], v[180:183], v[68:71]
    v_exp_f32 v53, v53
    v_mfma_f32_16x16x32_bf16 v[76:79], a[20:23], v[196:199], v[76:79]
    ds_read_b64_tr_b16 a[4:5], v21 offset:24576
    ds_read_b64_tr_b16 a[6:7], v21 offset:28672
    v_mfma_f32_16x16x32_bf16 v[68:71], a[24:27], v[184:187], v[68:71]
    v_exp_f32 v54, v54
    v_mfma_f32_16x16x32_bf16 v[76:79], a[24:27], v[200:203], v[76:79]
    ds_read_b64_tr_b16 a[8:9], v22 offset:24576
    ds_read_b64_tr_b16 a[10:11], v22 offset:28672
    v_mfma_f32_16x16x32_bf16 v[68:71], a[28:31], v[188:191], v[68:71]
    v_exp_f32 v55, v55
    v_mfma_f32_16x16x32_bf16 v[76:79], a[28:31], v[204:207], v[76:79]
    ds_read_b64_tr_b16 a[12:13], v23 offset:24576
    ds_read_b64_tr_b16 a[14:15], v23 offset:28672
    v_mfma_f32_16x16x32_bf16 v[108:111], v[44:47], v[100:103], v[108:111]
    s_waitcnt lgkmcnt(8)
    v_mfma_f32_16x16x32_bf16 v[112:115], a[32:35], v[96:99], v[112:115]
    v_exp_f32 v56, v56
    v_mfma_f32_16x16x32_bf16 v[116:119], a[32:35], v[100:103], v[116:119]
    v_cvt_pk_bf16_f32 v88, v48, v49
    v_mfma_f32_16x16x32_bf16 v[120:123], a[36:39], v[96:99], v[120:123]
    v_exp_f32 v57, v57
    v_mfma_f32_16x16x32_bf16 v[124:127], a[36:39], v[100:103], v[124:127]
    v_cvt_pk_bf16_f32 v89, v50, v51
    v_mfma_f32_16x16x32_bf16 v[128:131], a[40:43], v[96:99], v[128:131]
    v_exp_f32 v58, v58
    v_cvt_pk_bf16_f32 v90, v52, v53
    s_waitcnt lgkmcnt(0)
    v_mfma_f32_16x16x32_bf16 v[132:135], a[40:43], v[100:103], v[132:135]
    s_barrier
    v_mfma_f32_16x16x32_bf16 v[136:139], a[44:47], v[96:99], v[136:139]
    ds_read_b128 a[16:19], v8 offset:32768
    v_exp_f32 v59, v59
    v_mfma_f32_16x16x32_bf16 v[140:143], a[44:47], v[100:103], v[140:143]
    ds_read_b128 a[20:23], v9 offset:32768
    ds_read_b128 a[24:27], v10 offset:32768
    v_cvt_pk_bf16_f32 v91, v54, v55
    v_mfma_f32_16x16x32_bf16 v[144:147], a[0:3], v[96:99], v[144:147]
    v_exp_f32 v60, v60
    v_mfma_f32_16x16x32_bf16 v[148:151], a[0:3], v[100:103], v[148:151]
    ds_read_b128 a[28:31], v11 offset:32768
    ds_read_b128 a[32:35], v8 offset:36864
    v_cvt_pk_bf16_f32 v92, v56, v57
    v_mfma_f32_16x16x32_bf16 v[152:155], a[4:7], v[96:99], v[152:155]
    v_exp_f32 v61, v61
    v_mfma_f32_16x16x32_bf16 v[156:159], a[4:7], v[100:103], v[156:159]
    ds_read_b128 a[36:39], v9 offset:36864
    v_cvt_pk_bf16_f32 v93, v58, v59
    v_mfma_f32_16x16x32_bf16 v[160:163], a[8:11], v[96:99], v[160:163]
    v_exp_f32 v62, v62
    v_mfma_f32_16x16x32_bf16 v[164:167], a[8:11], v[100:103], v[164:167]
    ds_read_b128 a[40:43], v10 offset:36864
    v_cvt_pk_bf16_f32 v94, v60, v61
    v_mfma_f32_16x16x32_bf16 v[168:171], a[12:15], v[96:99], v[168:171]
    v_exp_f32 v63, v63
    v_mfma_f32_16x16x32_bf16 v[172:175], a[12:15], v[100:103], v[172:175]
    ds_read_b128 a[44:47], v11 offset:36864
    v_cvt_pk_bf16_f32 v95, v62, v63
    s_waitcnt lgkmcnt(4)
    v_mfma_f32_16x16x32_bf16 v[48:51], a[16:19], v[176:179], v[80:83]
    v_exp_f32 v64, v64
    v_mfma_f32_16x16x32_bf16 v[56:59], a[16:19], v[192:195], v[84:87]
    ds_read_b64_tr_b16 a[0:1], v16 offset:32768
    ds_read_b64_tr_b16 a[2:3], v16 offset:36864
    v_mfma_f32_16x16x32_bf16 v[48:51], a[20:23], v[180:183], v[48:51]
    v_exp_f32 v65, v65
    v_mfma_f32_16x16x32_bf16 v[56:59], a[20:23], v[196:199], v[56:59]
    ds_read_b64_tr_b16 a[4:5], v17 offset:32768
    ds_read_b64_tr_b16 a[6:7], v17 offset:36864
    v_mfma_f32_16x16x32_bf16 v[48:51], a[24:27], v[184:187], v[48:51]
    v_exp_f32 v66, v66
    v_mfma_f32_16x16x32_bf16 v[56:59], a[24:27], v[200:203], v[56:59]
    ds_read_b64_tr_b16 a[8:9], v18 offset:32768
    ds_read_b64_tr_b16 a[10:11], v18 offset:36864
    v_mfma_f32_16x16x32_bf16 v[48:51], a[28:31], v[188:191], v[48:51]
    v_exp_f32 v67, v67
    v_mfma_f32_16x16x32_bf16 v[56:59], a[28:31], v[204:207], v[56:59]
    ds_read_b64_tr_b16 a[12:13], v19 offset:32768
    ds_read_b64_tr_b16 a[14:15], v19 offset:36864
    v_mfma_f32_16x16x32_bf16 v[104:107], v[44:47], v[88:91], v[104:107]
    s_waitcnt lgkmcnt(8)
    v_mfma_f32_16x16x32_bf16 v[52:55], a[32:35], v[176:179], v[80:83]
    v_exp_f32 v68, v68
    v_mfma_f32_16x16x32_bf16 v[60:63], a[32:35], v[192:195], v[84:87]
    ds_read_b64_tr_b16 a[16:17], v20 offset:32768
    ds_read_b64_tr_b16 a[18:19], v20 offset:36864
    v_mfma_f32_16x16x32_bf16 v[52:55], a[36:39], v[180:183], v[52:55]
    v_exp_f32 v69, v69
    v_mfma_f32_16x16x32_bf16 v[60:63], a[36:39], v[196:199], v[60:63]
    ds_read_b64_tr_b16 a[20:21], v21 offset:32768
    ds_read_b64_tr_b16 a[22:23], v21 offset:36864
    v_mfma_f32_16x16x32_bf16 v[52:55], a[40:43], v[184:187], v[52:55]
    v_exp_f32 v70, v70
    v_mfma_f32_16x16x32_bf16 v[60:63], a[40:43], v[200:203], v[60:63]
    ds_read_b64_tr_b16 a[24:25], v22 offset:32768
    ds_read_b64_tr_b16 a[26:27], v22 offset:36864
    v_mfma_f32_16x16x32_bf16 v[52:55], a[44:47], v[188:191], v[52:55]
    v_exp_f32 v71, v71
    v_mfma_f32_16x16x32_bf16 v[60:63], a[44:47], v[204:207], v[60:63]
    ds_read_b64_tr_b16 a[28:29], v23 offset:32768
    ds_read_b64_tr_b16 a[30:31], v23 offset:36864
    v_mfma_f32_16x16x32_bf16 v[108:111], v[44:47], v[92:95], v[108:111]
    s_waitcnt lgkmcnt(8)
    v_mfma_f32_16x16x32_bf16 v[112:115], a[0:3], v[88:91], v[112:115]
    v_exp_f32 v72, v72
    v_mfma_f32_16x16x32_bf16 v[116:119], a[0:3], v[92:95], v[116:119]
    ds_read_b128 a[32:35], v8 offset:40960
    v_cvt_pk_bf16_f32 v96, v64, v65
    v_mfma_f32_16x16x32_bf16 v[120:123], a[4:7], v[88:91], v[120:123]
    v_exp_f32 v73, v73
    v_mfma_f32_16x16x32_bf16 v[124:127], a[4:7], v[92:95], v[124:127]
    ds_read_b128 a[36:39], v9 offset:40960
    v_cvt_pk_bf16_f32 v97, v66, v67
    v_mfma_f32_16x16x32_bf16 v[128:131], a[8:11], v[88:91], v[128:131]
    v_exp_f32 v74, v74
    v_mfma_f32_16x16x32_bf16 v[132:135], a[8:11], v[92:95], v[132:135]
    ds_read_b128 a[40:43], v10 offset:40960
    v_cvt_pk_bf16_f32 v98, v68, v69
    v_mfma_f32_16x16x32_bf16 v[136:139], a[12:15], v[88:91], v[136:139]
    v_exp_f32 v75, v75
    v_mfma_f32_16x16x32_bf16 v[140:143], a[12:15], v[92:95], v[140:143]
    ds_read_b128 a[44:47], v11 offset:40960
    v_cvt_pk_bf16_f32 v99, v70, v71
    s_waitcnt lgkmcnt(4)
    v_mfma_f32_16x16x32_bf16 v[144:147], a[16:19], v[88:91], v[144:147]
    v_exp_f32 v76, v76
    v_mfma_f32_16x16x32_bf16 v[148:151], a[16:19], v[92:95], v[148:151]
    ds_read_b128 a[0:3], v8 offset:45056
    v_cvt_pk_bf16_f32 v100, v72, v73
    v_mfma_f32_16x16x32_bf16 v[152:155], a[20:23], v[88:91], v[152:155]
    v_exp_f32 v77, v77
    v_mfma_f32_16x16x32_bf16 v[156:159], a[20:23], v[92:95], v[156:159]
    ds_read_b128 a[4:7], v9 offset:45056
    v_cvt_pk_bf16_f32 v101, v74, v75
    v_mfma_f32_16x16x32_bf16 v[160:163], a[24:27], v[88:91], v[160:163]
    v_exp_f32 v78, v78
    v_mfma_f32_16x16x32_bf16 v[164:167], a[24:27], v[92:95], v[164:167]
    ds_read_b128 a[8:11], v10 offset:45056
    v_cvt_pk_bf16_f32 v102, v76, v77
    v_mfma_f32_16x16x32_bf16 v[168:171], a[28:31], v[88:91], v[168:171]
    v_exp_f32 v79, v79
    v_mfma_f32_16x16x32_bf16 v[172:175], a[28:31], v[92:95], v[172:175]
    ds_read_b128 a[12:15], v11 offset:45056
    v_cvt_pk_bf16_f32 v103, v78, v79
    s_waitcnt lgkmcnt(4)
    v_mfma_f32_16x16x32_bf16 v[64:67], a[32:35], v[176:179], v[80:83]
    v_exp_f32 v48, v48
    v_mfma_f32_16x16x32_bf16 v[72:75], a[32:35], v[192:195], v[84:87]
    ds_read_b64_tr_b16 a[16:17], v16 offset:40960
    ds_read_b64_tr_b16 a[18:19], v16 offset:45056
    v_mfma_f32_16x16x32_bf16 v[64:67], a[36:39], v[180:183], v[64:67]
    v_exp_f32 v49, v49
    v_mfma_f32_16x16x32_bf16 v[72:75], a[36:39], v[196:199], v[72:75]
    ds_read_b64_tr_b16 a[20:21], v17 offset:40960
    ds_read_b64_tr_b16 a[22:23], v17 offset:45056
    v_mfma_f32_16x16x32_bf16 v[64:67], a[40:43], v[184:187], v[64:67]
    v_exp_f32 v50, v50
    v_mfma_f32_16x16x32_bf16 v[72:75], a[40:43], v[200:203], v[72:75]
    ds_read_b64_tr_b16 a[24:25], v18 offset:40960
    ds_read_b64_tr_b16 a[26:27], v18 offset:45056
    v_mfma_f32_16x16x32_bf16 v[64:67], a[44:47], v[188:191], v[64:67]
    v_exp_f32 v51, v51
    v_mfma_f32_16x16x32_bf16 v[72:75], a[44:47], v[204:207], v[72:75]
    ds_read_b64_tr_b16 a[28:29], v19 offset:40960
    ds_read_b64_tr_b16 a[30:31], v19 offset:45056
    v_mfma_f32_16x16x32_bf16 v[104:107], v[44:47], v[96:99], v[104:107]
    s_waitcnt lgkmcnt(8)
    v_mfma_f32_16x16x32_bf16 v[68:71], a[0:3], v[176:179], v[80:83]
    v_exp_f32 v52, v52
    v_mfma_f32_16x16x32_bf16 v[76:79], a[0:3], v[192:195], v[84:87]
    ds_read_b64_tr_b16 a[32:33], v20 offset:40960
    ds_read_b64_tr_b16 a[34:35], v20 offset:45056
    v_mfma_f32_16x16x32_bf16 v[68:71], a[4:7], v[180:183], v[68:71]
    v_exp_f32 v53, v53
    v_mfma_f32_16x16x32_bf16 v[76:79], a[4:7], v[196:199], v[76:79]
    ds_read_b64_tr_b16 a[36:37], v21 offset:40960
    ds_read_b64_tr_b16 a[38:39], v21 offset:45056
    v_mfma_f32_16x16x32_bf16 v[68:71], a[8:11], v[184:187], v[68:71]
    v_exp_f32 v54, v54
    v_mfma_f32_16x16x32_bf16 v[76:79], a[8:11], v[200:203], v[76:79]
    ds_read_b64_tr_b16 a[40:41], v22 offset:40960
    ds_read_b64_tr_b16 a[42:43], v22 offset:45056
    v_mfma_f32_16x16x32_bf16 v[68:71], a[12:15], v[188:191], v[68:71]
    v_exp_f32 v55, v55
    v_mfma_f32_16x16x32_bf16 v[76:79], a[12:15], v[204:207], v[76:79]
    ds_read_b64_tr_b16 a[44:45], v23 offset:40960
    ds_read_b64_tr_b16 a[46:47], v23 offset:45056
    v_mfma_f32_16x16x32_bf16 v[108:111], v[44:47], v[100:103], v[108:111]
    s_waitcnt lgkmcnt(8)
    v_mfma_f32_16x16x32_bf16 v[112:115], a[16:19], v[96:99], v[112:115]
    v_exp_f32 v56, v56
    v_mfma_f32_16x16x32_bf16 v[116:119], a[16:19], v[100:103], v[116:119]
    v_cvt_pk_bf16_f32 v88, v48, v49
    v_mfma_f32_16x16x32_bf16 v[120:123], a[20:23], v[96:99], v[120:123]
    v_exp_f32 v57, v57
    v_mfma_f32_16x16x32_bf16 v[124:127], a[20:23], v[100:103], v[124:127]
    v_cvt_pk_bf16_f32 v89, v50, v51
    v_mfma_f32_16x16x32_bf16 v[128:131], a[24:27], v[96:99], v[128:131]
    v_exp_f32 v58, v58
    v_cvt_pk_bf16_f32 v90, v52, v53
    s_waitcnt lgkmcnt(0)
    v_mfma_f32_16x16x32_bf16 v[132:135], a[24:27], v[100:103], v[132:135]
    s_barrier
    v_mfma_f32_16x16x32_bf16 v[136:139], a[28:31], v[96:99], v[136:139]
    ds_read_b128 a[0:3], v8 offset:49152
    v_exp_f32 v59, v59
    v_mfma_f32_16x16x32_bf16 v[140:143], a[28:31], v[100:103], v[140:143]
    ds_read_b128 a[4:7], v9 offset:49152
    ds_read_b128 a[8:11], v10 offset:49152
    v_cvt_pk_bf16_f32 v91, v54, v55
    v_mfma_f32_16x16x32_bf16 v[144:147], a[32:35], v[96:99], v[144:147]
    v_exp_f32 v60, v60
    v_mfma_f32_16x16x32_bf16 v[148:151], a[32:35], v[100:103], v[148:151]
    ds_read_b128 a[12:15], v11 offset:49152
    ds_read_b128 a[16:19], v8 offset:53248
    v_cvt_pk_bf16_f32 v92, v56, v57
    v_mfma_f32_16x16x32_bf16 v[152:155], a[36:39], v[96:99], v[152:155]
    v_exp_f32 v61, v61
    v_mfma_f32_16x16x32_bf16 v[156:159], a[36:39], v[100:103], v[156:159]
    ds_read_b128 a[20:23], v9 offset:53248
    v_cvt_pk_bf16_f32 v93, v58, v59
    v_mfma_f32_16x16x32_bf16 v[160:163], a[40:43], v[96:99], v[160:163]
    v_exp_f32 v62, v62
    v_mfma_f32_16x16x32_bf16 v[164:167], a[40:43], v[100:103], v[164:167]
    ds_read_b128 a[24:27], v10 offset:53248
    v_cvt_pk_bf16_f32 v94, v60, v61
    v_mfma_f32_16x16x32_bf16 v[168:171], a[44:47], v[96:99], v[168:171]
    v_exp_f32 v63, v63
    v_mfma_f32_16x16x32_bf16 v[172:175], a[44:47], v[100:103], v[172:175]
    ds_read_b128 a[28:31], v11 offset:53248
    v_cvt_pk_bf16_f32 v95, v62, v63
    s_waitcnt lgkmcnt(4)
    v_mfma_f32_16x16x32_bf16 v[48:51], a[0:3], v[176:179], v[80:83]
    v_exp_f32 v64, v64
    v_mfma_f32_16x16x32_bf16 v[56:59], a[0:3], v[192:195], v[84:87]
    ds_read_b64_tr_b16 a[32:33], v16 offset:49152
    ds_read_b64_tr_b16 a[34:35], v16 offset:53248
    v_mfma_f32_16x16x32_bf16 v[48:51], a[4:7], v[180:183], v[48:51]
    v_exp_f32 v65, v65
    v_mfma_f32_16x16x32_bf16 v[56:59], a[4:7], v[196:199], v[56:59]
    ds_read_b64_tr_b16 a[36:37], v17 offset:49152
    ds_read_b64_tr_b16 a[38:39], v17 offset:53248
    v_mfma_f32_16x16x32_bf16 v[48:51], a[8:11], v[184:187], v[48:51]
    v_exp_f32 v66, v66
    v_mfma_f32_16x16x32_bf16 v[56:59], a[8:11], v[200:203], v[56:59]
    ds_read_b64_tr_b16 a[40:41], v18 offset:49152
    ds_read_b64_tr_b16 a[42:43], v18 offset:53248
    v_mfma_f32_16x16x32_bf16 v[48:51], a[12:15], v[188:191], v[48:51]
    v_exp_f32 v67, v67
    v_mfma_f32_16x16x32_bf16 v[56:59], a[12:15], v[204:207], v[56:59]
    ds_read_b64_tr_b16 a[44:45], v19 offset:49152
    ds_read_b64_tr_b16 a[46:47], v19 offset:53248
    v_mfma_f32_16x16x32_bf16 v[104:107], v[44:47], v[88:91], v[104:107]
    s_waitcnt lgkmcnt(8)
    v_mfma_f32_16x16x32_bf16 v[52:55], a[16:19], v[176:179], v[80:83]
    v_exp_f32 v68, v68
    v_mfma_f32_16x16x32_bf16 v[60:63], a[16:19], v[192:195], v[84:87]
    ds_read_b64_tr_b16 a[0:1], v20 offset:49152
    ds_read_b64_tr_b16 a[2:3], v20 offset:53248
    v_mfma_f32_16x16x32_bf16 v[52:55], a[20:23], v[180:183], v[52:55]
    v_exp_f32 v69, v69
    v_mfma_f32_16x16x32_bf16 v[60:63], a[20:23], v[196:199], v[60:63]
    ds_read_b64_tr_b16 a[4:5], v21 offset:49152
    ds_read_b64_tr_b16 a[6:7], v21 offset:53248
    v_mfma_f32_16x16x32_bf16 v[52:55], a[24:27], v[184:187], v[52:55]
    v_exp_f32 v70, v70
    v_mfma_f32_16x16x32_bf16 v[60:63], a[24:27], v[200:203], v[60:63]
    ds_read_b64_tr_b16 a[8:9], v22 offset:49152
    ds_read_b64_tr_b16 a[10:11], v22 offset:53248
    v_mfma_f32_16x16x32_bf16 v[52:55], a[28:31], v[188:191], v[52:55]
    v_exp_f32 v71, v71
    v_mfma_f32_16x16x32_bf16 v[60:63], a[28:31], v[204:207], v[60:63]
    ds_read_b64_tr_b16 a[12:13], v23 offset:49152
    ds_read_b64_tr_b16 a[14:15], v23 offset:53248
    v_mfma_f32_16x16x32_bf16 v[108:111], v[44:47], v[92:95], v[108:111]
    s_waitcnt lgkmcnt(8)
    v_mfma_f32_16x16x32_bf16 v[112:115], a[32:35], v[88:91], v[112:115]
    v_exp_f32 v72, v72
    v_mfma_f32_16x16x32_bf16 v[116:119], a[32:35], v[92:95], v[116:119]
    ds_read_b128 a[16:19], v8 offset:57344
    v_cvt_pk_bf16_f32 v96, v64, v65
    v_mfma_f32_16x16x32_bf16 v[120:123], a[36:39], v[88:91], v[120:123]
    v_exp_f32 v73, v73
    v_mfma_f32_16x16x32_bf16 v[124:127], a[36:39], v[92:95], v[124:127]
    ds_read_b128 a[20:23], v9 offset:57344
    v_cvt_pk_bf16_f32 v97, v66, v67
    v_mfma_f32_16x16x32_bf16 v[128:131], a[40:43], v[88:91], v[128:131]
    v_exp_f32 v74, v74
    v_mfma_f32_16x16x32_bf16 v[132:135], a[40:43], v[92:95], v[132:135]
    ds_read_b128 a[24:27], v10 offset:57344
    v_cvt_pk_bf16_f32 v98, v68, v69
    v_mfma_f32_16x16x32_bf16 v[136:139], a[44:47], v[88:91], v[136:139]
    v_exp_f32 v75, v75
    v_mfma_f32_16x16x32_bf16 v[140:143], a[44:47], v[92:95], v[140:143]
    ds_read_b128 a[28:31], v11 offset:57344
    v_cvt_pk_bf16_f32 v99, v70, v71
    s_waitcnt lgkmcnt(4)
    v_mfma_f32_16x16x32_bf16 v[144:147], a[0:3], v[88:91], v[144:147]
    v_exp_f32 v76, v76
    v_mfma_f32_16x16x32_bf16 v[148:151], a[0:3], v[92:95], v[148:151]
    ds_read_b128 a[32:35], v8 offset:61440
    v_cvt_pk_bf16_f32 v100, v72, v73
    v_mfma_f32_16x16x32_bf16 v[152:155], a[4:7], v[88:91], v[152:155]
    v_exp_f32 v77, v77
    v_mfma_f32_16x16x32_bf16 v[156:159], a[4:7], v[92:95], v[156:159]
    ds_read_b128 a[36:39], v9 offset:61440
    v_cvt_pk_bf16_f32 v101, v74, v75
    v_mfma_f32_16x16x32_bf16 v[160:163], a[8:11], v[88:91], v[160:163]
    v_exp_f32 v78, v78
    v_mfma_f32_16x16x32_bf16 v[164:167], a[8:11], v[92:95], v[164:167]
    ds_read_b128 a[40:43], v10 offset:61440
    v_cvt_pk_bf16_f32 v102, v76, v77
    v_mfma_f32_16x16x32_bf16 v[168:171], a[12:15], v[88:91], v[168:171]
    v_exp_f32 v79, v79
    v_mfma_f32_16x16x32_bf16 v[172:175], a[12:15], v[92:95], v[172:175]
    ds_read_b128 a[44:47], v11 offset:61440
    v_cvt_pk_bf16_f32 v103, v78, v79
    s_waitcnt lgkmcnt(4)
    v_mfma_f32_16x16x32_bf16 v[64:67], a[16:19], v[176:179], v[80:83]
    v_exp_f32 v48, v48
    v_mfma_f32_16x16x32_bf16 v[72:75], a[16:19], v[192:195], v[84:87]
    ds_read_b64_tr_b16 a[0:1], v16 offset:57344
    ds_read_b64_tr_b16 a[2:3], v16 offset:61440
    v_mfma_f32_16x16x32_bf16 v[64:67], a[20:23], v[180:183], v[64:67]
    v_exp_f32 v49, v49
    v_mfma_f32_16x16x32_bf16 v[72:75], a[20:23], v[196:199], v[72:75]
    ds_read_b64_tr_b16 a[4:5], v17 offset:57344
    ds_read_b64_tr_b16 a[6:7], v17 offset:61440
    v_mfma_f32_16x16x32_bf16 v[64:67], a[24:27], v[184:187], v[64:67]
    v_exp_f32 v50, v50
    v_mfma_f32_16x16x32_bf16 v[72:75], a[24:27], v[200:203], v[72:75]
    ds_read_b64_tr_b16 a[8:9], v18 offset:57344
    ds_read_b64_tr_b16 a[10:11], v18 offset:61440
    v_mfma_f32_16x16x32_bf16 v[64:67], a[28:31], v[188:191], v[64:67]
    v_exp_f32 v51, v51
    v_mfma_f32_16x16x32_bf16 v[72:75], a[28:31], v[204:207], v[72:75]
    ds_read_b64_tr_b16 a[12:13], v19 offset:57344
    ds_read_b64_tr_b16 a[14:15], v19 offset:61440
    v_mfma_f32_16x16x32_bf16 v[104:107], v[44:47], v[96:99], v[104:107]
    s_waitcnt lgkmcnt(8)
    v_mfma_f32_16x16x32_bf16 v[68:71], a[32:35], v[176:179], v[80:83]
    v_exp_f32 v52, v52
    v_mfma_f32_16x16x32_bf16 v[76:79], a[32:35], v[192:195], v[84:87]
    ds_read_b64_tr_b16 a[16:17], v20 offset:57344
    ds_read_b64_tr_b16 a[18:19], v20 offset:61440
    v_mfma_f32_16x16x32_bf16 v[68:71], a[36:39], v[180:183], v[68:71]
    v_exp_f32 v53, v53
    v_mfma_f32_16x16x32_bf16 v[76:79], a[36:39], v[196:199], v[76:79]
    ds_read_b64_tr_b16 a[20:21], v21 offset:57344
    ds_read_b64_tr_b16 a[22:23], v21 offset:61440
    v_mfma_f32_16x16x32_bf16 v[68:71], a[40:43], v[184:187], v[68:71]
    v_exp_f32 v54, v54
    v_mfma_f32_16x16x32_bf16 v[76:79], a[40:43], v[200:203], v[76:79]
    ds_read_b64_tr_b16 a[24:25], v22 offset:57344
    ds_read_b64_tr_b16 a[26:27], v22 offset:61440
    v_mfma_f32_16x16x32_bf16 v[68:71], a[44:47], v[188:191], v[68:71]
    v_exp_f32 v55, v55
    v_mfma_f32_16x16x32_bf16 v[76:79], a[44:47], v[204:207], v[76:79]
    ds_read_b64_tr_b16 a[28:29], v23 offset:57344
    ds_read_b64_tr_b16 a[30:31], v23 offset:61440
    v_mfma_f32_16x16x32_bf16 v[108:111], v[44:47], v[100:103], v[108:111]
    s_waitcnt lgkmcnt(8)
    v_mfma_f32_16x16x32_bf16 v[112:115], a[0:3], v[96:99], v[112:115]
    v_exp_f32 v56, v56
    v_mfma_f32_16x16x32_bf16 v[116:119], a[0:3], v[100:103], v[116:119]
    v_cvt_pk_bf16_f32 v88, v48, v49
    v_mfma_f32_16x16x32_bf16 v[120:123], a[4:7], v[96:99], v[120:123]
    v_exp_f32 v57, v57
    v_mfma_f32_16x16x32_bf16 v[124:127], a[4:7], v[100:103], v[124:127]
    v_cvt_pk_bf16_f32 v89, v50, v51
    v_mfma_f32_16x16x32_bf16 v[128:131], a[8:11], v[96:99], v[128:131]
    v_exp_f32 v58, v58
    v_cvt_pk_bf16_f32 v90, v52, v53
    s_waitcnt lgkmcnt(0)
    v_mfma_f32_16x16x32_bf16 v[132:135], a[8:11], v[100:103], v[132:135]
    s_barrier
    v_mfma_f32_16x16x32_bf16 v[136:139], a[12:15], v[96:99], v[136:139]
    ds_read_b128 a[32:35], v8 offset:0
    v_exp_f32 v59, v59
    v_mfma_f32_16x16x32_bf16 v[140:143], a[12:15], v[100:103], v[140:143]
    ds_read_b128 a[36:39], v9 offset:0
    ds_read_b128 a[40:43], v10 offset:0
    v_cvt_pk_bf16_f32 v91, v54, v55
    v_mfma_f32_16x16x32_bf16 v[144:147], a[16:19], v[96:99], v[144:147]
    v_exp_f32 v60, v60
    v_mfma_f32_16x16x32_bf16 v[148:151], a[16:19], v[100:103], v[148:151]
    ds_read_b128 a[44:47], v11 offset:0
    ds_read_b128 a[0:3], v8 offset:4096
    v_cvt_pk_bf16_f32 v92, v56, v57
    v_mfma_f32_16x16x32_bf16 v[152:155], a[20:23], v[96:99], v[152:155]
    v_exp_f32 v61, v61
    v_mfma_f32_16x16x32_bf16 v[156:159], a[20:23], v[100:103], v[156:159]
    ds_read_b128 a[4:7], v9 offset:4096
    v_cvt_pk_bf16_f32 v93, v58, v59
    v_mfma_f32_16x16x32_bf16 v[160:163], a[24:27], v[96:99], v[160:163]
    v_exp_f32 v62, v62
    v_mfma_f32_16x16x32_bf16 v[164:167], a[24:27], v[100:103], v[164:167]
    ds_read_b128 a[8:11], v10 offset:4096
    v_cvt_pk_bf16_f32 v94, v60, v61
    v_mfma_f32_16x16x32_bf16 v[168:171], a[28:31], v[96:99], v[168:171]
    v_exp_f32 v63, v63
    v_mfma_f32_16x16x32_bf16 v[172:175], a[28:31], v[100:103], v[172:175]
    ds_read_b128 a[12:15], v11 offset:4096
    v_cvt_pk_bf16_f32 v95, v62, v63
    s_waitcnt lgkmcnt(4)
    v_mfma_f32_16x16x32_bf16 v[48:51], a[32:35], v[176:179], v[80:83]
    v_exp_f32 v64, v64
    v_mfma_f32_16x16x32_bf16 v[56:59], a[32:35], v[192:195], v[84:87]
    ds_read_b64_tr_b16 a[16:17], v16 offset:0
    ds_read_b64_tr_b16 a[18:19], v16 offset:4096
    v_mfma_f32_16x16x32_bf16 v[48:51], a[36:39], v[180:183], v[48:51]
    v_exp_f32 v65, v65
    v_mfma_f32_16x16x32_bf16 v[56:59], a[36:39], v[196:199], v[56:59]
    ds_read_b64_tr_b16 a[20:21], v17 offset:0
    ds_read_b64_tr_b16 a[22:23], v17 offset:4096
    v_mfma_f32_16x16x32_bf16 v[48:51], a[40:43], v[184:187], v[48:51]
    v_exp_f32 v66, v66
    v_mfma_f32_16x16x32_bf16 v[56:59], a[40:43], v[200:203], v[56:59]
    ds_read_b64_tr_b16 a[24:25], v18 offset:0
    ds_read_b64_tr_b16 a[26:27], v18 offset:4096
    v_mfma_f32_16x16x32_bf16 v[48:51], a[44:47], v[188:191], v[48:51]
    v_exp_f32 v67, v67
    v_mfma_f32_16x16x32_bf16 v[56:59], a[44:47], v[204:207], v[56:59]
    ds_read_b64_tr_b16 a[28:29], v19 offset:0
    ds_read_b64_tr_b16 a[30:31], v19 offset:4096
    v_mfma_f32_16x16x32_bf16 v[104:107], v[44:47], v[88:91], v[104:107]
    s_waitcnt lgkmcnt(8)
    v_mfma_f32_16x16x32_bf16 v[52:55], a[0:3], v[176:179], v[80:83]
    v_exp_f32 v68, v68
    v_mfma_f32_16x16x32_bf16 v[60:63], a[0:3], v[192:195], v[84:87]
    ds_read_b64_tr_b16 a[32:33], v20 offset:0
    ds_read_b64_tr_b16 a[34:35], v20 offset:4096
    v_mfma_f32_16x16x32_bf16 v[52:55], a[4:7], v[180:183], v[52:55]
    v_exp_f32 v69, v69
    v_mfma_f32_16x16x32_bf16 v[60:63], a[4:7], v[196:199], v[60:63]
    ds_read_b64_tr_b16 a[36:37], v21 offset:0
    ds_read_b64_tr_b16 a[38:39], v21 offset:4096
    v_mfma_f32_16x16x32_bf16 v[52:55], a[8:11], v[184:187], v[52:55]
    v_exp_f32 v70, v70
    v_mfma_f32_16x16x32_bf16 v[60:63], a[8:11], v[200:203], v[60:63]
    ds_read_b64_tr_b16 a[40:41], v22 offset:0
    ds_read_b64_tr_b16 a[42:43], v22 offset:4096
    v_mfma_f32_16x16x32_bf16 v[52:55], a[12:15], v[188:191], v[52:55]
    v_exp_f32 v71, v71
    v_mfma_f32_16x16x32_bf16 v[60:63], a[12:15], v[204:207], v[60:63]
    ds_read_b64_tr_b16 a[44:45], v23 offset:0
    ds_read_b64_tr_b16 a[46:47], v23 offset:4096
    v_mfma_f32_16x16x32_bf16 v[108:111], v[44:47], v[92:95], v[108:111]
    s_waitcnt lgkmcnt(8)
    v_mfma_f32_16x16x32_bf16 v[112:115], a[16:19], v[88:91], v[112:115]
    v_exp_f32 v72, v72
    v_mfma_f32_16x16x32_bf16 v[116:119], a[16:19], v[92:95], v[116:119]
    ds_read_b128 a[0:3], v8 offset:8192
    v_cvt_pk_bf16_f32 v96, v64, v65
    v_mfma_f32_16x16x32_bf16 v[120:123], a[20:23], v[88:91], v[120:123]
    v_exp_f32 v73, v73
    v_mfma_f32_16x16x32_bf16 v[124:127], a[20:23], v[92:95], v[124:127]
    ds_read_b128 a[4:7], v9 offset:8192
    v_cvt_pk_bf16_f32 v97, v66, v67
    v_mfma_f32_16x16x32_bf16 v[128:131], a[24:27], v[88:91], v[128:131]
    v_exp_f32 v74, v74
    v_mfma_f32_16x16x32_bf16 v[132:135], a[24:27], v[92:95], v[132:135]
    ds_read_b128 a[8:11], v10 offset:8192
    v_cvt_pk_bf16_f32 v98, v68, v69
    v_mfma_f32_16x16x32_bf16 v[136:139], a[28:31], v[88:91], v[136:139]
    v_exp_f32 v75, v75
    v_mfma_f32_16x16x32_bf16 v[140:143], a[28:31], v[92:95], v[140:143]
    ds_read_b128 a[12:15], v11 offset:8192
    v_cvt_pk_bf16_f32 v99, v70, v71
    s_waitcnt lgkmcnt(4)
    v_mfma_f32_16x16x32_bf16 v[144:147], a[32:35], v[88:91], v[144:147]
    v_exp_f32 v76, v76
    v_mfma_f32_16x16x32_bf16 v[148:151], a[32:35], v[92:95], v[148:151]
    ds_read_b128 a[16:19], v8 offset:12288
    v_cvt_pk_bf16_f32 v100, v72, v73
    v_mfma_f32_16x16x32_bf16 v[152:155], a[36:39], v[88:91], v[152:155]
    v_exp_f32 v77, v77
    v_mfma_f32_16x16x32_bf16 v[156:159], a[36:39], v[92:95], v[156:159]
    ds_read_b128 a[20:23], v9 offset:12288
    v_cvt_pk_bf16_f32 v101, v74, v75
    v_mfma_f32_16x16x32_bf16 v[160:163], a[40:43], v[88:91], v[160:163]
    v_exp_f32 v78, v78
    v_mfma_f32_16x16x32_bf16 v[164:167], a[40:43], v[92:95], v[164:167]
    ds_read_b128 a[24:27], v10 offset:12288
    v_cvt_pk_bf16_f32 v102, v76, v77
    v_mfma_f32_16x16x32_bf16 v[168:171], a[44:47], v[88:91], v[168:171]
    v_exp_f32 v79, v79
    v_mfma_f32_16x16x32_bf16 v[172:175], a[44:47], v[92:95], v[172:175]
    ds_read_b128 a[28:31], v11 offset:12288
    v_cvt_pk_bf16_f32 v103, v78, v79
    s_waitcnt lgkmcnt(4)
    v_mfma_f32_16x16x32_bf16 v[64:67], a[0:3], v[176:179], v[80:83]
    v_exp_f32 v48, v48
    v_mfma_f32_16x16x32_bf16 v[72:75], a[0:3], v[192:195], v[84:87]
    ds_read_b64_tr_b16 a[32:33], v16 offset:8192
    ds_read_b64_tr_b16 a[34:35], v16 offset:12288
    v_mfma_f32_16x16x32_bf16 v[64:67], a[4:7], v[180:183], v[64:67]
    v_exp_f32 v49, v49
    v_mfma_f32_16x16x32_bf16 v[72:75], a[4:7], v[196:199], v[72:75]
    ds_read_b64_tr_b16 a[36:37], v17 offset:8192
    ds_read_b64_tr_b16 a[38:39], v17 offset:12288
    v_mfma_f32_16x16x32_bf16 v[64:67], a[8:11], v[184:187], v[64:67]
    v_exp_f32 v50, v50
    v_mfma_f32_16x16x32_bf16 v[72:75], a[8:11], v[200:203], v[72:75]
    ds_read_b64_tr_b16 a[40:41], v18 offset:8192
    ds_read_b64_tr_b16 a[42:43], v18 offset:12288
    v_mfma_f32_16x16x32_bf16 v[64:67], a[12:15], v[188:191], v[64:67]
    v_exp_f32 v51, v51
    v_mfma_f32_16x16x32_bf16 v[72:75], a[12:15], v[204:207], v[72:75]
    ds_read_b64_tr_b16 a[44:45], v19 offset:8192
    ds_read_b64_tr_b16 a[46:47], v19 offset:12288
    v_mfma_f32_16x16x32_bf16 v[104:107], v[44:47], v[96:99], v[104:107]
    s_waitcnt lgkmcnt(8)
    v_mfma_f32_16x16x32_bf16 v[68:71], a[16:19], v[176:179], v[80:83]
    v_exp_f32 v52, v52
    v_mfma_f32_16x16x32_bf16 v[76:79], a[16:19], v[192:195], v[84:87]
    ds_read_b64_tr_b16 a[0:1], v20 offset:8192
    ds_read_b64_tr_b16 a[2:3], v20 offset:12288
    v_mfma_f32_16x16x32_bf16 v[68:71], a[20:23], v[180:183], v[68:71]
    v_exp_f32 v53, v53
    v_mfma_f32_16x16x32_bf16 v[76:79], a[20:23], v[196:199], v[76:79]
    ds_read_b64_tr_b16 a[4:5], v21 offset:8192
    ds_read_b64_tr_b16 a[6:7], v21 offset:12288
    v_mfma_f32_16x16x32_bf16 v[68:71], a[24:27], v[184:187], v[68:71]
    v_exp_f32 v54, v54
    v_mfma_f32_16x16x32_bf16 v[76:79], a[24:27], v[200:203], v[76:79]
    ds_read_b64_tr_b16 a[8:9], v22 offset:8192
    ds_read_b64_tr_b16 a[10:11], v22 offset:12288
    v_mfma_f32_16x16x32_bf16 v[68:71], a[28:31], v[188:191], v[68:71]
    v_exp_f32 v55, v55
    v_mfma_f32_16x16x32_bf16 v[76:79], a[28:31], v[204:207], v[76:79]
    ds_read_b64_tr_b16 a[12:13], v23 offset:8192
    ds_read_b64_tr_b16 a[14:15], v23 offset:12288
    v_mfma_f32_16x16x32_bf16 v[108:111], v[44:47], v[100:103], v[108:111]
    s_waitcnt lgkmcnt(8)
    v_mfma_f32_16x16x32_bf16 v[112:115], a[32:35], v[96:99], v[112:115]
    v_exp_f32 v56, v56
    v_mfma_f32_16x16x32_bf16 v[116:119], a[32:35], v[100:103], v[116:119]
    v_cvt_pk_bf16_f32 v88, v48, v49
    v_mfma_f32_16x16x32_bf16 v[120:123], a[36:39], v[96:99], v[120:123]
    v_exp_f32 v57, v57
    v_mfma_f32_16x16x32_bf16 v[124:127], a[36:39], v[100:103], v[124:127]
    v_cvt_pk_bf16_f32 v89, v50, v51
    v_mfma_f32_16x16x32_bf16 v[128:131], a[40:43], v[96:99], v[128:131]
    v_exp_f32 v58, v58
    v_cvt_pk_bf16_f32 v90, v52, v53
    s_waitcnt lgkmcnt(0)
    v_mfma_f32_16x16x32_bf16 v[132:135], a[40:43], v[100:103], v[132:135]
    s_barrier
    v_mfma_f32_16x16x32_bf16 v[136:139], a[44:47], v[96:99], v[136:139]
    ds_read_b128 a[16:19], v8 offset:16384
    v_exp_f32 v59, v59
    v_mfma_f32_16x16x32_bf16 v[140:143], a[44:47], v[100:103], v[140:143]
    ds_read_b128 a[20:23], v9 offset:16384
    ds_read_b128 a[24:27], v10 offset:16384
    v_cvt_pk_bf16_f32 v91, v54, v55
    v_mfma_f32_16x16x32_bf16 v[144:147], a[0:3], v[96:99], v[144:147]
    v_exp_f32 v60, v60
    v_mfma_f32_16x16x32_bf16 v[148:151], a[0:3], v[100:103], v[148:151]
    ds_read_b128 a[28:31], v11 offset:16384
    ds_read_b128 a[32:35], v8 offset:20480
    v_cvt_pk_bf16_f32 v92, v56, v57
    v_mfma_f32_16x16x32_bf16 v[152:155], a[4:7], v[96:99], v[152:155]
    v_exp_f32 v61, v61
    v_mfma_f32_16x16x32_bf16 v[156:159], a[4:7], v[100:103], v[156:159]
    ds_read_b128 a[36:39], v9 offset:20480
    v_cvt_pk_bf16_f32 v93, v58, v59
    v_mfma_f32_16x16x32_bf16 v[160:163], a[8:11], v[96:99], v[160:163]
    v_exp_f32 v62, v62
    v_mfma_f32_16x16x32_bf16 v[164:167], a[8:11], v[100:103], v[164:167]
    ds_read_b128 a[40:43], v10 offset:20480
    v_cvt_pk_bf16_f32 v94, v60, v61
    v_mfma_f32_16x16x32_bf16 v[168:171], a[12:15], v[96:99], v[168:171]
    v_exp_f32 v63, v63
    v_mfma_f32_16x16x32_bf16 v[172:175], a[12:15], v[100:103], v[172:175]
    ds_read_b128 a[44:47], v11 offset:20480
    v_cvt_pk_bf16_f32 v95, v62, v63
    s_waitcnt lgkmcnt(4)
    v_mfma_f32_16x16x32_bf16 v[48:51], a[16:19], v[176:179], v[80:83]
    v_exp_f32 v64, v64
    v_mfma_f32_16x16x32_bf16 v[56:59], a[16:19], v[192:195], v[84:87]
    ds_read_b64_tr_b16 a[0:1], v16 offset:16384
    ds_read_b64_tr_b16 a[2:3], v16 offset:20480
    v_mfma_f32_16x16x32_bf16 v[48:51], a[20:23], v[180:183], v[48:51]
    v_exp_f32 v65, v65
    v_mfma_f32_16x16x32_bf16 v[56:59], a[20:23], v[196:199], v[56:59]
    ds_read_b64_tr_b16 a[4:5], v17 offset:16384
    ds_read_b64_tr_b16 a[6:7], v17 offset:20480
    v_mfma_f32_16x16x32_bf16 v[48:51], a[24:27], v[184:187], v[48:51]
    v_exp_f32 v66, v66
    v_mfma_f32_16x16x32_bf16 v[56:59], a[24:27], v[200:203], v[56:59]
    ds_read_b64_tr_b16 a[8:9], v18 offset:16384
    ds_read_b64_tr_b16 a[10:11], v18 offset:20480
    v_mfma_f32_16x16x32_bf16 v[48:51], a[28:31], v[188:191], v[48:51]
    v_exp_f32 v67, v67
    v_mfma_f32_16x16x32_bf16 v[56:59], a[28:31], v[204:207], v[56:59]
    ds_read_b64_tr_b16 a[12:13], v19 offset:16384
    ds_read_b64_tr_b16 a[14:15], v19 offset:20480
    v_mfma_f32_16x16x32_bf16 v[104:107], v[44:47], v[88:91], v[104:107]
    s_waitcnt lgkmcnt(8)
    v_mfma_f32_16x16x32_bf16 v[52:55], a[32:35], v[176:179], v[80:83]
    v_exp_f32 v68, v68
    v_mfma_f32_16x16x32_bf16 v[60:63], a[32:35], v[192:195], v[84:87]
    ds_read_b64_tr_b16 a[16:17], v20 offset:16384
    ds_read_b64_tr_b16 a[18:19], v20 offset:20480
    v_mfma_f32_16x16x32_bf16 v[52:55], a[36:39], v[180:183], v[52:55]
    v_exp_f32 v69, v69
    v_mfma_f32_16x16x32_bf16 v[60:63], a[36:39], v[196:199], v[60:63]
    ds_read_b64_tr_b16 a[20:21], v21 offset:16384
    ds_read_b64_tr_b16 a[22:23], v21 offset:20480
    v_mfma_f32_16x16x32_bf16 v[52:55], a[40:43], v[184:187], v[52:55]
    v_exp_f32 v70, v70
    v_mfma_f32_16x16x32_bf16 v[60:63], a[40:43], v[200:203], v[60:63]
    ds_read_b64_tr_b16 a[24:25], v22 offset:16384
    ds_read_b64_tr_b16 a[26:27], v22 offset:20480
    v_mfma_f32_16x16x32_bf16 v[52:55], a[44:47], v[188:191], v[52:55]
    v_exp_f32 v71, v71
    v_mfma_f32_16x16x32_bf16 v[60:63], a[44:47], v[204:207], v[60:63]
    ds_read_b64_tr_b16 a[28:29], v23 offset:16384
    ds_read_b64_tr_b16 a[30:31], v23 offset:20480
    v_mfma_f32_16x16x32_bf16 v[108:111], v[44:47], v[92:95], v[108:111]
    s_waitcnt lgkmcnt(8)
    v_mfma_f32_16x16x32_bf16 v[112:115], a[0:3], v[88:91], v[112:115]
    v_exp_f32 v72, v72
    v_mfma_f32_16x16x32_bf16 v[116:119], a[0:3], v[92:95], v[116:119]
    ds_read_b128 a[32:35], v8 offset:24576
    v_cvt_pk_bf16_f32 v96, v64, v65
    v_mfma_f32_16x16x32_bf16 v[120:123], a[4:7], v[88:91], v[120:123]
    v_exp_f32 v73, v73
    v_mfma_f32_16x16x32_bf16 v[124:127], a[4:7], v[92:95], v[124:127]
    ds_read_b128 a[36:39], v9 offset:24576
    v_cvt_pk_bf16_f32 v97, v66, v67
    v_mfma_f32_16x16x32_bf16 v[128:131], a[8:11], v[88:91], v[128:131]
    v_exp_f32 v74, v74
    v_mfma_f32_16x16x32_bf16 v[132:135], a[8:11], v[92:95], v[132:135]
    ds_read_b128 a[40:43], v10 offset:24576
    v_cvt_pk_bf16_f32 v98, v68, v69
    v_mfma_f32_16x16x32_bf16 v[136:139], a[12:15], v[88:91], v[136:139]
    v_exp_f32 v75, v75
    v_mfma_f32_16x16x32_bf16 v[140:143], a[12:15], v[92:95], v[140:143]
    ds_read_b128 a[44:47], v11 offset:24576
    v_cvt_pk_bf16_f32 v99, v70, v71
    s_waitcnt lgkmcnt(4)
    v_mfma_f32_16x16x32_bf16 v[144:147], a[16:19], v[88:91], v[144:147]
    v_exp_f32 v76, v76
    v_mfma_f32_16x16x32_bf16 v[148:151], a[16:19], v[92:95], v[148:151]
    ds_read_b128 a[0:3], v8 offset:28672
    v_cvt_pk_bf16_f32 v100, v72, v73
    v_mfma_f32_16x16x32_bf16 v[152:155], a[20:23], v[88:91], v[152:155]
    v_exp_f32 v77, v77
    v_mfma_f32_16x16x32_bf16 v[156:159], a[20:23], v[92:95], v[156:159]
    ds_read_b128 a[4:7], v9 offset:28672
    v_cvt_pk_bf16_f32 v101, v74, v75
    v_mfma_f32_16x16x32_bf16 v[160:163], a[24:27], v[88:91], v[160:163]
    v_exp_f32 v78, v78
    v_mfma_f32_16x16x32_bf16 v[164:167], a[24:27], v[92:95], v[164:167]
    ds_read_b128 a[8:11], v10 offset:28672
    v_cvt_pk_bf16_f32 v102, v76, v77
    v_mfma_f32_16x16x32_bf16 v[168:171], a[28:31], v[88:91], v[168:171]
    v_exp_f32 v79, v79
    v_mfma_f32_16x16x32_bf16 v[172:175], a[28:31], v[92:95], v[172:175]
    ds_read_b128 a[12:15], v11 offset:28672
    v_cvt_pk_bf16_f32 v103, v78, v79
    s_waitcnt lgkmcnt(4)
    v_mfma_f32_16x16x32_bf16 v[64:67], a[32:35], v[176:179], v[80:83]
    v_exp_f32 v48, v48
    v_mfma_f32_16x16x32_bf16 v[72:75], a[32:35], v[192:195], v[84:87]
    ds_read_b64_tr_b16 a[16:17], v16 offset:24576
    ds_read_b64_tr_b16 a[18:19], v16 offset:28672
    v_mfma_f32_16x16x32_bf16 v[64:67], a[36:39], v[180:183], v[64:67]
    v_exp_f32 v49, v49
    v_mfma_f32_16x16x32_bf16 v[72:75], a[36:39], v[196:199], v[72:75]
    ds_read_b64_tr_b16 a[20:21], v17 offset:24576
    ds_read_b64_tr_b16 a[22:23], v17 offset:28672
    v_mfma_f32_16x16x32_bf16 v[64:67], a[40:43], v[184:187], v[64:67]
    v_exp_f32 v50, v50
    v_mfma_f32_16x16x32_bf16 v[72:75], a[40:43], v[200:203], v[72:75]
    ds_read_b64_tr_b16 a[24:25], v18 offset:24576
    ds_read_b64_tr_b16 a[26:27], v18 offset:28672
    v_mfma_f32_16x16x32_bf16 v[64:67], a[44:47], v[188:191], v[64:67]
    v_exp_f32 v51, v51
    v_mfma_f32_16x16x32_bf16 v[72:75], a[44:47], v[204:207], v[72:75]
    ds_read_b64_tr_b16 a[28:29], v19 offset:24576
    ds_read_b64_tr_b16 a[30:31], v19 offset:28672
    v_mfma_f32_16x16x32_bf16 v[104:107], v[44:47], v[96:99], v[104:107]
    s_waitcnt lgkmcnt(8)
    v_mfma_f32_16x16x32_bf16 v[68:71], a[0:3], v[176:179], v[80:83]
    v_exp_f32 v52, v52
    v_mfma_f32_16x16x32_bf16 v[76:79], a[0:3], v[192:195], v[84:87]
    ds_read_b64_tr_b16 a[32:33], v20 offset:24576
    ds_read_b64_tr_b16 a[34:35], v20 offset:28672
    v_mfma_f32_16x16x32_bf16 v[68:71], a[4:7], v[180:183], v[68:71]
    v_exp_f32 v53, v53
    v_mfma_f32_16x16x32_bf16 v[76:79], a[4:7], v[196:199], v[76:79]
    ds_read_b64_tr_b16 a[36:37], v21 offset:24576
    ds_read_b64_tr_b16 a[38:39], v21 offset:28672
    v_mfma_f32_16x16x32_bf16 v[68:71], a[8:11], v[184:187], v[68:71]
    v_exp_f32 v54, v54
    v_mfma_f32_16x16x32_bf16 v[76:79], a[8:11], v[200:203], v[76:79]
    ds_read_b64_tr_b16 a[40:41], v22 offset:24576
    ds_read_b64_tr_b16 a[42:43], v22 offset:28672
    v_mfma_f32_16x16x32_bf16 v[68:71], a[12:15], v[188:191], v[68:71]
    v_exp_f32 v55, v55
    v_mfma_f32_16x16x32_bf16 v[76:79], a[12:15], v[204:207], v[76:79]
    ds_read_b64_tr_b16 a[44:45], v23 offset:24576
    ds_read_b64_tr_b16 a[46:47], v23 offset:28672
    v_mfma_f32_16x16x32_bf16 v[108:111], v[44:47], v[100:103], v[108:111]
    s_waitcnt lgkmcnt(8)
    v_mfma_f32_16x16x32_bf16 v[112:115], a[16:19], v[96:99], v[112:115]
    v_exp_f32 v56, v56
    v_mfma_f32_16x16x32_bf16 v[116:119], a[16:19], v[100:103], v[116:119]
    v_cvt_pk_bf16_f32 v88, v48, v49
    v_mfma_f32_16x16x32_bf16 v[120:123], a[20:23], v[96:99], v[120:123]
    v_exp_f32 v57, v57
    v_mfma_f32_16x16x32_bf16 v[124:127], a[20:23], v[100:103], v[124:127]
    v_cvt_pk_bf16_f32 v89, v50, v51
    v_mfma_f32_16x16x32_bf16 v[128:131], a[24:27], v[96:99], v[128:131]
    v_exp_f32 v58, v58
    v_cvt_pk_bf16_f32 v90, v52, v53
    s_waitcnt lgkmcnt(0)
    v_mfma_f32_16x16x32_bf16 v[132:135], a[24:27], v[100:103], v[132:135]
    s_barrier
    v_mfma_f32_16x16x32_bf16 v[136:139], a[28:31], v[96:99], v[136:139]
    ds_read_b64_tr_b16 a[0:1], v16 offset:32768
    ds_read_b64_tr_b16 a[2:3], v16 offset:36864
    v_exp_f32 v59, v59
    v_mfma_f32_16x16x32_bf16 v[140:143], a[28:31], v[100:103], v[140:143]
    ds_read_b64_tr_b16 a[4:5], v17 offset:32768
    ds_read_b64_tr_b16 a[6:7], v17 offset:36864
    ds_read_b64_tr_b16 a[8:9], v18 offset:32768
    ds_read_b64_tr_b16 a[10:11], v18 offset:36864
    v_cvt_pk_bf16_f32 v91, v54, v55
    v_mfma_f32_16x16x32_bf16 v[144:147], a[32:35], v[96:99], v[144:147]
    v_exp_f32 v60, v60
    v_mfma_f32_16x16x32_bf16 v[148:151], a[32:35], v[100:103], v[148:151]
    ds_read_b64_tr_b16 a[12:13], v19 offset:32768
    ds_read_b64_tr_b16 a[14:15], v19 offset:36864
    ds_read_b64_tr_b16 a[16:17], v20 offset:32768
    ds_read_b64_tr_b16 a[18:19], v20 offset:36864
    v_cvt_pk_bf16_f32 v92, v56, v57
    v_mfma_f32_16x16x32_bf16 v[152:155], a[36:39], v[96:99], v[152:155]
    v_exp_f32 v61, v61
    v_mfma_f32_16x16x32_bf16 v[156:159], a[36:39], v[100:103], v[156:159]
    ds_read_b64_tr_b16 a[20:21], v21 offset:32768
    ds_read_b64_tr_b16 a[22:23], v21 offset:36864
    v_cvt_pk_bf16_f32 v93, v58, v59
    v_mfma_f32_16x16x32_bf16 v[160:163], a[40:43], v[96:99], v[160:163]
    v_exp_f32 v62, v62
    v_mfma_f32_16x16x32_bf16 v[164:167], a[40:43], v[100:103], v[164:167]
    ds_read_b64_tr_b16 a[24:25], v22 offset:32768
    ds_read_b64_tr_b16 a[26:27], v22 offset:36864
    v_cvt_pk_bf16_f32 v94, v60, v61
    v_mfma_f32_16x16x32_bf16 v[168:171], a[44:47], v[96:99], v[168:171]
    v_exp_f32 v63, v63
    v_mfma_f32_16x16x32_bf16 v[172:175], a[44:47], v[100:103], v[172:175]
    ds_read_b64_tr_b16 a[28:29], v23 offset:32768
    ds_read_b64_tr_b16 a[30:31], v23 offset:36864
    v_cvt_pk_bf16_f32 v95, v62, v63
    s_waitcnt lgkmcnt(8)
    v_mfma_f32_16x16x32_bf16 v[112:115], a[0:3], v[88:91], v[112:115]
    v_exp_f32 v64, v64
    v_mfma_f32_16x16x32_bf16 v[116:119], a[0:3], v[92:95], v[116:119]
    ds_read_b64_tr_b16 a[32:33], v16 offset:40960
    ds_read_b64_tr_b16 a[34:35], v16 offset:45056
    v_exp_f32 v65, v65
    v_exp_f32 v66, v66
    v_mfma_f32_16x16x32_bf16 v[104:107], v[44:47], v[88:91], v[104:107]
    v_mfma_f32_16x16x32_bf16 v[120:123], a[4:7], v[88:91], v[120:123]
    v_cvt_pk_bf16_f32 v96, v64, v65
    v_exp_f32 v67, v67
    v_mfma_f32_16x16x32_bf16 v[124:127], a[4:7], v[92:95], v[124:127]
    ds_read_b64_tr_b16 a[36:37], v17 offset:40960
    ds_read_b64_tr_b16 a[38:39], v17 offset:45056
    v_exp_f32 v68, v68
    v_mfma_f32_16x16x32_bf16 v[108:111], v[44:47], v[92:95], v[108:111]
    v_mfma_f32_16x16x32_bf16 v[128:131], a[8:11], v[88:91], v[128:131]
    v_cvt_pk_bf16_f32 v97, v66, v67
    v_exp_f32 v69, v69
    v_mfma_f32_16x16x32_bf16 v[132:135], a[8:11], v[92:95], v[132:135]
    ds_read_b64_tr_b16 a[40:41], v18 offset:40960
    ds_read_b64_tr_b16 a[42:43], v18 offset:45056
    v_exp_f32 v70, v70
    v_cvt_pk_bf16_f32 v98, v68, v69
    v_mfma_f32_16x16x32_bf16 v[136:139], a[12:15], v[88:91], v[136:139]
    v_exp_f32 v71, v71
    v_exp_f32 v72, v72
    v_mfma_f32_16x16x32_bf16 v[140:143], a[12:15], v[92:95], v[140:143]
    ds_read_b64_tr_b16 a[44:45], v19 offset:40960
    ds_read_b64_tr_b16 a[46:47], v19 offset:45056
    v_cvt_pk_bf16_f32 v99, v70, v71
    s_waitcnt lgkmcnt(8)
    v_mfma_f32_16x16x32_bf16 v[144:147], a[16:19], v[88:91], v[144:147]
    v_exp_f32 v73, v73
    v_exp_f32 v74, v74
    v_mfma_f32_16x16x32_bf16 v[148:151], a[16:19], v[92:95], v[148:151]
    ds_read_b64_tr_b16 a[0:1], v20 offset:40960
    ds_read_b64_tr_b16 a[2:3], v20 offset:45056
    v_cvt_pk_bf16_f32 v100, v72, v73
    v_exp_f32 v75, v75
    v_mfma_f32_16x16x32_bf16 v[152:155], a[20:23], v[88:91], v[152:155]
    v_exp_f32 v76, v76
    v_mfma_f32_16x16x32_bf16 v[156:159], a[20:23], v[92:95], v[156:159]
    ds_read_b64_tr_b16 a[4:5], v21 offset:40960
    ds_read_b64_tr_b16 a[6:7], v21 offset:45056
    v_cvt_pk_bf16_f32 v101, v74, v75
    v_exp_f32 v77, v77
    v_mfma_f32_16x16x32_bf16 v[160:163], a[24:27], v[88:91], v[160:163]
    v_exp_f32 v78, v78
    v_cvt_pk_bf16_f32 v102, v76, v77
    v_mfma_f32_16x16x32_bf16 v[164:167], a[24:27], v[92:95], v[164:167]
    ds_read_b64_tr_b16 a[8:9], v22 offset:40960
    ds_read_b64_tr_b16 a[10:11], v22 offset:45056
    v_exp_f32 v79, v79
    s_nop 0
    v_cvt_pk_bf16_f32 v103, v78, v79
    v_mfma_f32_16x16x32_bf16 v[168:171], a[28:31], v[88:91], v[168:171]
    v_mfma_f32_16x16x32_bf16 v[172:175], a[28:31], v[92:95], v[172:175]
    ds_read_b64_tr_b16 a[12:13], v23 offset:40960
    ds_read_b64_tr_b16 a[14:15], v23 offset:45056
    v_mfma_f32_16x16x32_bf16 v[104:107], v[44:47], v[96:99], v[104:107]
    v_mfma_f32_16x16x32_bf16 v[108:111], v[44:47], v[100:103], v[108:111]
    s_waitcnt lgkmcnt(8)
    v_mfma_f32_16x16x32_bf16 v[112:115], a[32:35], v[96:99], v[112:115]
    v_mfma_f32_16x16x32_bf16 v[116:119], a[32:35], v[100:103], v[116:119]
    v_mfma_f32_16x16x32_bf16 v[120:123], a[36:39], v[96:99], v[120:123]
    s_nop 2
    v_rcp_f32 v2, v104
    v_mfma_f32_16x16x32_bf16 v[124:127], a[36:39], v[100:103], v[124:127]
    v_rcp_f32 v4, v108
    v_add_f32 v1, v104, v108
    v_mfma_f32_16x16x32_bf16 v[128:131], a[40:43], v[96:99], v[128:131]
    v_mov_b32 v3, v2
    v_mfma_f32_16x16x32_bf16 v[132:135], a[40:43], v[100:103], v[132:135]
    v_mov_b32 v5, v4
    v_cmp_nlt_f32 s[98:99], v1, s79
    v_mfma_f32_16x16x32_bf16 v[136:139], a[44:47], v[96:99], v[136:139]
    s_cmp_lg_u64 s[98:99], 0
    s_cselect_b32 s52, s78, 0
    v_mov_b32 v1, s52
    ds_write_b32 v35, v1
    s_waitcnt lgkmcnt(0)
    v_mfma_f32_16x16x32_bf16 v[140:143], a[44:47], v[100:103], v[140:143]
    s_barrier
    v_and_b32 v1, 4294966272, v33
    ds_read_b128 v[76:79], v1 offset:7168
    v_mfma_f32_16x16x32_bf16 v[144:147], a[0:3], v[96:99], v[144:147]
    ds_read_b64_tr_b16 a[16:17], v12 offset:49152
    ds_read_b64_tr_b16 a[18:19], v12 offset:51200
    v_pk_mul_f32 v[112:113], v[112:113], v[2:3]
    v_pk_mul_f32 v[114:115], v[114:115], v[2:3]
    v_cvt_pk_bf16_f32 v48, v112, v113
    v_cvt_pk_bf16_f32 v49, v114, v115
    v_pk_mul_f32 v[120:121], v[120:121], v[2:3]
    v_pk_mul_f32 v[122:123], v[122:123], v[2:3]
    v_mfma_f32_16x16x32_bf16 v[148:151], a[0:3], v[100:103], v[148:151]
    ds_read_b64_tr_b16 a[20:21], v13 offset:49152
    ds_read_b64_tr_b16 a[22:23], v13 offset:51200
    ds_read_b64_tr_b16 a[24:25], v12 offset:53248
    ds_read_b64_tr_b16 a[26:27], v12 offset:55296
    v_cvt_pk_bf16_f32 v50, v120, v121
    v_cvt_pk_bf16_f32 v51, v122, v123
    v_min_u32 v48, -2, v48
    v_mfma_f32_16x16x32_bf16 v[152:155], a[4:7], v[96:99], v[152:155]
    ds_write_b128 v33, v[48:51] offset:0
    v_pk_mul_f32 v[116:117], v[116:117], v[4:5]
    v_pk_mul_f32 v[118:119], v[118:119], v[4:5]
    v_cvt_pk_bf16_f32 v52, v116, v117
    v_cvt_pk_bf16_f32 v53, v118, v119
    v_pk_mul_f32 v[124:125], v[124:125], v[4:5]
    v_mfma_f32_16x16x32_bf16 v[156:159], a[4:7], v[100:103], v[156:159]
    ds_read_b64_tr_b16 a[28:29], v13 offset:53248
    ds_read_b64_tr_b16 a[30:31], v13 offset:55296
    ds_read_b64_tr_b16 a[32:33], v12 offset:57344
    ds_read_b64_tr_b16 a[34:35], v12 offset:59392
    v_pk_mul_f32 v[126:127], v[126:127], v[4:5]
    v_cvt_pk_bf16_f32 v54, v124, v125
    v_cvt_pk_bf16_f32 v55, v126, v127
    ds_write_b128 v33, v[52:55] offset:1024
    v_mfma_f32_16x16x32_bf16 v[160:163], a[8:11], v[96:99], v[160:163]
    v_pk_mul_f32 v[128:129], v[128:129], v[2:3]
    v_pk_mul_f32 v[130:131], v[130:131], v[2:3]
    v_cvt_pk_bf16_f32 v56, v128, v129
    v_cvt_pk_bf16_f32 v57, v130, v131
    v_pk_mul_f32 v[136:137], v[136:137], v[2:3]
    v_pk_mul_f32 v[138:139], v[138:139], v[2:3]
    v_mfma_f32_16x16x32_bf16 v[164:167], a[8:11], v[100:103], v[164:167]
    ds_read_b64_tr_b16 a[36:37], v13 offset:57344
    ds_read_b64_tr_b16 a[38:39], v13 offset:59392
    ds_read_b64_tr_b16 a[40:41], v12 offset:61440
    ds_read_b64_tr_b16 a[42:43], v12 offset:63488
    v_cvt_pk_bf16_f32 v58, v136, v137
    v_cvt_pk_bf16_f32 v59, v138, v139
    ds_write_b128 v33, v[56:59] offset:2048
    v_mfma_f32_16x16x32_bf16 v[168:171], a[12:15], v[96:99], v[168:171]
    v_pk_mul_f32 v[132:133], v[132:133], v[4:5]
    v_pk_mul_f32 v[134:135], v[134:135], v[4:5]
    v_cvt_pk_bf16_f32 v60, v132, v133
    v_cvt_pk_bf16_f32 v61, v134, v135
    v_pk_mul_f32 v[140:141], v[140:141], v[4:5]
    v_pk_mul_f32 v[142:143], v[142:143], v[4:5]
    v_mfma_f32_16x16x32_bf16 v[172:175], a[12:15], v[100:103], v[172:175]
    ds_read_b64_tr_b16 a[44:45], v13 offset:61440
    ds_read_b64_tr_b16 a[46:47], v13 offset:63488
    v_cvt_pk_bf16_f32 v62, v140, v141
    v_cvt_pk_bf16_f32 v63, v142, v143
    ds_write_b128 v33, v[60:63] offset:3072
    s_waitcnt lgkmcnt(11)
    v_mfma_f32_16x16x32_bf16 v[80:83], a[16:19], v[48:51], 0
    v_pk_mul_f32 v[144:145], v[144:145], v[2:3]
    v_pk_mul_f32 v[146:147], v[146:147], v[2:3]
    v_cvt_pk_bf16_f32 v64, v144, v145
    v_cvt_pk_bf16_f32 v65, v146, v147
    v_mfma_f32_16x16x32_bf16 v[88:91], a[16:19], v[52:55], 0
    v_pk_mul_f32 v[152:153], v[152:153], v[2:3]
    v_pk_mul_f32 v[154:155], v[154:155], v[2:3]
    v_or3_b32 v1, v76, v77, v78
    v_or_b32 v1, v1, v79
    s_nop 0
    v_readfirstlane_b32 s52, v1
    s_nop 0
    s_cmp_lg_u32 s52, 0
    s_cbranch_scc1 L_safe_compute
    v_mfma_f32_16x16x32_bf16 v[84:87], a[20:23], v[48:51], 0
    v_cvt_pk_bf16_f32 v66, v152, v153
    v_cvt_pk_bf16_f32 v67, v154, v155
    ds_write_b128 v33, v[64:67] offset:4096
    v_pk_mul_f32 v[148:149], v[148:149], v[4:5]
    v_mfma_f32_16x16x32_bf16 v[92:95], a[20:23], v[52:55], 0
    v_pk_mul_f32 v[150:151], v[150:151], v[4:5]
    v_cvt_pk_bf16_f32 v68, v148, v149
    v_mfma_f32_16x16x32_bf16 v[80:83], a[24:27], v[56:59], v[80:83]
    v_cvt_pk_bf16_f32 v69, v150, v151
    v_pk_mul_f32 v[156:157], v[156:157], v[4:5]
    v_pk_mul_f32 v[158:159], v[158:159], v[4:5]
    v_cvt_pk_bf16_f32 v70, v156, v157
    v_mfma_f32_16x16x32_bf16 v[88:91], a[24:27], v[60:63], v[88:91]
    v_cvt_pk_bf16_f32 v71, v158, v159
    ds_write_b128 v33, v[68:71] offset:5120
    v_mfma_f32_16x16x32_bf16 v[84:87], a[28:31], v[56:59], v[84:87]
    v_pk_mul_f32 v[160:161], v[160:161], v[2:3]
    v_pk_mul_f32 v[162:163], v[162:163], v[2:3]
    v_cvt_pk_bf16_f32 v72, v160, v161
    v_cvt_pk_bf16_f32 v73, v162, v163
    v_pk_mul_f32 v[168:169], v[168:169], v[2:3]
    v_pk_mul_f32 v[170:171], v[170:171], v[2:3]
    v_mfma_f32_16x16x32_bf16 v[92:95], a[28:31], v[60:63], v[92:95]
    v_cvt_pk_bf16_f32 v74, v168, v169
    v_cvt_pk_bf16_f32 v75, v170, v171
    ds_write_b128 v33, v[72:75] offset:6144
    s_waitcnt lgkmcnt(4)
    v_mfma_f32_16x16x32_bf16 v[80:83], a[32:35], v[64:67], v[80:83]
    v_pk_mul_f32 v[164:165], v[164:165], v[4:5]
    v_pk_mul_f32 v[166:167], v[166:167], v[4:5]
    v_cvt_pk_bf16_f32 v76, v164, v165
    v_cvt_pk_bf16_f32 v77, v166, v167
    v_pk_mul_f32 v[172:173], v[172:173], v[4:5]
    v_pk_mul_f32 v[174:175], v[174:175], v[4:5]
    v_cvt_pk_bf16_f32 v78, v172, v173
    v_cvt_pk_bf16_f32 v79, v174, v175
    ds_write_b128 v33, v[76:79] offset:7168
    s_waitcnt lgkmcnt(0)
    v_mfma_f32_16x16x32_bf16 v[88:91], a[32:35], v[68:71], v[88:91]
    s_barrier
    v_mfma_f32_16x16x32_bf16 v[84:87], a[36:39], v[64:67], v[84:87]
    ds_read_b128 v[180:183], v34 offset:1024
    ds_read_b128 v[176:179], v34 offset:0
    ds_read_b64_tr_b16 a[0:1], v14 offset:49152
    ds_read_b64_tr_b16 a[2:3], v14 offset:51200
    v_mfma_f32_16x16x32_bf16 v[92:95], a[36:39], v[68:71], v[92:95]
    ds_read_b64_tr_b16 a[4:5], v15 offset:49152
    ds_read_b64_tr_b16 a[6:7], v15 offset:51200
    ds_read_b128 v[188:191], v34 offset:3072
    ds_read_b128 v[184:187], v34 offset:2048
    ds_read_b64_tr_b16 a[8:9], v14 offset:53248
    ds_read_b64_tr_b16 a[10:11], v14 offset:55296
    v_mfma_f32_16x16x32_bf16 v[80:83], a[40:43], v[72:75], v[80:83]
    v_mfma_f32_16x16x32_bf16 v[88:91], a[40:43], v[76:79], v[88:91]
    ds_read_b64_tr_b16 a[12:13], v15 offset:53248
    ds_read_b64_tr_b16 a[14:15], v15 offset:55296
    ds_read_b128 v[196:199], v34 offset:5120
    ds_read_b128 v[192:195], v34 offset:4096
    ds_read_b64_tr_b16 a[16:17], v14 offset:57344
    ds_read_b64_tr_b16 a[18:19], v14 offset:59392
    v_mfma_f32_16x16x32_bf16 v[84:87], a[44:47], v[72:75], v[84:87]
    v_mfma_f32_16x16x32_bf16 v[92:95], a[44:47], v[76:79], v[92:95]
    ds_read_b64_tr_b16 a[20:21], v15 offset:57344
    ds_read_b64_tr_b16 a[22:23], v15 offset:59392
    ds_read_b128 v[204:207], v34 offset:7168
    ds_read_b128 v[200:203], v34 offset:6144
    ds_read_b64_tr_b16 a[24:25], v14 offset:61440
    ds_read_b64_tr_b16 a[26:27], v14 offset:63488
    s_waitcnt lgkmcnt(12)
    v_mfma_f32_16x16x32_bf16 v[80:83], a[0:3], v[176:179], v[80:83]
    v_mfma_f32_16x16x32_bf16 v[88:91], a[0:3], v[180:183], v[88:91]
    ds_read_b64_tr_b16 a[28:29], v15 offset:61440
    ds_read_b64_tr_b16 a[30:31], v15 offset:63488
    v_mfma_f32_16x16x32_bf16 v[84:87], a[4:7], v[176:179], v[84:87]
    v_and_b32 v6, 1, v0
    v_bfe_u32 v1, v0, 1, 1
    v_mfma_f32_16x16x32_bf16 v[92:95], a[4:7], v[180:183], v[92:95]
    v_mfma_f32_16x16x32_bf16 v[80:83], a[8:11], v[184:187], v[80:83]
    v_lshl_add_u32 v6, v1, 3, v6
    v_mov_b32 v7, 1
    s_waitcnt lgkmcnt(0)
    v_mfma_f32_16x16x32_bf16 v[88:91], a[8:11], v[188:191], v[88:91]
    s_barrier
    v_mfma_f32_16x16x32_bf16 v[84:87], a[12:15], v[184:187], v[84:87]
    ds_read_b64_tr_b16 a[32:33], v12 offset:0
    ds_read_b64_tr_b16 a[34:35], v12 offset:2048
    v_lshlrev_b32 v6, 9, v6
    s_lshl_b32 s55, s3, 10
    v_mfma_f32_16x16x32_bf16 v[92:95], a[12:15], v[188:191], v[92:95]
    ds_read_b64_tr_b16 a[36:37], v13 offset:0
    ds_read_b64_tr_b16 a[38:39], v13 offset:2048
    ds_read_b64_tr_b16 a[40:41], v12 offset:4096
    ds_read_b64_tr_b16 a[42:43], v12 offset:6144
    v_mfma_f32_16x16x32_bf16 v[80:83], a[16:19], v[192:195], v[80:83]
    s_lshl_b32 s52, s63, 3
    s_add_u32 s55, s55, s52
    v_mfma_f32_16x16x32_bf16 v[88:91], a[16:19], v[196:199], v[88:91]
    ds_read_b64_tr_b16 a[44:45], v13 offset:4096
    ds_read_b64_tr_b16 a[46:47], v13 offset:6144
    ds_read_b64_tr_b16 a[0:1], v12 offset:8192
    ds_read_b64_tr_b16 a[2:3], v12 offset:10240
    v_mfma_f32_16x16x32_bf16 v[84:87], a[20:23], v[192:195], v[84:87]
    v_mfma_f32_16x16x32_bf16 v[92:95], a[20:23], v[196:199], v[92:95]
    ds_read_b64_tr_b16 a[4:5], v13 offset:8192
    ds_read_b64_tr_b16 a[6:7], v13 offset:10240
    v_mfma_f32_16x16x32_bf16 v[80:83], a[24:27], v[200:203], v[80:83]
    v_mfma_f32_16x16x32_bf16 v[88:91], a[24:27], v[204:207], v[88:91]
    ds_read_b64_tr_b16 a[8:9], v12 offset:12288
    ds_read_b64_tr_b16 a[10:11], v12 offset:14336
    v_mfma_f32_16x16x32_bf16 v[84:87], a[28:31], v[200:203], v[84:87]
    v_mfma_f32_16x16x32_bf16 v[92:95], a[28:31], v[204:207], v[92:95]
    ds_read_b64_tr_b16 a[12:13], v13 offset:12288
    ds_read_b64_tr_b16 a[14:15], v13 offset:14336
    s_waitcnt lgkmcnt(8)
    v_mfma_f32_16x16x32_bf16 v[96:99], a[32:35], v[48:51], 0
    v_mfma_f32_16x16x32_bf16 v[104:107], a[32:35], v[52:55], 0
    ds_read_b64_tr_b16 a[16:17], v14 offset:0
    ds_read_b64_tr_b16 a[18:19], v14 offset:2048
    v_mfma_f32_16x16x32_bf16 v[100:103], a[36:39], v[48:51], 0
    v_mfma_f32_16x16x32_bf16 v[108:111], a[36:39], v[52:55], 0
    ds_read_b64_tr_b16 a[20:21], v15 offset:0
    ds_read_b64_tr_b16 a[22:23], v15 offset:2048
    v_mfma_f32_16x16x32_bf16 v[96:99], a[40:43], v[56:59], v[96:99]
    s_mov_b32 s53, 0
    v_cvt_pk_bf16_f32 v144, v80, v81
    v_mfma_f32_16x16x32_bf16 v[104:107], a[40:43], v[60:63], v[104:107]
    ds_read_b64_tr_b16 a[24:25], v14 offset:4096
    ds_read_b64_tr_b16 a[26:27], v14 offset:6144
    v_cvt_pk_bf16_f32 v145, v82, v83
    v_mfma_f32_16x16x32_bf16 v[100:103], a[44:47], v[56:59], v[100:103]
    v_cvt_pk_bf16_f32 v146, v84, v85
    v_cvt_pk_bf16_f32 v147, v86, v87
    v_mfma_f32_16x16x32_bf16 v[108:111], a[44:47], v[60:63], v[108:111]
    ds_read_b64_tr_b16 a[28:29], v15 offset:4096
    ds_read_b64_tr_b16 a[30:31], v15 offset:6144
    buffer_store_dwordx4 v[144:147], v32, s[40:43], s53 offen sc1
    s_waitcnt lgkmcnt(8)
    v_mfma_f32_16x16x32_bf16 v[96:99], a[0:3], v[64:67], v[96:99]
    s_mov_b32 s54, 16384
    v_cvt_pk_bf16_f32 v148, v88, v89
    v_mfma_f32_16x16x32_bf16 v[104:107], a[0:3], v[68:71], v[104:107]
    ds_read_b64_tr_b16 a[32:33], v14 offset:8192
    ds_read_b64_tr_b16 a[34:35], v14 offset:10240
    v_cvt_pk_bf16_f32 v149, v90, v91
    v_mfma_f32_16x16x32_bf16 v[100:103], a[4:7], v[64:67], v[100:103]
    v_cvt_pk_bf16_f32 v150, v92, v93
    v_cvt_pk_bf16_f32 v151, v94, v95
    v_mfma_f32_16x16x32_bf16 v[108:111], a[4:7], v[68:71], v[108:111]
    ds_read_b64_tr_b16 a[36:37], v15 offset:8192
    ds_read_b64_tr_b16 a[38:39], v15 offset:10240
    buffer_store_dwordx4 v[148:151], v32, s[40:43], s54 offen sc1
    v_mfma_f32_16x16x32_bf16 v[96:99], a[8:11], v[72:75], v[96:99]
    v_mfma_f32_16x16x32_bf16 v[104:107], a[8:11], v[76:79], v[104:107]
    ds_read_b64_tr_b16 a[40:41], v14 offset:12288
    ds_read_b64_tr_b16 a[42:43], v14 offset:14336
    v_mfma_f32_16x16x32_bf16 v[100:103], a[12:15], v[72:75], v[100:103]
    v_mfma_f32_16x16x32_bf16 v[108:111], a[12:15], v[76:79], v[108:111]
    ds_read_b64_tr_b16 a[44:45], v15 offset:12288
    ds_read_b64_tr_b16 a[46:47], v15 offset:14336
    s_waitcnt lgkmcnt(8)
    v_mfma_f32_16x16x32_bf16 v[96:99], a[16:19], v[176:179], v[96:99]
    v_mfma_f32_16x16x32_bf16 v[104:107], a[16:19], v[180:183], v[104:107]
    v_mfma_f32_16x16x32_bf16 v[100:103], a[20:23], v[176:179], v[100:103]
    v_mfma_f32_16x16x32_bf16 v[108:111], a[20:23], v[180:183], v[108:111]
    v_mfma_f32_16x16x32_bf16 v[96:99], a[24:27], v[184:187], v[96:99]
    s_waitcnt lgkmcnt(0)
    v_mfma_f32_16x16x32_bf16 v[104:107], a[24:27], v[188:191], v[104:107]
    s_barrier
    v_mfma_f32_16x16x32_bf16 v[100:103], a[28:31], v[184:187], v[100:103]
    ds_read_b64_tr_b16 a[0:1], v12 offset:16384
    ds_read_b64_tr_b16 a[2:3], v12 offset:18432
    v_mfma_f32_16x16x32_bf16 v[108:111], a[28:31], v[188:191], v[108:111]
    ds_read_b64_tr_b16 a[4:5], v13 offset:16384
    ds_read_b64_tr_b16 a[6:7], v13 offset:18432
    ds_read_b64_tr_b16 a[8:9], v12 offset:20480
    ds_read_b64_tr_b16 a[10:11], v12 offset:22528
    v_mfma_f32_16x16x32_bf16 v[96:99], a[32:35], v[192:195], v[96:99]
    v_mfma_f32_16x16x32_bf16 v[104:107], a[32:35], v[196:199], v[104:107]
    ds_read_b64_tr_b16 a[12:13], v13 offset:20480
    ds_read_b64_tr_b16 a[14:15], v13 offset:22528
    ds_read_b64_tr_b16 a[16:17], v12 offset:24576
    ds_read_b64_tr_b16 a[18:19], v12 offset:26624
    v_mfma_f32_16x16x32_bf16 v[100:103], a[36:39], v[192:195], v[100:103]
    v_mfma_f32_16x16x32_bf16 v[108:111], a[36:39], v[196:199], v[108:111]
    ds_read_b64_tr_b16 a[20:21], v13 offset:24576
    ds_read_b64_tr_b16 a[22:23], v13 offset:26624
    v_mfma_f32_16x16x32_bf16 v[96:99], a[40:43], v[200:203], v[96:99]
    v_mfma_f32_16x16x32_bf16 v[104:107], a[40:43], v[204:207], v[104:107]
    ds_read_b64_tr_b16 a[24:25], v12 offset:28672
    ds_read_b64_tr_b16 a[26:27], v12 offset:30720
    v_mfma_f32_16x16x32_bf16 v[100:103], a[44:47], v[200:203], v[100:103]
    v_mfma_f32_16x16x32_bf16 v[108:111], a[44:47], v[204:207], v[108:111]
    ds_read_b64_tr_b16 a[28:29], v13 offset:28672
    ds_read_b64_tr_b16 a[30:31], v13 offset:30720
    s_waitcnt lgkmcnt(8)
    v_mfma_f32_16x16x32_bf16 v[112:115], a[0:3], v[48:51], 0
    v_mfma_f32_16x16x32_bf16 v[120:123], a[0:3], v[52:55], 0
    ds_read_b64_tr_b16 a[32:33], v14 offset:16384
    ds_read_b64_tr_b16 a[34:35], v14 offset:18432
    v_mfma_f32_16x16x32_bf16 v[116:119], a[4:7], v[48:51], 0
    v_mfma_f32_16x16x32_bf16 v[124:127], a[4:7], v[52:55], 0
    ds_read_b64_tr_b16 a[36:37], v15 offset:16384
    ds_read_b64_tr_b16 a[38:39], v15 offset:18432
    v_mfma_f32_16x16x32_bf16 v[112:115], a[8:11], v[56:59], v[112:115]
    s_mov_b32 s53, 131072
    v_cvt_pk_bf16_f32 v152, v96, v97
    v_mfma_f32_16x16x32_bf16 v[120:123], a[8:11], v[60:63], v[120:123]
    ds_read_b64_tr_b16 a[40:41], v14 offset:20480
    ds_read_b64_tr_b16 a[42:43], v14 offset:22528
    v_cvt_pk_bf16_f32 v153, v98, v99
    v_mfma_f32_16x16x32_bf16 v[116:119], a[12:15], v[56:59], v[116:119]
    v_cvt_pk_bf16_f32 v154, v100, v101
    v_cvt_pk_bf16_f32 v155, v102, v103
    v_mfma_f32_16x16x32_bf16 v[124:127], a[12:15], v[60:63], v[124:127]
    ds_read_b64_tr_b16 a[44:45], v15 offset:20480
    ds_read_b64_tr_b16 a[46:47], v15 offset:22528
    buffer_store_dwordx4 v[152:155], v32, s[40:43], s53 offen sc1
    s_waitcnt lgkmcnt(8)
    v_mfma_f32_16x16x32_bf16 v[112:115], a[16:19], v[64:67], v[112:115]
    s_mov_b32 s54, 147456
    v_cvt_pk_bf16_f32 v156, v104, v105
    v_mfma_f32_16x16x32_bf16 v[120:123], a[16:19], v[68:71], v[120:123]
    ds_read_b64_tr_b16 a[0:1], v14 offset:24576
    ds_read_b64_tr_b16 a[2:3], v14 offset:26624
    v_cvt_pk_bf16_f32 v157, v106, v107
    v_mfma_f32_16x16x32_bf16 v[116:119], a[20:23], v[64:67], v[116:119]
    v_cvt_pk_bf16_f32 v158, v108, v109
    v_cvt_pk_bf16_f32 v159, v110, v111
    v_mfma_f32_16x16x32_bf16 v[124:127], a[20:23], v[68:71], v[124:127]
    ds_read_b64_tr_b16 a[4:5], v15 offset:24576
    ds_read_b64_tr_b16 a[6:7], v15 offset:26624
    buffer_store_dwordx4 v[156:159], v32, s[40:43], s54 offen sc1
    v_mfma_f32_16x16x32_bf16 v[112:115], a[24:27], v[72:75], v[112:115]
    v_mfma_f32_16x16x32_bf16 v[120:123], a[24:27], v[76:79], v[120:123]
    ds_read_b64_tr_b16 a[8:9], v14 offset:28672
    ds_read_b64_tr_b16 a[10:11], v14 offset:30720
    v_mfma_f32_16x16x32_bf16 v[116:119], a[28:31], v[72:75], v[116:119]
    v_mfma_f32_16x16x32_bf16 v[124:127], a[28:31], v[76:79], v[124:127]
    ds_read_b64_tr_b16 a[12:13], v15 offset:28672
    ds_read_b64_tr_b16 a[14:15], v15 offset:30720
    s_waitcnt lgkmcnt(8)
    v_mfma_f32_16x16x32_bf16 v[112:115], a[32:35], v[176:179], v[112:115]
    v_mfma_f32_16x16x32_bf16 v[120:123], a[32:35], v[180:183], v[120:123]
    v_mfma_f32_16x16x32_bf16 v[116:119], a[36:39], v[176:179], v[116:119]
    v_mfma_f32_16x16x32_bf16 v[124:127], a[36:39], v[180:183], v[124:127]
    v_mfma_f32_16x16x32_bf16 v[112:115], a[40:43], v[184:187], v[112:115]
    s_waitcnt lgkmcnt(0)
    v_mfma_f32_16x16x32_bf16 v[120:123], a[40:43], v[188:191], v[120:123]
    s_barrier
    v_mfma_f32_16x16x32_bf16 v[116:119], a[44:47], v[184:187], v[116:119]
    ds_read_b64_tr_b16 a[16:17], v12 offset:32768
    ds_read_b64_tr_b16 a[18:19], v12 offset:34816
    v_mfma_f32_16x16x32_bf16 v[124:127], a[44:47], v[188:191], v[124:127]
    ds_read_b64_tr_b16 a[20:21], v13 offset:32768
    ds_read_b64_tr_b16 a[22:23], v13 offset:34816
    ds_read_b64_tr_b16 a[24:25], v12 offset:36864
    ds_read_b64_tr_b16 a[26:27], v12 offset:38912
    v_mfma_f32_16x16x32_bf16 v[112:115], a[0:3], v[192:195], v[112:115]
    v_mfma_f32_16x16x32_bf16 v[120:123], a[0:3], v[196:199], v[120:123]
    ds_read_b64_tr_b16 a[28:29], v13 offset:36864
    ds_read_b64_tr_b16 a[30:31], v13 offset:38912
    ds_read_b64_tr_b16 a[32:33], v12 offset:40960
    ds_read_b64_tr_b16 a[34:35], v12 offset:43008
    v_mfma_f32_16x16x32_bf16 v[116:119], a[4:7], v[192:195], v[116:119]
    v_mfma_f32_16x16x32_bf16 v[124:127], a[4:7], v[196:199], v[124:127]
    ds_read_b64_tr_b16 a[36:37], v13 offset:40960
    ds_read_b64_tr_b16 a[38:39], v13 offset:43008
    v_mfma_f32_16x16x32_bf16 v[112:115], a[8:11], v[200:203], v[112:115]
    v_mfma_f32_16x16x32_bf16 v[120:123], a[8:11], v[204:207], v[120:123]
    ds_read_b64_tr_b16 a[40:41], v12 offset:45056
    ds_read_b64_tr_b16 a[42:43], v12 offset:47104
    v_mfma_f32_16x16x32_bf16 v[116:119], a[12:15], v[200:203], v[116:119]
    v_mfma_f32_16x16x32_bf16 v[124:127], a[12:15], v[204:207], v[124:127]
    ds_read_b64_tr_b16 a[44:45], v13 offset:45056
    ds_read_b64_tr_b16 a[46:47], v13 offset:47104
    s_waitcnt lgkmcnt(8)
    v_mfma_f32_16x16x32_bf16 v[128:131], a[16:19], v[48:51], 0
    v_mfma_f32_16x16x32_bf16 v[136:139], a[16:19], v[52:55], 0
    ds_read_b64_tr_b16 a[0:1], v14 offset:32768
    ds_read_b64_tr_b16 a[2:3], v14 offset:34816
    v_mfma_f32_16x16x32_bf16 v[132:135], a[20:23], v[48:51], 0
    v_mfma_f32_16x16x32_bf16 v[140:143], a[20:23], v[52:55], 0
    ds_read_b64_tr_b16 a[4:5], v15 offset:32768
    ds_read_b64_tr_b16 a[6:7], v15 offset:34816
    v_mfma_f32_16x16x32_bf16 v[128:131], a[24:27], v[56:59], v[128:131]
    s_mov_b32 s53, 262144
    v_cvt_pk_bf16_f32 v160, v112, v113
    v_mfma_f32_16x16x32_bf16 v[136:139], a[24:27], v[60:63], v[136:139]
    ds_read_b64_tr_b16 a[8:9], v14 offset:36864
    ds_read_b64_tr_b16 a[10:11], v14 offset:38912
    v_cvt_pk_bf16_f32 v161, v114, v115
    v_mfma_f32_16x16x32_bf16 v[132:135], a[28:31], v[56:59], v[132:135]
    v_cvt_pk_bf16_f32 v162, v116, v117
    v_cvt_pk_bf16_f32 v163, v118, v119
    v_mfma_f32_16x16x32_bf16 v[140:143], a[28:31], v[60:63], v[140:143]
    ds_read_b64_tr_b16 a[12:13], v15 offset:36864
    ds_read_b64_tr_b16 a[14:15], v15 offset:38912
    buffer_store_dwordx4 v[160:163], v32, s[40:43], s53 offen sc1
    s_waitcnt lgkmcnt(8)
    v_mfma_f32_16x16x32_bf16 v[128:131], a[32:35], v[64:67], v[128:131]
    s_mov_b32 s54, 278528
    v_cvt_pk_bf16_f32 v164, v120, v121
    v_mfma_f32_16x16x32_bf16 v[136:139], a[32:35], v[68:71], v[136:139]
    ds_read_b64_tr_b16 a[16:17], v14 offset:40960
    ds_read_b64_tr_b16 a[18:19], v14 offset:43008
    v_cvt_pk_bf16_f32 v165, v122, v123
    v_mfma_f32_16x16x32_bf16 v[132:135], a[36:39], v[64:67], v[132:135]
    v_cvt_pk_bf16_f32 v166, v124, v125
    v_cvt_pk_bf16_f32 v167, v126, v127
    v_mfma_f32_16x16x32_bf16 v[140:143], a[36:39], v[68:71], v[140:143]
    ds_read_b64_tr_b16 a[20:21], v15 offset:40960
    ds_read_b64_tr_b16 a[22:23], v15 offset:43008
    buffer_store_dwordx4 v[164:167], v32, s[40:43], s54 offen sc1
    v_mfma_f32_16x16x32_bf16 v[128:131], a[40:43], v[72:75], v[128:131]
    v_mfma_f32_16x16x32_bf16 v[136:139], a[40:43], v[76:79], v[136:139]
    ds_read_b64_tr_b16 a[24:25], v14 offset:45056
    ds_read_b64_tr_b16 a[26:27], v14 offset:47104
    v_mfma_f32_16x16x32_bf16 v[132:135], a[44:47], v[72:75], v[132:135]
    v_mfma_f32_16x16x32_bf16 v[140:143], a[44:47], v[76:79], v[140:143]
    ds_read_b64_tr_b16 a[28:29], v15 offset:45056
    ds_read_b64_tr_b16 a[30:31], v15 offset:47104
    s_waitcnt lgkmcnt(8)
    v_mfma_f32_16x16x32_bf16 v[128:131], a[0:3], v[176:179], v[128:131]
    v_mfma_f32_16x16x32_bf16 v[136:139], a[0:3], v[180:183], v[136:139]
    v_mfma_f32_16x16x32_bf16 v[132:135], a[4:7], v[176:179], v[132:135]
    v_mfma_f32_16x16x32_bf16 v[140:143], a[4:7], v[180:183], v[140:143]
    v_mfma_f32_16x16x32_bf16 v[128:131], a[8:11], v[184:187], v[128:131]
    s_waitcnt lgkmcnt(0)
    v_mfma_f32_16x16x32_bf16 v[136:139], a[8:11], v[188:191], v[136:139]
    s_barrier
    v_mfma_f32_16x16x32_bf16 v[132:135], a[12:15], v[184:187], v[132:135]
    ds_read_b64_tr_b16 a[32:33], v12 offset:49152
    ds_read_b64_tr_b16 a[34:35], v12 offset:51200
    v_mfma_f32_16x16x32_bf16 v[140:143], a[12:15], v[188:191], v[140:143]
    ds_read_b64_tr_b16 a[36:37], v13 offset:49152
    ds_read_b64_tr_b16 a[38:39], v13 offset:51200
    ds_read_b64_tr_b16 a[40:41], v12 offset:53248
    ds_read_b64_tr_b16 a[42:43], v12 offset:55296
    v_mfma_f32_16x16x32_bf16 v[128:131], a[16:19], v[192:195], v[128:131]
    v_mfma_f32_16x16x32_bf16 v[136:139], a[16:19], v[196:199], v[136:139]
    ds_read_b64_tr_b16 a[44:45], v13 offset:53248
    ds_read_b64_tr_b16 a[46:47], v13 offset:55296
    ds_read_b64_tr_b16 a[0:1], v12 offset:57344
    ds_read_b64_tr_b16 a[2:3], v12 offset:59392
    v_mfma_f32_16x16x32_bf16 v[132:135], a[20:23], v[192:195], v[132:135]
    v_mfma_f32_16x16x32_bf16 v[140:143], a[20:23], v[196:199], v[140:143]
    ds_read_b64_tr_b16 a[4:5], v13 offset:57344
    ds_read_b64_tr_b16 a[6:7], v13 offset:59392
    v_mfma_f32_16x16x32_bf16 v[128:131], a[24:27], v[200:203], v[128:131]
    v_mfma_f32_16x16x32_bf16 v[136:139], a[24:27], v[204:207], v[136:139]
    ds_read_b64_tr_b16 a[8:9], v12 offset:61440
    ds_read_b64_tr_b16 a[10:11], v12 offset:63488
    v_mfma_f32_16x16x32_bf16 v[132:135], a[28:31], v[200:203], v[132:135]
    v_mfma_f32_16x16x32_bf16 v[140:143], a[28:31], v[204:207], v[140:143]
    ds_read_b64_tr_b16 a[12:13], v13 offset:61440
    ds_read_b64_tr_b16 a[14:15], v13 offset:63488
    s_waitcnt lgkmcnt(8)
    v_mfma_f32_16x16x32_bf16 v[80:83], a[32:35], v[48:51], 0
    v_mfma_f32_16x16x32_bf16 v[88:91], a[32:35], v[52:55], 0
    ds_read_b64_tr_b16 a[16:17], v14 offset:49152
    ds_read_b64_tr_b16 a[18:19], v14 offset:51200
    v_mfma_f32_16x16x32_bf16 v[84:87], a[36:39], v[48:51], 0
    v_mfma_f32_16x16x32_bf16 v[92:95], a[36:39], v[52:55], 0
    ds_read_b64_tr_b16 a[20:21], v15 offset:49152
    ds_read_b64_tr_b16 a[22:23], v15 offset:51200
    v_mfma_f32_16x16x32_bf16 v[80:83], a[40:43], v[56:59], v[80:83]
    s_mov_b32 s53, 393216
    v_cvt_pk_bf16_f32 v168, v128, v129
    v_mfma_f32_16x16x32_bf16 v[88:91], a[40:43], v[60:63], v[88:91]
    ds_read_b64_tr_b16 a[24:25], v14 offset:53248
    ds_read_b64_tr_b16 a[26:27], v14 offset:55296
    v_cvt_pk_bf16_f32 v169, v130, v131
    v_mfma_f32_16x16x32_bf16 v[84:87], a[44:47], v[56:59], v[84:87]
    v_cvt_pk_bf16_f32 v170, v132, v133
    v_cvt_pk_bf16_f32 v171, v134, v135
    v_mfma_f32_16x16x32_bf16 v[92:95], a[44:47], v[60:63], v[92:95]
    ds_read_b64_tr_b16 a[28:29], v15 offset:53248
    ds_read_b64_tr_b16 a[30:31], v15 offset:55296
    buffer_store_dwordx4 v[168:171], v32, s[40:43], s53 offen sc1
    s_waitcnt lgkmcnt(8)
    v_mfma_f32_16x16x32_bf16 v[80:83], a[0:3], v[64:67], v[80:83]
    s_mov_b32 s54, 409600
    v_cvt_pk_bf16_f32 v172, v136, v137
    v_mfma_f32_16x16x32_bf16 v[88:91], a[0:3], v[68:71], v[88:91]
    ds_read_b64_tr_b16 a[32:33], v14 offset:57344
    ds_read_b64_tr_b16 a[34:35], v14 offset:59392
    v_cvt_pk_bf16_f32 v173, v138, v139
    v_mfma_f32_16x16x32_bf16 v[84:87], a[4:7], v[64:67], v[84:87]
    v_cvt_pk_bf16_f32 v174, v140, v141
    v_cvt_pk_bf16_f32 v175, v142, v143
    v_mfma_f32_16x16x32_bf16 v[92:95], a[4:7], v[68:71], v[92:95]
    ds_read_b64_tr_b16 a[36:37], v15 offset:57344
    ds_read_b64_tr_b16 a[38:39], v15 offset:59392
    buffer_store_dwordx4 v[172:175], v32, s[40:43], s54 offen sc1
    v_mfma_f32_16x16x32_bf16 v[80:83], a[8:11], v[72:75], v[80:83]
    v_mfma_f32_16x16x32_bf16 v[88:91], a[8:11], v[76:79], v[88:91]
    ds_read_b64_tr_b16 a[40:41], v14 offset:61440
    ds_read_b64_tr_b16 a[42:43], v14 offset:63488
    v_mfma_f32_16x16x32_bf16 v[84:87], a[12:15], v[72:75], v[84:87]
    v_mfma_f32_16x16x32_bf16 v[92:95], a[12:15], v[76:79], v[92:95]
    ds_read_b64_tr_b16 a[44:45], v15 offset:61440
    ds_read_b64_tr_b16 a[46:47], v15 offset:63488
    s_waitcnt lgkmcnt(8)
    v_mfma_f32_16x16x32_bf16 v[80:83], a[16:19], v[176:179], v[80:83]
    v_mfma_f32_16x16x32_bf16 v[88:91], a[16:19], v[180:183], v[88:91]
    v_mfma_f32_16x16x32_bf16 v[84:87], a[20:23], v[176:179], v[84:87]
    v_mfma_f32_16x16x32_bf16 v[92:95], a[20:23], v[180:183], v[92:95]
    v_mfma_f32_16x16x32_bf16 v[80:83], a[24:27], v[184:187], v[80:83]
    s_waitcnt lgkmcnt(0)
    s_waitcnt vmcnt(4)
    v_mfma_f32_16x16x32_bf16 v[88:91], a[24:27], v[188:191], v[88:91]
    s_barrier
    v_mfma_f32_16x16x32_bf16 v[84:87], a[28:31], v[184:187], v[84:87]
    ds_read_b64_tr_b16 a[0:1], v12 offset:0
    ds_read_b64_tr_b16 a[2:3], v12 offset:2048
    v_mfma_f32_16x16x32_bf16 v[92:95], a[28:31], v[188:191], v[92:95]
    ds_read_b64_tr_b16 a[4:5], v13 offset:0
    ds_read_b64_tr_b16 a[6:7], v13 offset:2048
    ds_read_b64_tr_b16 a[8:9], v12 offset:4096
    ds_read_b64_tr_b16 a[10:11], v12 offset:6144
    v_mfma_f32_16x16x32_bf16 v[80:83], a[32:35], v[192:195], v[80:83]
    v_mfma_f32_16x16x32_bf16 v[88:91], a[32:35], v[196:199], v[88:91]
    ds_read_b64_tr_b16 a[12:13], v13 offset:4096
    ds_read_b64_tr_b16 a[14:15], v13 offset:6144
    ds_read_b64_tr_b16 a[16:17], v12 offset:8192
    ds_read_b64_tr_b16 a[18:19], v12 offset:10240
    v_mfma_f32_16x16x32_bf16 v[84:87], a[36:39], v[192:195], v[84:87]
    v_mfma_f32_16x16x32_bf16 v[92:95], a[36:39], v[196:199], v[92:95]
    ds_read_b64_tr_b16 a[20:21], v13 offset:8192
    ds_read_b64_tr_b16 a[22:23], v13 offset:10240
    v_mfma_f32_16x16x32_bf16 v[80:83], a[40:43], v[200:203], v[80:83]
    v_mfma_f32_16x16x32_bf16 v[88:91], a[40:43], v[204:207], v[88:91]
    ds_read_b64_tr_b16 a[24:25], v12 offset:12288
    ds_read_b64_tr_b16 a[26:27], v12 offset:14336
    v_mfma_f32_16x16x32_bf16 v[84:87], a[44:47], v[200:203], v[84:87]
    v_mfma_f32_16x16x32_bf16 v[92:95], a[44:47], v[204:207], v[92:95]
    ds_read_b64_tr_b16 a[28:29], v13 offset:12288
    ds_read_b64_tr_b16 a[30:31], v13 offset:14336
    s_waitcnt lgkmcnt(8)
    v_mfma_f32_16x16x32_bf16 v[96:99], a[0:3], v[48:51], 0
    v_mfma_f32_16x16x32_bf16 v[104:107], a[0:3], v[52:55], 0
    ds_read_b64_tr_b16 a[32:33], v14 offset:0
    ds_read_b64_tr_b16 a[34:35], v14 offset:2048
    v_mfma_f32_16x16x32_bf16 v[100:103], a[4:7], v[48:51], 0
    v_mfma_f32_16x16x32_bf16 v[108:111], a[4:7], v[52:55], 0
    ds_read_b64_tr_b16 a[36:37], v15 offset:0
    ds_read_b64_tr_b16 a[38:39], v15 offset:2048
    v_mfma_f32_16x16x32_bf16 v[96:99], a[8:11], v[56:59], v[96:99]
    s_mov_b32 s53, 524288
    v_cvt_pk_bf16_f32 v144, v80, v81
    v_mfma_f32_16x16x32_bf16 v[104:107], a[8:11], v[60:63], v[104:107]
    ds_read_b64_tr_b16 a[40:41], v14 offset:4096
    ds_read_b64_tr_b16 a[42:43], v14 offset:6144
    v_cvt_pk_bf16_f32 v145, v82, v83
    v_mfma_f32_16x16x32_bf16 v[100:103], a[12:15], v[56:59], v[100:103]
    v_cvt_pk_bf16_f32 v146, v84, v85
    v_cvt_pk_bf16_f32 v147, v86, v87
    v_mfma_f32_16x16x32_bf16 v[108:111], a[12:15], v[60:63], v[108:111]
    ds_read_b64_tr_b16 a[44:45], v15 offset:4096
    ds_read_b64_tr_b16 a[46:47], v15 offset:6144
    buffer_store_dwordx4 v[144:147], v32, s[40:43], s53 offen sc1
    s_waitcnt lgkmcnt(8)
    v_mfma_f32_16x16x32_bf16 v[96:99], a[16:19], v[64:67], v[96:99]
    s_mov_b32 s54, 540672
    v_cvt_pk_bf16_f32 v148, v88, v89
    v_mfma_f32_16x16x32_bf16 v[104:107], a[16:19], v[68:71], v[104:107]
    ds_read_b64_tr_b16 a[0:1], v14 offset:8192
    ds_read_b64_tr_b16 a[2:3], v14 offset:10240
    v_cvt_pk_bf16_f32 v149, v90, v91
    v_mfma_f32_16x16x32_bf16 v[100:103], a[20:23], v[64:67], v[100:103]
    v_cvt_pk_bf16_f32 v150, v92, v93
    v_cvt_pk_bf16_f32 v151, v94, v95
    v_mfma_f32_16x16x32_bf16 v[108:111], a[20:23], v[68:71], v[108:111]
    ds_read_b64_tr_b16 a[4:5], v15 offset:8192
    ds_read_b64_tr_b16 a[6:7], v15 offset:10240
    buffer_store_dwordx4 v[148:151], v32, s[40:43], s54 offen sc1
    v_mfma_f32_16x16x32_bf16 v[96:99], a[24:27], v[72:75], v[96:99]
    v_mfma_f32_16x16x32_bf16 v[104:107], a[24:27], v[76:79], v[104:107]
    ds_read_b64_tr_b16 a[8:9], v14 offset:12288
    ds_read_b64_tr_b16 a[10:11], v14 offset:14336
    v_mfma_f32_16x16x32_bf16 v[100:103], a[28:31], v[72:75], v[100:103]
    v_mfma_f32_16x16x32_bf16 v[108:111], a[28:31], v[76:79], v[108:111]
    ds_read_b64_tr_b16 a[12:13], v15 offset:12288
    ds_read_b64_tr_b16 a[14:15], v15 offset:14336
    s_waitcnt lgkmcnt(8)
    v_mfma_f32_16x16x32_bf16 v[96:99], a[32:35], v[176:179], v[96:99]
    v_mfma_f32_16x16x32_bf16 v[104:107], a[32:35], v[180:183], v[104:107]
    v_mfma_f32_16x16x32_bf16 v[100:103], a[36:39], v[176:179], v[100:103]
    v_mfma_f32_16x16x32_bf16 v[108:111], a[36:39], v[180:183], v[108:111]
    v_mfma_f32_16x16x32_bf16 v[96:99], a[40:43], v[184:187], v[96:99]
    s_waitcnt lgkmcnt(0)
    v_mfma_f32_16x16x32_bf16 v[104:107], a[40:43], v[188:191], v[104:107]
    s_barrier
    v_mfma_f32_16x16x32_bf16 v[100:103], a[44:47], v[184:187], v[100:103]
    ds_read_b64_tr_b16 a[16:17], v12 offset:16384
    ds_read_b64_tr_b16 a[18:19], v12 offset:18432
    v_mfma_f32_16x16x32_bf16 v[108:111], a[44:47], v[188:191], v[108:111]
    ds_read_b64_tr_b16 a[20:21], v13 offset:16384
    ds_read_b64_tr_b16 a[22:23], v13 offset:18432
    ds_read_b64_tr_b16 a[24:25], v12 offset:20480
    ds_read_b64_tr_b16 a[26:27], v12 offset:22528
    v_mfma_f32_16x16x32_bf16 v[96:99], a[0:3], v[192:195], v[96:99]
    v_mfma_f32_16x16x32_bf16 v[104:107], a[0:3], v[196:199], v[104:107]
    ds_read_b64_tr_b16 a[28:29], v13 offset:20480
    ds_read_b64_tr_b16 a[30:31], v13 offset:22528
    ds_read_b64_tr_b16 a[32:33], v12 offset:24576
    ds_read_b64_tr_b16 a[34:35], v12 offset:26624
    v_mfma_f32_16x16x32_bf16 v[100:103], a[4:7], v[192:195], v[100:103]
    v_mfma_f32_16x16x32_bf16 v[108:111], a[4:7], v[196:199], v[108:111]
    ds_read_b64_tr_b16 a[36:37], v13 offset:24576
    ds_read_b64_tr_b16 a[38:39], v13 offset:26624
    v_mfma_f32_16x16x32_bf16 v[96:99], a[8:11], v[200:203], v[96:99]
    v_mfma_f32_16x16x32_bf16 v[104:107], a[8:11], v[204:207], v[104:107]
    ds_read_b64_tr_b16 a[40:41], v12 offset:28672
    ds_read_b64_tr_b16 a[42:43], v12 offset:30720
    v_mfma_f32_16x16x32_bf16 v[100:103], a[12:15], v[200:203], v[100:103]
    v_mfma_f32_16x16x32_bf16 v[108:111], a[12:15], v[204:207], v[108:111]
    ds_read_b64_tr_b16 a[44:45], v13 offset:28672
    ds_read_b64_tr_b16 a[46:47], v13 offset:30720
    s_waitcnt lgkmcnt(8)
    v_mfma_f32_16x16x32_bf16 v[112:115], a[16:19], v[48:51], 0
    v_mfma_f32_16x16x32_bf16 v[120:123], a[16:19], v[52:55], 0
    ds_read_b64_tr_b16 a[0:1], v14 offset:16384
    ds_read_b64_tr_b16 a[2:3], v14 offset:18432
    v_mfma_f32_16x16x32_bf16 v[116:119], a[20:23], v[48:51], 0
    v_mfma_f32_16x16x32_bf16 v[124:127], a[20:23], v[52:55], 0
    ds_read_b64_tr_b16 a[4:5], v15 offset:16384
    ds_read_b64_tr_b16 a[6:7], v15 offset:18432
    v_mfma_f32_16x16x32_bf16 v[112:115], a[24:27], v[56:59], v[112:115]
    s_mov_b32 s53, 655360
    v_cvt_pk_bf16_f32 v152, v96, v97
    v_mfma_f32_16x16x32_bf16 v[120:123], a[24:27], v[60:63], v[120:123]
    ds_read_b64_tr_b16 a[8:9], v14 offset:20480
    ds_read_b64_tr_b16 a[10:11], v14 offset:22528
    v_cvt_pk_bf16_f32 v153, v98, v99
    v_mfma_f32_16x16x32_bf16 v[116:119], a[28:31], v[56:59], v[116:119]
    v_cvt_pk_bf16_f32 v154, v100, v101
    v_cvt_pk_bf16_f32 v155, v102, v103
    v_mfma_f32_16x16x32_bf16 v[124:127], a[28:31], v[60:63], v[124:127]
    ds_read_b64_tr_b16 a[12:13], v15 offset:20480
    ds_read_b64_tr_b16 a[14:15], v15 offset:22528
    buffer_store_dwordx4 v[152:155], v32, s[40:43], s53 offen sc1
    s_waitcnt lgkmcnt(8)
    v_mfma_f32_16x16x32_bf16 v[112:115], a[32:35], v[64:67], v[112:115]
    s_mov_b32 s54, 671744
    v_cvt_pk_bf16_f32 v156, v104, v105
    v_mfma_f32_16x16x32_bf16 v[120:123], a[32:35], v[68:71], v[120:123]
    ds_read_b64_tr_b16 a[16:17], v14 offset:24576
    ds_read_b64_tr_b16 a[18:19], v14 offset:26624
    v_cvt_pk_bf16_f32 v157, v106, v107
    v_mfma_f32_16x16x32_bf16 v[116:119], a[36:39], v[64:67], v[116:119]
    v_cvt_pk_bf16_f32 v158, v108, v109
    v_cvt_pk_bf16_f32 v159, v110, v111
    v_mfma_f32_16x16x32_bf16 v[124:127], a[36:39], v[68:71], v[124:127]
    ds_read_b64_tr_b16 a[20:21], v15 offset:24576
    ds_read_b64_tr_b16 a[22:23], v15 offset:26624
    buffer_store_dwordx4 v[156:159], v32, s[40:43], s54 offen sc1
    v_mfma_f32_16x16x32_bf16 v[112:115], a[40:43], v[72:75], v[112:115]
    v_mfma_f32_16x16x32_bf16 v[120:123], a[40:43], v[76:79], v[120:123]
    ds_read_b64_tr_b16 a[24:25], v14 offset:28672
    ds_read_b64_tr_b16 a[26:27], v14 offset:30720
    v_mfma_f32_16x16x32_bf16 v[116:119], a[44:47], v[72:75], v[116:119]
    v_mfma_f32_16x16x32_bf16 v[124:127], a[44:47], v[76:79], v[124:127]
    ds_read_b64_tr_b16 a[28:29], v15 offset:28672
    ds_read_b64_tr_b16 a[30:31], v15 offset:30720
    s_waitcnt lgkmcnt(8)
    v_mfma_f32_16x16x32_bf16 v[112:115], a[0:3], v[176:179], v[112:115]
    v_mfma_f32_16x16x32_bf16 v[120:123], a[0:3], v[180:183], v[120:123]
    v_mfma_f32_16x16x32_bf16 v[116:119], a[4:7], v[176:179], v[116:119]
    v_mfma_f32_16x16x32_bf16 v[124:127], a[4:7], v[180:183], v[124:127]
    v_mfma_f32_16x16x32_bf16 v[112:115], a[8:11], v[184:187], v[112:115]
    s_waitcnt lgkmcnt(0)
    s_waitcnt vmcnt(4)
    v_mfma_f32_16x16x32_bf16 v[120:123], a[8:11], v[188:191], v[120:123]
    s_barrier
    v_mfma_f32_16x16x32_bf16 v[116:119], a[12:15], v[184:187], v[116:119]
    ds_read_b64_tr_b16 a[32:33], v12 offset:32768
    ds_read_b64_tr_b16 a[34:35], v12 offset:34816
    v_mfma_f32_16x16x32_bf16 v[124:127], a[12:15], v[188:191], v[124:127]
    ds_read_b64_tr_b16 a[36:37], v13 offset:32768
    ds_read_b64_tr_b16 a[38:39], v13 offset:34816
    ds_read_b64_tr_b16 a[40:41], v12 offset:36864
    ds_read_b64_tr_b16 a[42:43], v12 offset:38912
    v_mfma_f32_16x16x32_bf16 v[112:115], a[16:19], v[192:195], v[112:115]
    v_mfma_f32_16x16x32_bf16 v[120:123], a[16:19], v[196:199], v[120:123]
    ds_read_b64_tr_b16 a[44:45], v13 offset:36864
    ds_read_b64_tr_b16 a[46:47], v13 offset:38912
    ds_read_b64_tr_b16 a[0:1], v12 offset:40960
    ds_read_b64_tr_b16 a[2:3], v12 offset:43008
    v_mfma_f32_16x16x32_bf16 v[116:119], a[20:23], v[192:195], v[116:119]
    v_mfma_f32_16x16x32_bf16 v[124:127], a[20:23], v[196:199], v[124:127]
    ds_read_b64_tr_b16 a[4:5], v13 offset:40960
    ds_read_b64_tr_b16 a[6:7], v13 offset:43008
    v_mfma_f32_16x16x32_bf16 v[112:115], a[24:27], v[200:203], v[112:115]
    v_mfma_f32_16x16x32_bf16 v[120:123], a[24:27], v[204:207], v[120:123]
    ds_read_b64_tr_b16 a[8:9], v12 offset:45056
    ds_read_b64_tr_b16 a[10:11], v12 offset:47104
    v_mfma_f32_16x16x32_bf16 v[116:119], a[28:31], v[200:203], v[116:119]
    v_mfma_f32_16x16x32_bf16 v[124:127], a[28:31], v[204:207], v[124:127]
    ds_read_b64_tr_b16 a[12:13], v13 offset:45056
    ds_read_b64_tr_b16 a[14:15], v13 offset:47104
    s_waitcnt lgkmcnt(8)
    v_mfma_f32_16x16x32_bf16 v[128:131], a[32:35], v[48:51], 0
    v_mfma_f32_16x16x32_bf16 v[136:139], a[32:35], v[52:55], 0
    ds_read_b64_tr_b16 a[16:17], v14 offset:32768
    ds_read_b64_tr_b16 a[18:19], v14 offset:34816
    v_mfma_f32_16x16x32_bf16 v[132:135], a[36:39], v[48:51], 0
    v_mfma_f32_16x16x32_bf16 v[140:143], a[36:39], v[52:55], 0
    ds_read_b64_tr_b16 a[20:21], v15 offset:32768
    ds_read_b64_tr_b16 a[22:23], v15 offset:34816
    v_mfma_f32_16x16x32_bf16 v[128:131], a[40:43], v[56:59], v[128:131]
    s_mov_b32 s53, 786432
    v_cvt_pk_bf16_f32 v160, v112, v113
    v_mfma_f32_16x16x32_bf16 v[136:139], a[40:43], v[60:63], v[136:139]
    ds_read_b64_tr_b16 a[24:25], v14 offset:36864
    ds_read_b64_tr_b16 a[26:27], v14 offset:38912
    v_cvt_pk_bf16_f32 v161, v114, v115
    v_mfma_f32_16x16x32_bf16 v[132:135], a[44:47], v[56:59], v[132:135]
    v_cvt_pk_bf16_f32 v162, v116, v117
    v_cvt_pk_bf16_f32 v163, v118, v119
    v_mfma_f32_16x16x32_bf16 v[140:143], a[44:47], v[60:63], v[140:143]
    ds_read_b64_tr_b16 a[28:29], v15 offset:36864
    ds_read_b64_tr_b16 a[30:31], v15 offset:38912
    buffer_store_dwordx4 v[160:163], v32, s[40:43], s53 offen sc1
    s_waitcnt lgkmcnt(8)
    v_mfma_f32_16x16x32_bf16 v[128:131], a[0:3], v[64:67], v[128:131]
    s_mov_b32 s54, 802816
    v_cvt_pk_bf16_f32 v164, v120, v121
    v_mfma_f32_16x16x32_bf16 v[136:139], a[0:3], v[68:71], v[136:139]
    ds_read_b64_tr_b16 a[32:33], v14 offset:40960
    ds_read_b64_tr_b16 a[34:35], v14 offset:43008
    v_cvt_pk_bf16_f32 v165, v122, v123
    v_mfma_f32_16x16x32_bf16 v[132:135], a[4:7], v[64:67], v[132:135]
    v_cvt_pk_bf16_f32 v166, v124, v125
    v_cvt_pk_bf16_f32 v167, v126, v127
    v_mfma_f32_16x16x32_bf16 v[140:143], a[4:7], v[68:71], v[140:143]
    ds_read_b64_tr_b16 a[36:37], v15 offset:40960
    ds_read_b64_tr_b16 a[38:39], v15 offset:43008
    buffer_store_dwordx4 v[164:167], v32, s[40:43], s54 offen sc1
    v_mfma_f32_16x16x32_bf16 v[128:131], a[8:11], v[72:75], v[128:131]
    v_mfma_f32_16x16x32_bf16 v[136:139], a[8:11], v[76:79], v[136:139]
    ds_read_b64_tr_b16 a[40:41], v14 offset:45056
    ds_read_b64_tr_b16 a[42:43], v14 offset:47104
    v_mfma_f32_16x16x32_bf16 v[132:135], a[12:15], v[72:75], v[132:135]
    v_mfma_f32_16x16x32_bf16 v[140:143], a[12:15], v[76:79], v[140:143]
    ds_read_b64_tr_b16 a[44:45], v15 offset:45056
    ds_read_b64_tr_b16 a[46:47], v15 offset:47104
    s_waitcnt lgkmcnt(8)
    v_mfma_f32_16x16x32_bf16 v[128:131], a[16:19], v[176:179], v[128:131]
    v_mfma_f32_16x16x32_bf16 v[136:139], a[16:19], v[180:183], v[136:139]
    v_mfma_f32_16x16x32_bf16 v[132:135], a[20:23], v[176:179], v[132:135]
    v_mfma_f32_16x16x32_bf16 v[140:143], a[20:23], v[180:183], v[140:143]
    v_mfma_f32_16x16x32_bf16 v[128:131], a[24:27], v[184:187], v[128:131]
    v_mfma_f32_16x16x32_bf16 v[136:139], a[24:27], v[188:191], v[136:139]
    v_mfma_f32_16x16x32_bf16 v[132:135], a[28:31], v[184:187], v[132:135]
    v_mfma_f32_16x16x32_bf16 v[140:143], a[28:31], v[188:191], v[140:143]
    s_waitcnt lgkmcnt(0)
    v_mfma_f32_16x16x32_bf16 v[128:131], a[32:35], v[192:195], v[128:131]
    v_mfma_f32_16x16x32_bf16 v[136:139], a[32:35], v[196:199], v[136:139]
    v_mfma_f32_16x16x32_bf16 v[132:135], a[36:39], v[192:195], v[132:135]
    v_mfma_f32_16x16x32_bf16 v[140:143], a[36:39], v[196:199], v[140:143]
    v_mfma_f32_16x16x32_bf16 v[128:131], a[40:43], v[200:203], v[128:131]
    v_mfma_f32_16x16x32_bf16 v[136:139], a[40:43], v[204:207], v[136:139]
    v_mfma_f32_16x16x32_bf16 v[132:135], a[44:47], v[200:203], v[132:135]
    v_mfma_f32_16x16x32_bf16 v[140:143], a[44:47], v[204:207], v[140:143]
    s_mov_b32 s53, 917504
    s_nop 3
    v_cvt_pk_bf16_f32 v168, v128, v129
    v_cvt_pk_bf16_f32 v169, v130, v131
    v_cvt_pk_bf16_f32 v170, v132, v133
    v_cvt_pk_bf16_f32 v171, v134, v135
    buffer_store_dwordx4 v[168:171], v32, s[40:43], s53 offen sc1
    s_mov_b32 s54, 933888
    v_cvt_pk_bf16_f32 v172, v136, v137
    v_cvt_pk_bf16_f32 v173, v138, v139
    v_cvt_pk_bf16_f32 v174, v140, v141
    v_cvt_pk_bf16_f32 v175, v142, v143
    buffer_store_dwordx4 v[172:175], v32, s[40:43], s54 offen sc1
    s_memrealtime s[72:73]
    s_lshl_b32 s65, s63, 14
    s_lshl_b32 s67, s3, 8
    s_add_u32 s65, s65, s67
    s_add_u32 s65, s65, 786432
    s_add_u32 s44, s65, 4096
    s_add_u32 s45, s65, 8192
    s_add_u32 s46, s65, 12288
    v_lshlrev_b32 v1, 2, v0
    v_lshrrev_b32 v2, 2, v0
    v_lshlrev_b32 v2, 10, v2
    v_bfe_u32 v3, v0, 1, 1
    v_lshl_add_u32 v2, v3, 5, v2
    v_and_b32 v3, 1, v0
    v_lshl_add_u32 v2, v3, 2, v2
    s_lshl_b32 s47, 3, 1
    s_lshr_b32 s52, s63, 3
    s_add_u32 s47, s47, s52
    s_and_b32 s52, s61, 7
    s_xor_b32 s47, s47, s52
    s_lshl_b32 s47, s47, 7
    s_bfe_u32 s52, s63, 0x10002
    s_lshl_b32 s52, s52, 6
    s_add_u32 s47, s47, s52
    s_and_b32 s52, s63, 3
    s_lshl_b32 s52, s52, 14
    s_add_u32 s47, s47, s52
    s_lshl_b32 s52, s3, 3
    s_add_u32 s47, s47, s52
    s_mov_b32 s66, 0xffff0000
    s_waitcnt lgkmcnt(0)
    v_mov_b32 v4, s72
    v_mov_b32 v5, s73
    s_waitcnt vmcnt(4)
    s_mov_b64 exec, 15
    buffer_store_dwordx2 v[4:5], v6, s[92:95], s55 offen offset:256 sc0 sc1
    s_mov_b64 exec, -1
    s_waitcnt vmcnt(1)
    s_mov_b64 exec, 15
    buffer_store_dwordx2 v[4:5], v6, s[92:95], s55 offen offset:384 sc0 sc1
    s_mov_b64 exec, -1
    s_lshl_b32 s52, s63, 9
    s_add_u32 s52, s52, 384
    v_and_b32 v3, 15, v0
    v_lshlrev_b32 v3, 3, v3
    v_mov_b32 v66, s71
    s_mov_b32 s67, 0
L_poll_f:
    buffer_load_dwordx2 v[64:65], v3, s[92:95], s52 offen sc0 sc1
    s_waitcnt vmcnt(0)
    v_subrev_co_u32 v64, vcc, s70, v64
    s_nop 1
    v_subb_co_u32 v65, vcc, v65, v66, vcc
    v_lshrrev_b32 v64, 24, v64
    v_or_b32 v64, v64, v65
    v_cmp_ne_u32 vcc, 0, v64
    s_nop 4
    s_cbranch_vccz L_poll_f_done
    s_add_u32 s67, s67, 1
    s_cmp_lt_u32 s67, 0x40000
    s_cbranch_scc1 L_poll_f
L_poll_f_done:
    s_mov_b32 s67, 0
L_poll_c:
    buffer_load_dword v48, v1, s[88:91], s65 offen offset:0 sc1
    buffer_load_dword v49, v1, s[88:91], s65 offen offset:1024 sc1
    buffer_load_dword v50, v1, s[88:91], s65 offen offset:2048 sc1
    buffer_load_dword v51, v1, s[88:91], s65 offen offset:3072 sc1
    buffer_load_dword v52, v1, s[88:91], s44 offen offset:0 sc1
    buffer_load_dword v53, v1, s[88:91], s44 offen offset:1024 sc1
    buffer_load_dword v54, v1, s[88:91], s44 offen offset:2048 sc1
    buffer_load_dword v55, v1, s[88:91], s44 offen offset:3072 sc1
    buffer_load_dword v56, v1, s[88:91], s45 offen offset:0 sc1
    buffer_load_dword v57, v1, s[88:91], s45 offen offset:1024 sc1
    buffer_load_dword v58, v1, s[88:91], s45 offen offset:2048 sc1
    buffer_load_dword v59, v1, s[88:91], s45 offen offset:3072 sc1
    buffer_load_dword v60, v1, s[88:91], s46 offen offset:0 sc1
    buffer_load_dword v61, v1, s[88:91], s46 offen offset:1024 sc1
    buffer_load_dword v62, v1, s[88:91], s46 offen offset:2048 sc1
    buffer_load_dword v63, v1, s[88:91], s46 offen offset:3072 sc1
    s_add_u32 s67, s67, 1
    s_waitcnt vmcnt(14)
    v_max_u32 v3, v48, v49
    v_lshlrev_b32 v4, 16, v48
    v_and_b32 v5, s66, v48
    v_lshlrev_b32 v6, 16, v49
    v_and_b32 v7, s66, v49
    v_add_f32 v4, v4, v6
    v_add_f32 v5, v5, v7
    s_waitcnt vmcnt(12)
    v_max3_u32 v3, v3, v50, v51
    v_lshlrev_b32 v6, 16, v50
    v_and_b32 v7, s66, v50
    v_add_f32 v4, v4, v6
    v_add_f32 v5, v5, v7
    v_lshlrev_b32 v6, 16, v51
    v_and_b32 v7, s66, v51
    v_add_f32 v4, v4, v6
    v_add_f32 v5, v5, v7
    s_waitcnt vmcnt(10)
    v_max3_u32 v3, v3, v52, v53
    v_lshlrev_b32 v6, 16, v52
    v_and_b32 v7, s66, v52
    v_add_f32 v4, v4, v6
    v_add_f32 v5, v5, v7
    v_lshlrev_b32 v6, 16, v53
    v_and_b32 v7, s66, v53
    v_add_f32 v4, v4, v6
    v_add_f32 v5, v5, v7
    s_waitcnt vmcnt(8)
    v_max3_u32 v3, v3, v54, v55
    v_lshlrev_b32 v6, 16, v54
    v_and_b32 v7, s66, v54
    v_add_f32 v4, v4, v6
    v_add_f32 v5, v5, v7
    v_lshlrev_b32 v6, 16, v55
    v_and_b32 v7, s66, v55
    v_add_f32 v4, v4, v6
    v_add_f32 v5, v5, v7
    s_waitcnt vmcnt(6)
    v_max3_u32 v3, v3, v56, v57
    v_lshlrev_b32 v6, 16, v56
    v_and_b32 v7, s66, v56
    v_add_f32 v4, v4, v6
    v_add_f32 v5, v5, v7
    v_lshlrev_b32 v6, 16, v57
    v_and_b32 v7, s66, v57
    v_add_f32 v4, v4, v6
    v_add_f32 v5, v5, v7
    s_waitcnt vmcnt(4)
    v_max3_u32 v3, v3, v58, v59
    v_lshlrev_b32 v6, 16, v58
    v_and_b32 v7, s66, v58
    v_add_f32 v4, v4, v6
    v_add_f32 v5, v5, v7
    v_lshlrev_b32 v6, 16, v59
    v_and_b32 v7, s66, v59
    v_add_f32 v4, v4, v6
    v_add_f32 v5, v5, v7
    s_waitcnt vmcnt(2)
    v_max3_u32 v3, v3, v60, v61
    v_lshlrev_b32 v6, 16, v60
    v_and_b32 v7, s66, v60
    v_add_f32 v4, v4, v6
    v_add_f32 v5, v5, v7
    v_lshlrev_b32 v6, 16, v61
    v_and_b32 v7, s66, v61
    v_add_f32 v4, v4, v6
    v_add_f32 v5, v5, v7
    s_waitcnt vmcnt(0)
    v_max3_u32 v3, v3, v62, v63
    v_lshlrev_b32 v6, 16, v62
    v_and_b32 v7, s66, v62
    v_add_f32 v4, v4, v6
    v_add_f32 v5, v5, v7
    v_lshlrev_b32 v6, 16, v63
    v_and_b32 v7, s66, v63
    v_add_f32 v4, v4, v6
    v_add_f32 v5, v5, v7
    v_cmp_eq_u32 vcc, -1, v3
    s_cmp_gt_u32 s67, 0x40000
    s_cbranch_scc1 L_poll_c_done
    s_nop 3
L_poll_c_done:
    v_cvt_pk_bf16_f32 v4, v4, v5
    buffer_store_dword v4, v2, s[84:87], s47 offen
    s_endpgm
L_safe_compute:
    v_mov_b32 v1, 131072
    v_mov_b32 v2, -1
    ds_write_b32 v1, v2
    s_waitcnt lgkmcnt(0)
    s_barrier
    s_barrier
    s_mov_b32 s78, 0
    s_mov_b32 s67, 0
L_safe_c_loop:
    s_barrier
    ds_read_b128 a[0:3], v8 offset:0
    ds_read_b128 a[4:7], v9 offset:0
    ds_read_b128 a[8:11], v10 offset:0
    ds_read_b128 a[12:15], v11 offset:0
    ds_read_b128 a[16:19], v8 offset:4096
    ds_read_b128 a[20:23], v9 offset:4096
    ds_read_b128 a[24:27], v10 offset:4096
    ds_read_b128 a[28:31], v11 offset:4096
    s_waitcnt lgkmcnt(0)
    v_mfma_f32_16x16x32_bf16 v[48:51], a[0:3], v[176:179], 0
    v_mfma_f32_16x16x32_bf16 v[56:59], a[0:3], v[192:195], 0
    v_mfma_f32_16x16x32_bf16 v[48:51], a[4:7], v[180:183], v[48:51]
    v_mfma_f32_16x16x32_bf16 v[56:59], a[4:7], v[196:199], v[56:59]
    v_mfma_f32_16x16x32_bf16 v[48:51], a[8:11], v[184:187], v[48:51]
    v_mfma_f32_16x16x32_bf16 v[56:59], a[8:11], v[200:203], v[56:59]
    v_mfma_f32_16x16x32_bf16 v[48:51], a[12:15], v[188:191], v[48:51]
    v_mfma_f32_16x16x32_bf16 v[56:59], a[12:15], v[204:207], v[56:59]
    v_mfma_f32_16x16x32_bf16 v[52:55], a[16:19], v[176:179], 0
    v_mfma_f32_16x16x32_bf16 v[60:63], a[16:19], v[192:195], 0
    v_mfma_f32_16x16x32_bf16 v[52:55], a[20:23], v[180:183], v[52:55]
    v_mfma_f32_16x16x32_bf16 v[60:63], a[20:23], v[196:199], v[60:63]
    v_mfma_f32_16x16x32_bf16 v[52:55], a[24:27], v[184:187], v[52:55]
    v_mfma_f32_16x16x32_bf16 v[60:63], a[24:27], v[200:203], v[60:63]
    v_mfma_f32_16x16x32_bf16 v[52:55], a[28:31], v[188:191], v[52:55]
    v_mfma_f32_16x16x32_bf16 v[60:63], a[28:31], v[204:207], v[60:63]
    s_nop 7
    ds_read_b128 a[0:3], v8 offset:8192
    ds_read_b128 a[4:7], v9 offset:8192
    ds_read_b128 a[8:11], v10 offset:8192
    ds_read_b128 a[12:15], v11 offset:8192
    ds_read_b128 a[16:19], v8 offset:12288
    ds_read_b128 a[20:23], v9 offset:12288
    ds_read_b128 a[24:27], v10 offset:12288
    ds_read_b128 a[28:31], v11 offset:12288
    s_waitcnt lgkmcnt(0)
    v_mfma_f32_16x16x32_bf16 v[64:67], a[0:3], v[176:179], 0
    v_mfma_f32_16x16x32_bf16 v[72:75], a[0:3], v[192:195], 0
    v_mfma_f32_16x16x32_bf16 v[64:67], a[4:7], v[180:183], v[64:67]
    v_mfma_f32_16x16x32_bf16 v[72:75], a[4:7], v[196:199], v[72:75]
    v_mfma_f32_16x16x32_bf16 v[64:67], a[8:11], v[184:187], v[64:67]
    v_mfma_f32_16x16x32_bf16 v[72:75], a[8:11], v[200:203], v[72:75]
    v_mfma_f32_16x16x32_bf16 v[64:67], a[12:15], v[188:191], v[64:67]
    v_mfma_f32_16x16x32_bf16 v[72:75], a[12:15], v[204:207], v[72:75]
    v_mfma_f32_16x16x32_bf16 v[68:71], a[16:19], v[176:179], 0
    v_mfma_f32_16x16x32_bf16 v[76:79], a[16:19], v[192:195], 0
    v_mfma_f32_16x16x32_bf16 v[68:71], a[20:23], v[180:183], v[68:71]
    v_mfma_f32_16x16x32_bf16 v[76:79], a[20:23], v[196:199], v[76:79]
    v_mfma_f32_16x16x32_bf16 v[68:71], a[24:27], v[184:187], v[68:71]
    v_mfma_f32_16x16x32_bf16 v[76:79], a[24:27], v[200:203], v[76:79]
    v_mfma_f32_16x16x32_bf16 v[68:71], a[28:31], v[188:191], v[68:71]
    v_mfma_f32_16x16x32_bf16 v[76:79], a[28:31], v[204:207], v[76:79]
    s_nop 7
    s_barrier
    v_max3_f32 v38, v38, v48, v49
    v_max3_f32 v38, v38, v50, v51
    v_max3_f32 v38, v38, v52, v53
    v_max3_f32 v38, v38, v54, v55
    v_max3_f32 v38, v38, v64, v65
    v_max3_f32 v38, v38, v66, v67
    v_max3_f32 v38, v38, v68, v69
    v_max3_f32 v38, v38, v70, v71
    v_max3_f32 v39, v39, v56, v57
    v_max3_f32 v39, v39, v58, v59
    v_max3_f32 v39, v39, v60, v61
    v_max3_f32 v39, v39, v62, v63
    v_max3_f32 v39, v39, v72, v73
    v_max3_f32 v39, v39, v74, v75
    v_max3_f32 v39, v39, v76, v77
    v_max3_f32 v39, v39, v78, v79
    s_add_u32 s67, s67, 1
    s_cmp_lt_u32 s67, 16
    s_cbranch_scc1 L_safe_c_loop
    s_barrier
    ds_read_b128 a[0:3], v8 offset:32768
    ds_read_b128 a[4:7], v9 offset:32768
    ds_read_b128 a[8:11], v10 offset:32768
    ds_read_b128 a[12:15], v11 offset:32768
    ds_read_b128 a[16:19], v8 offset:36864
    s_waitcnt lgkmcnt(0)
    v_mfma_f32_16x16x32_bf16 v[48:51], a[0:3], v[176:179], 0
    v_mfma_f32_16x16x32_bf16 v[56:59], a[0:3], v[192:195], 0
    v_mfma_f32_16x16x32_bf16 v[48:51], a[4:7], v[180:183], v[48:51]
    v_mfma_f32_16x16x32_bf16 v[56:59], a[4:7], v[196:199], v[56:59]
    v_mfma_f32_16x16x32_bf16 v[48:51], a[8:11], v[184:187], v[48:51]
    v_mfma_f32_16x16x32_bf16 v[56:59], a[8:11], v[200:203], v[56:59]
    v_mfma_f32_16x16x32_bf16 v[48:51], a[12:15], v[188:191], v[48:51]
    v_mfma_f32_16x16x32_bf16 v[56:59], a[12:15], v[204:207], v[56:59]
    v_mfma_f32_16x16x32_bf16 v[52:55], a[16:19], v[176:179], 0
    v_mfma_f32_16x16x32_bf16 v[60:63], a[16:19], v[192:195], 0
    s_nop 7
    ds_read_b128 a[4:7], v9 offset:36864
    ds_read_b128 a[8:11], v10 offset:36864
    ds_read_b128 a[12:15], v11 offset:36864
    ds_read_b128 a[16:19], v8 offset:40960
    ds_read_b128 a[20:23], v9 offset:40960
    ds_read_b128 a[24:27], v10 offset:40960
    ds_read_b128 a[28:31], v11 offset:40960
    ds_read_b128 a[32:35], v8 offset:45056
    s_waitcnt lgkmcnt(0)
    s_branch L_re_compute
L_code_end:
.section .rodata,"a"
.p2align 6
.amdhsa_kernel standalone__gqa_block_cached__near_ridge_kernel
  .amdhsa_next_free_vgpr 256
  .amdhsa_next_free_sgpr 102
  .amdhsa_accum_offset 208
  .amdhsa_group_segment_fixed_size 0
  .amdhsa_kernarg_size 64
  .amdhsa_user_sgpr_count 2
  .amdhsa_user_sgpr_kernarg_segment_ptr 1
  .amdhsa_system_sgpr_workgroup_id_x 1
.end_amdhsa_kernel
```
